```python
import torch

def _softmax(x, axis=-1):
    return torch.softmax(x, dim=axis)
def _gelu(x):
    return torch.nn.functional.gelu(x, approximate="tanh")
def _silu(x):
    return torch.nn.functional.silu(x)
def _sigmoid(x):
    return torch.sigmoid(x)
def _layernorm(x, axis=-1, eps=1e-5):
    m = x.mean(dim=axis, keepdim=True)
    v = x.var(dim=axis, keepdim=True, unbiased=False)
    return (x - m) / torch.sqrt(v + eps)
def _scatter_add(tgt, idx, src, axis=0):
    return tgt.clone().index_add_(axis, idx, src)
def _segment_sum(src, seg, n):
    out = torch.zeros((n,) + src.shape[1:], dtype=src.dtype)
    return out.index_add_(0, seg, src)
def _pad(x, pw):
    flat = tuple(v for pair in reversed(pw) for v in pair)
    return torch.nn.functional.pad(x, flat)

kernel_name = 'concat_heads__spectral_gfnet__grouped_kv_mqa__prompt'

def setup_inputs():

    _w = (lambda a: (lambda t: t.to(torch.bfloat16) if t.is_floating_point() else t)(torch.as_tensor(a)))
    def _A_setup():
        B, S, D = 1, 2048, 576
        Df = D // 2 + 1
        return {
            "x": _w((lambda *s: torch.randn(*s, dtype=torch.bfloat16) * 0.05)(B, S, D)),
            "w_r": _w((lambda *s: torch.randn(*s, dtype=torch.bfloat16) * 0.8)(S, Df) * 0.02),
            "w_i": _w((lambda *s: torch.randn(*s, dtype=torch.bfloat16) * 0.8)(S, Df) * 0.02),
        }
    _A_in = _A_setup()

    def _B_setup():
        B, S, D, H = 1, 2048, 576, 32
        Dh = D // H
        return {
            "x": _w((lambda *s: torch.randn(*s, dtype=torch.bfloat16) * 0.05)(B, S, D)),
            "wq": _w((lambda *s: torch.randn(*s, dtype=torch.bfloat16) * 0.8)(D, H * Dh)),
            "wk": _w((lambda *s: torch.randn(*s, dtype=torch.bfloat16) * 0.8)(D, Dh)),
            "wv": _w((lambda *s: torch.randn(*s, dtype=torch.bfloat16) * 0.05)(D, Dh)),
            "wo": _w((lambda *s: torch.randn(*s, dtype=torch.bfloat16) * 0.05)(H * Dh, D)),
        }
    _B_in = _B_setup()

    return {
        "A_x": _A_in["x"],
        "A_w_r": _A_in["w_r"],
        "A_w_i": _A_in["w_i"],
        "B_x": _B_in["x"],
        "B_wq": _B_in["wq"],
        "B_wk": _B_in["wk"],
        "B_wv": _B_in["wv"],
        "B_wo": _B_in["wo"],
    }

def reference(A_x, A_w_r, A_w_i, B_x, B_wq, B_wk, B_wv, B_wo):
    def _A_ref(x, w_r, w_i):
        B, S, D = x.shape
        X = (lambda x, axes=(-2,-1): torch.fft.rfft2(x.float(), dim=axes))(x, axes=(-2, -1))
        W = w_r + 1j * w_i
        X = X * W
        y = (lambda x, s, axes=(-2,-1): torch.fft.irfft2(x, s=s, dim=axes).to(torch.bfloat16))(X, (S, D), axes=(-2, -1))
        return y

    def _B_ref(x, wq, wk, wv, wo):
        B, S, D = x.shape
        H = 32
        Dh = D // H
        q = (lambda x, *d: x.permute(*d))((x @ wq).reshape(B, S, H, Dh), 0, 2, 1, 3)
        k = x @ wk
        v = x @ wv
        scores = torch.einsum("bhqd,bkd->bhqk", q, k) * (Dh ** -0.5)
        p = _softmax(scores, axis=-1)
        o = torch.einsum("bhqk,bkd->bhqd", p, v)
        return (lambda x, *d: x.permute(*d))(o, 0, 2, 1, 3).reshape(B, S, H * Dh) @ wo

    a = _A_ref(A_x, A_w_r, A_w_i)
    b = _B_ref(B_x, B_wq, B_wk, B_wv, B_wo)
    return torch.concatenate([a, b], axis=-1)
```

```asm
; @launch kernel=k1_kernel grid=(256,1,1) block=(512,1,1) lds=143360
; @launch kernel=k2_kernel grid=(256,1,1) block=(768,1,1) lds=69632
; @launch kernel=k3_kernel grid=(192,1,1) block=(512,1,1) lds=143360
.amdgcn_target "amdgcn-amd-amdhsa--gfx950"
.text
.globl k1_kernel
.p2align 8
.type k1_kernel,@function
k1_kernel:
    s_cmp_ge_u32 s2, 256
    s_cbranch_scc1 K1_end
    s_load_dwordx4 s[36:39], s[0:1], 0
    s_load_dwordx4 s[40:43], s[0:1], 16
    s_load_dwordx4 s[44:47], s[0:1], 32
    s_load_dwordx2 s[48:49], s[0:1], 48
    s_load_dwordx2 s[50:51], s[0:1], 80
    v_lshrrev_b32 v1, 6, v0
    s_nop 0
    v_readfirstlane_b32 s35, v1
    v_and_b32 v0, 63, v0
    s_and_b32 s30, s35, 3
    s_cmp_ge_u32 s2, 208
    s_cbranch_scc1 K1_wt
    s_cmp_ge_u32 s2, 192
    s_cbranch_scc1 K1_kv
    s_cmp_ge_u32 s2, 96
    s_cbranch_scc1 K1_af
    s_lshr_b32 s27, s2, 3
    s_and_b32 s28, s2, 7
    s_lshl_b32 s28, s28, 1
    s_cmp_ge_u32 s27, 6
    s_cselect_b32 s29, 1, 0
    s_add_u32 s28, s28, s29
    s_lshl_b32 s31, s28, 7
    s_mul_i32 s29, s29, 6
    s_sub_u32 s27, s27, s29
    s_mul_i32 s32, s27, 96
    s_waitcnt lgkmcnt(0)
    s_mov_b32 s8, s42
    s_mov_b32 s9, s43
    s_mov_b32 s10, 2359296
    s_mov_b32 s11, 0x00020000
    s_mov_b32 s12, s44
    s_mov_b32 s13, s45
    s_mov_b32 s14, 663552
    s_mov_b32 s15, 0x00020000
    s_mov_b32 s16, s50
    s_mov_b32 s17, s51
    s_mov_b32 s18, 2359296
    s_mov_b32 s19, 0x00020000
    s_mul_i32 s33, s31, 1152
    s_lshl_b32 s34, s32, 1
    s_add_u32 s33, s33, s34
    s_cmp_ge_u32 s35, 4
    s_cbranch_scc1 K1q_ld
    s_mul_i32 s27, s32, 683
    s_lshr_b32 s27, s27, 16
    s_lshr_b32 s28, s31, 7
    s_and_b32 s28, s28, 1
    s_cmp_ge_u32 s30, 2
    s_cbranch_scc1 K1q_pf1
    s_lshl_b32 s29, s30, 6
    v_add_u32 v144, s29, v0
    v_mul_u32_u24 v145, 13108, v144
    v_lshrrev_b32 v145, 16, v145
    v_mul_u32_u24 v146, 5, v145
    v_sub_u32 v146, v144, v146
    s_mul_i32 s29, s27, 22
    s_add_u32 s29, s29, s31
    v_add_u32 v145, s29, v145
    v_mul_u32_u24 v145, 1152, v145
    v_lshl_add_u32 v145, v146, 7, v145
    buffer_load_dword v156, v145, s[8:11], 0 offen offset:512
K1q_pf1:
    s_lshl_b32 s29, s30, 6
    v_add_u32 v144, s29, v0
    s_mul_i32 s29, s28, 320
    v_add_u32 v144, s29, v144
    v_lshrrev_b32 v145, 1, v144
    v_add_u32 v145, 256, v145
    v_mul_u32_u24 v145, 1152, v145
    v_and_b32 v146, 1, v144
    v_lshl_add_u32 v145, v146, 7, v145
    s_lshl_b32 s29, s32, 1
    buffer_load_dword v157, v145, s[12:15], s29 offen
    s_cmp_lg_u32 s30, 2
    s_cbranch_scc1 K1q_pf2
    s_mov_b32 s34, 4
    s_lshl_b32 s29, s34, 6
    v_add_u32 v144, s29, v0
    s_mul_i32 s29, s28, 320
    v_add_u32 v144, s29, v144
    v_lshrrev_b32 v145, 1, v144
    v_add_u32 v145, 256, v145
    v_mul_u32_u24 v145, 1152, v145
    v_and_b32 v146, 1, v144
    v_lshl_add_u32 v145, v146, 7, v145
    s_lshl_b32 s29, s32, 1
    buffer_load_dword v158, v145, s[12:15], s29 offen
K1q_pf2:
    v_and_b32 v144, 31, v0
    v_lshrrev_b32 v145, 5, v0
    v_lshrrev_b32 v146, 1, v144
    v_and_b32 v146, 7, v146
    v_xor_b32 v146, v146, v145
    v_lshlrev_b32 v147, 7, v144
    s_lshl_b32 s27, s30, 12
    v_add_u32 v147, s27, v147
    v_xor_b32 v148, 0, v146
    v_lshl_add_u32 v12, v148, 4, v147
    v_xor_b32 v148, 2, v146
    v_lshl_add_u32 v13, v148, 4, v147
    v_xor_b32 v148, 4, v146
    v_lshl_add_u32 v14, v148, 4, v147
    v_xor_b32 v148, 6, v146
    v_lshl_add_u32 v15, v148, 4, v147
    v_lshrrev_b32 v144, 5, v0
    v_lshlrev_b32 v144, 3, v144
    v_bfe_u32 v145, v0, 2, 2
    v_add_u32 v144, v144, v145
    v_lshlrev_b32 v144, 6, v144
    v_bfe_u32 v145, v0, 4, 1
    v_lshl_add_u32 v144, v145, 5, v144
    v_and_b32 v145, 3, v0
    v_lshl_add_u32 v144, v145, 3, v144
    v_add_u32 v16, 16384, v144
    v_mov_b32 v96, 0
    v_mov_b32 v97, 0
    v_mov_b32 v98, 0
    v_mov_b32 v99, 0
    v_mov_b32 v100, 0
    v_mov_b32 v101, 0
    v_mov_b32 v102, 0
    v_mov_b32 v103, 0
    v_mov_b32 v104, 0
    v_mov_b32 v105, 0
    v_mov_b32 v106, 0
    v_mov_b32 v107, 0
    v_mov_b32 v108, 0
    v_mov_b32 v109, 0
    v_mov_b32 v110, 0
    v_mov_b32 v111, 0
    v_mov_b32 v112, 0
    v_mov_b32 v113, 0
    v_mov_b32 v114, 0
    v_mov_b32 v115, 0
    v_mov_b32 v116, 0
    v_mov_b32 v117, 0
    v_mov_b32 v118, 0
    v_mov_b32 v119, 0
    v_mov_b32 v120, 0
    v_mov_b32 v121, 0
    v_mov_b32 v122, 0
    v_mov_b32 v123, 0
    v_mov_b32 v124, 0
    v_mov_b32 v125, 0
    v_mov_b32 v126, 0
    v_mov_b32 v127, 0
    v_mov_b32 v128, 0
    v_mov_b32 v129, 0
    v_mov_b32 v130, 0
    v_mov_b32 v131, 0
    v_mov_b32 v132, 0
    v_mov_b32 v133, 0
    v_mov_b32 v134, 0
    v_mov_b32 v135, 0
    v_mov_b32 v136, 0
    v_mov_b32 v137, 0
    v_mov_b32 v138, 0
    v_mov_b32 v139, 0
    v_mov_b32 v140, 0
    v_mov_b32 v141, 0
    v_mov_b32 v142, 0
    v_mov_b32 v143, 0
    s_mov_b32 s21, 0
    s_mov_b32 s20, 0
    v_add_u32 v20, s21, v12
    v_add_u32 v21, s21, v13
    v_add_u32 v22, s21, v14
    v_add_u32 v23, s21, v15
    v_add_u32 v24, s21, v16
    s_barrier
    ds_read_b128 v[32:35], v20
    ds_read_b64_tr_b16 v[36:37], v24 offset:0
    ds_read_b64_tr_b16 v[38:39], v24 offset:256
    ds_read_b64_tr_b16 v[40:41], v24 offset:4096
    ds_read_b64_tr_b16 v[42:43], v24 offset:4352
    ds_read_b64_tr_b16 v[44:45], v24 offset:8192
    ds_read_b64_tr_b16 v[46:47], v24 offset:8448
    ds_read_b128 v[48:51], v21
    ds_read_b64_tr_b16 v[52:53], v24 offset:1024
    ds_read_b64_tr_b16 v[54:55], v24 offset:1280
    ds_read_b64_tr_b16 v[56:57], v24 offset:5120
    ds_read_b64_tr_b16 v[58:59], v24 offset:5376
    ds_read_b64_tr_b16 v[60:61], v24 offset:9216
    ds_read_b64_tr_b16 v[62:63], v24 offset:9472
K1q_loop:
    s_barrier
    s_waitcnt lgkmcnt(7)
    v_mfma_f32_32x32x16_bf16 v[96:111], v[36:39], v[32:35], v[96:111]
    ds_read_b128 v[64:67], v22
    ds_read_b64_tr_b16 v[68:69], v24 offset:2048
    ds_read_b64_tr_b16 v[70:71], v24 offset:2304
    v_mfma_f32_32x32x16_bf16 v[112:127], v[40:43], v[32:35], v[112:127]
    ds_read_b64_tr_b16 v[72:73], v24 offset:6144
    ds_read_b64_tr_b16 v[74:75], v24 offset:6400
    ds_read_b64_tr_b16 v[76:77], v24 offset:10240
    v_mfma_f32_32x32x16_bf16 v[128:143], v[44:47], v[32:35], v[128:143]
    ds_read_b64_tr_b16 v[78:79], v24 offset:10496
    s_waitcnt lgkmcnt(7)
    v_mfma_f32_32x32x16_bf16 v[96:111], v[52:55], v[48:51], v[96:111]
    ds_read_b128 v[80:83], v23
    ds_read_b64_tr_b16 v[84:85], v24 offset:3072
    ds_read_b64_tr_b16 v[86:87], v24 offset:3328
    v_mfma_f32_32x32x16_bf16 v[112:127], v[56:59], v[48:51], v[112:127]
    ds_read_b64_tr_b16 v[88:89], v24 offset:7168
    ds_read_b64_tr_b16 v[90:91], v24 offset:7424
    ds_read_b64_tr_b16 v[92:93], v24 offset:11264
    v_mfma_f32_32x32x16_bf16 v[128:143], v[60:63], v[48:51], v[128:143]
    ds_read_b64_tr_b16 v[94:95], v24 offset:11520
    s_add_u32 s21, s21, 28672
    s_cmp_ge_u32 s21, 143360
    s_cselect_b32 s21, 0, s21
    v_add_u32 v20, s21, v12
    v_add_u32 v21, s21, v13
    v_add_u32 v22, s21, v14
    v_add_u32 v23, s21, v15
    v_add_u32 v24, s21, v16
    s_waitcnt lgkmcnt(7)
    v_mfma_f32_32x32x16_bf16 v[96:111], v[68:71], v[64:67], v[96:111]
    ds_read_b128 v[32:35], v20
    ds_read_b64_tr_b16 v[36:37], v24 offset:0
    ds_read_b64_tr_b16 v[38:39], v24 offset:256
    v_mfma_f32_32x32x16_bf16 v[112:127], v[72:75], v[64:67], v[112:127]
    ds_read_b64_tr_b16 v[40:41], v24 offset:4096
    ds_read_b64_tr_b16 v[42:43], v24 offset:4352
    ds_read_b64_tr_b16 v[44:45], v24 offset:8192
    v_mfma_f32_32x32x16_bf16 v[128:143], v[76:79], v[64:67], v[128:143]
    ds_read_b64_tr_b16 v[46:47], v24 offset:8448
    s_waitcnt lgkmcnt(7)
    v_mfma_f32_32x32x16_bf16 v[96:111], v[84:87], v[80:83], v[96:111]
    ds_read_b128 v[48:51], v21
    ds_read_b64_tr_b16 v[52:53], v24 offset:1024
    ds_read_b64_tr_b16 v[54:55], v24 offset:1280
    v_mfma_f32_32x32x16_bf16 v[112:127], v[88:91], v[80:83], v[112:127]
    ds_read_b64_tr_b16 v[56:57], v24 offset:5120
    ds_read_b64_tr_b16 v[58:59], v24 offset:5376
    ds_read_b64_tr_b16 v[60:61], v24 offset:9216
    v_mfma_f32_32x32x16_bf16 v[128:143], v[92:95], v[80:83], v[128:143]
    ds_read_b64_tr_b16 v[62:63], v24 offset:9472
    s_add_u32 s20, s20, 1
    s_cmp_lt_u32 s20, 9
    s_cbranch_scc1 K1q_loop
    s_waitcnt lgkmcnt(0)
    s_nop 7
    s_nop 7
    s_waitcnt vmcnt(0)
    v_and_b32 v144, 31, v0
    s_lshl_b32 s27, s30, 5
    v_add_u32 v144, s27, v144
    v_mul_u32_u24 v144, 208, v144
    v_lshrrev_b32 v145, 5, v0
    v_lshl_add_u32 v144, v145, 3, v144
    s_mov_b32 s29, 1051597459
    v_mul_f32 v96, s29, v96
    v_mul_f32 v97, s29, v97
    v_mul_f32 v98, s29, v98
    v_mul_f32 v99, s29, v99
    v_cvt_pk_bf16_f32 v146, v96, v97
    v_cvt_pk_bf16_f32 v147, v98, v99
    s_barrier
    ds_write_b64 v144, v[146:147] offset:0
    v_mul_f32 v100, s29, v100
    v_mul_f32 v101, s29, v101
    v_mul_f32 v102, s29, v102
    v_mul_f32 v103, s29, v103
    v_cvt_pk_bf16_f32 v148, v100, v101
    v_cvt_pk_bf16_f32 v149, v102, v103
    ds_write_b64 v144, v[148:149] offset:16
    v_mul_f32 v104, s29, v104
    v_mul_f32 v105, s29, v105
    v_mul_f32 v106, s29, v106
    v_mul_f32 v107, s29, v107
    v_cvt_pk_bf16_f32 v150, v104, v105
    v_cvt_pk_bf16_f32 v151, v106, v107
    ds_write_b64 v144, v[150:151] offset:32
    v_mul_f32 v108, s29, v108
    v_mul_f32 v109, s29, v109
    v_mul_f32 v110, s29, v110
    v_mul_f32 v111, s29, v111
    v_cvt_pk_bf16_f32 v152, v108, v109
    v_cvt_pk_bf16_f32 v153, v110, v111
    ds_write_b64 v144, v[152:153] offset:48
    v_mul_f32 v112, s29, v112
    v_mul_f32 v113, s29, v113
    v_mul_f32 v114, s29, v114
    v_mul_f32 v115, s29, v115
    v_cvt_pk_bf16_f32 v146, v112, v113
    v_cvt_pk_bf16_f32 v147, v114, v115
    ds_write_b64 v144, v[146:147] offset:64
    v_mul_f32 v116, s29, v116
    v_mul_f32 v117, s29, v117
    v_mul_f32 v118, s29, v118
    v_mul_f32 v119, s29, v119
    v_cvt_pk_bf16_f32 v148, v116, v117
    v_cvt_pk_bf16_f32 v149, v118, v119
    ds_write_b64 v144, v[148:149] offset:80
    v_mul_f32 v120, s29, v120
    v_mul_f32 v121, s29, v121
    v_mul_f32 v122, s29, v122
    v_mul_f32 v123, s29, v123
    v_cvt_pk_bf16_f32 v150, v120, v121
    v_cvt_pk_bf16_f32 v151, v122, v123
    ds_write_b64 v144, v[150:151] offset:96
    v_mul_f32 v124, s29, v124
    v_mul_f32 v125, s29, v125
    v_mul_f32 v126, s29, v126
    v_mul_f32 v127, s29, v127
    v_cvt_pk_bf16_f32 v152, v124, v125
    v_cvt_pk_bf16_f32 v153, v126, v127
    ds_write_b64 v144, v[152:153] offset:112
    v_mul_f32 v128, s29, v128
    v_mul_f32 v129, s29, v129
    v_mul_f32 v130, s29, v130
    v_mul_f32 v131, s29, v131
    v_cvt_pk_bf16_f32 v146, v128, v129
    v_cvt_pk_bf16_f32 v147, v130, v131
    ds_write_b64 v144, v[146:147] offset:128
    v_mul_f32 v132, s29, v132
    v_mul_f32 v133, s29, v133
    v_mul_f32 v134, s29, v134
    v_mul_f32 v135, s29, v135
    v_cvt_pk_bf16_f32 v148, v132, v133
    v_cvt_pk_bf16_f32 v149, v134, v135
    ds_write_b64 v144, v[148:149] offset:144
    v_mul_f32 v136, s29, v136
    v_mul_f32 v137, s29, v137
    v_mul_f32 v138, s29, v138
    v_mul_f32 v139, s29, v139
    v_cvt_pk_bf16_f32 v150, v136, v137
    v_cvt_pk_bf16_f32 v151, v138, v139
    ds_write_b64 v144, v[150:151] offset:160
    v_mul_f32 v140, s29, v140
    v_mul_f32 v141, s29, v141
    v_mul_f32 v142, s29, v142
    v_mul_f32 v143, s29, v143
    v_cvt_pk_bf16_f32 v152, v140, v141
    v_cvt_pk_bf16_f32 v153, v142, v143
    ds_write_b64 v144, v[152:153] offset:176
    s_waitcnt lgkmcnt(0)
    s_barrier
    s_branch K1q_st
K1q_ld:
    v_lshrrev_b32 v144, 3, v0
    v_and_b32 v145, 7, v0
    v_add_u32 v146, 0, v144
    v_lshrrev_b32 v147, 1, v146
    v_and_b32 v147, 7, v147
    v_xor_b32 v147, v147, v145
    s_lshl_b32 s27, s30, 5
    s_add_u32 s27, s27, s31
    v_add_u32 v146, s27, v146
    s_movk_i32 s28, 1152
    v_mul_lo_u32 v146, v146, s28
    v_lshl_add_u32 v2, v147, 4, v146
    v_add_u32 v146, 8, v144
    v_lshrrev_b32 v147, 1, v146
    v_and_b32 v147, 7, v147
    v_xor_b32 v147, v147, v145
    s_lshl_b32 s27, s30, 5
    s_add_u32 s27, s27, s31
    v_add_u32 v146, s27, v146
    s_movk_i32 s28, 1152
    v_mul_lo_u32 v146, v146, s28
    v_lshl_add_u32 v3, v147, 4, v146
    v_add_u32 v146, 16, v144
    v_lshrrev_b32 v147, 1, v146
    v_and_b32 v147, 7, v147
    v_xor_b32 v147, v147, v145
    s_lshl_b32 s27, s30, 5
    s_add_u32 s27, s27, s31
    v_add_u32 v146, s27, v146
    s_movk_i32 s28, 1152
    v_mul_lo_u32 v146, v146, s28
    v_lshl_add_u32 v4, v147, 4, v146
    v_add_u32 v146, 24, v144
    v_lshrrev_b32 v147, 1, v146
    v_and_b32 v147, 7, v147
    v_xor_b32 v147, v147, v145
    s_lshl_b32 s27, s30, 5
    s_add_u32 s27, s27, s31
    v_add_u32 v146, s27, v146
    s_movk_i32 s28, 1152
    v_mul_lo_u32 v146, v146, s28
    v_lshl_add_u32 v5, v147, 4, v146
    v_lshrrev_b32 v144, 2, v0
    v_and_b32 v145, 3, v0
    v_lshlrev_b32 v145, 4, v145
    s_mov_b32 s28, 1152
    s_lshl_b32 s27, s30, 4
    v_add_u32 v144, s27, v144
    v_mul_lo_u32 v146, v144, s28
    v_add_u32 v146, v146, v145
    s_lshl_b32 s27, s32, 1
    v_add_u32 v6, s27, v146
    v_add_u32 v7, 64, v6
    v_add_u32 v8, 128, v6
    s_mov_b32 s22, 0
    s_mov_b32 s23, 0
    s_mov_b32 s24, 0
    s_mov_b32 s20, 0
K1q_pro:
    s_lshl_b32 s27, s30, 12
    s_add_u32 s27, s27, s22
    s_add_u32 m0, s27, 0
    s_nop 0
    buffer_load_dwordx4 v2, s[8:11], s23 offen lds
    s_add_u32 m0, s27, 1024
    s_nop 0
    buffer_load_dwordx4 v3, s[8:11], s23 offen lds
    s_add_u32 m0, s27, 2048
    s_nop 0
    buffer_load_dwordx4 v4, s[8:11], s23 offen lds
    s_add_u32 m0, s27, 3072
    s_nop 0
    buffer_load_dwordx4 v5, s[8:11], s23 offen lds
    s_lshl_b32 s27, s30, 10
    s_add_u32 s27, s27, s22
    s_add_u32 m0, s27, 16384
    s_nop 0
    buffer_load_dwordx4 v6, s[12:15], s24 offen lds
    s_add_u32 m0, s27, 20480
    s_nop 0
    buffer_load_dwordx4 v7, s[12:15], s24 offen lds
    s_add_u32 m0, s27, 24576
    s_nop 0
    buffer_load_dwordx4 v8, s[12:15], s24 offen lds
    s_add_u32 s22, s22, 28672
    s_add_u32 s23, s23, 128
    s_add_u32 s24, s24, 73728
    s_add_u32 s20, s20, 1
    s_cmp_lt_u32 s20, 4
    s_cbranch_scc1 K1q_pro
    s_mov_b32 s20, 0
    s_waitcnt vmcnt(21)
    s_barrier
K1q_lloop:
    s_waitcnt vmcnt(14)
    s_barrier
    s_lshl_b32 s27, s30, 12
    s_add_u32 s27, s27, s22
    s_add_u32 m0, s27, 0
    s_nop 0
    buffer_load_dwordx4 v2, s[8:11], s23 offen lds
    s_add_u32 m0, s27, 1024
    s_nop 0
    buffer_load_dwordx4 v3, s[8:11], s23 offen lds
    s_add_u32 m0, s27, 2048
    s_nop 0
    buffer_load_dwordx4 v4, s[8:11], s23 offen lds
    s_add_u32 m0, s27, 3072
    s_nop 0
    buffer_load_dwordx4 v5, s[8:11], s23 offen lds
    s_lshl_b32 s27, s30, 10
    s_add_u32 s27, s27, s22
    s_add_u32 m0, s27, 16384
    s_nop 0
    buffer_load_dwordx4 v6, s[12:15], s24 offen lds
    s_add_u32 m0, s27, 20480
    s_nop 0
    buffer_load_dwordx4 v7, s[12:15], s24 offen lds
    s_add_u32 m0, s27, 24576
    s_nop 0
    buffer_load_dwordx4 v8, s[12:15], s24 offen lds
    s_add_u32 s22, s22, 28672
    s_cmp_ge_u32 s22, 143360
    s_cselect_b32 s22, 0, s22
    s_add_u32 s23, s23, 128
    s_add_u32 s24, s24, 73728
    s_add_u32 s20, s20, 1
    s_cmp_lt_u32 s20, 5
    s_cbranch_scc1 K1q_lloop
    s_waitcnt vmcnt(14)
    s_barrier
    s_waitcnt vmcnt(7)
    s_barrier
    s_waitcnt vmcnt(0)
    s_barrier
    s_barrier
    s_lshl_b32 s27, s35, 6
    v_add_u32 v144, s27, v0
    v_add_u32 v147, 0, v144
    v_mul_u32_u24 v145, 5462, v147
    v_lshrrev_b32 v145, 16, v145
    v_mul_u32_u24 v146, 12, v145
    v_sub_u32 v146, v147, v146
    v_lshlrev_b32 v146, 4, v146
    v_mul_u32_u24 v148, 208, v145
    v_add_u32 v148, v148, v146
    v_mul_u32_u24 v152, 1152, v145
    v_add_u32 v152, v152, v146
    v_add_u32 v147, 512, v144
    v_mul_u32_u24 v145, 5462, v147
    v_lshrrev_b32 v145, 16, v145
    v_mul_u32_u24 v146, 12, v145
    v_sub_u32 v146, v147, v146
    v_lshlrev_b32 v146, 4, v146
    v_mul_u32_u24 v149, 208, v145
    v_add_u32 v149, v149, v146
    v_mul_u32_u24 v153, 1152, v145
    v_add_u32 v153, v153, v146
    v_add_u32 v147, 1024, v144
    v_mul_u32_u24 v145, 5462, v147
    v_lshrrev_b32 v145, 16, v145
    v_mul_u32_u24 v146, 12, v145
    v_sub_u32 v146, v147, v146
    v_lshlrev_b32 v146, 4, v146
    v_mul_u32_u24 v150, 208, v145
    v_add_u32 v150, v150, v146
    v_mul_u32_u24 v154, 1152, v145
    v_add_u32 v154, v154, v146
    s_barrier
    s_barrier
    s_branch K1q_st2
K1q_st:
    s_lshl_b32 s27, s35, 6
    v_add_u32 v144, s27, v0
    v_add_u32 v147, 0, v144
    v_mul_u32_u24 v145, 5462, v147
    v_lshrrev_b32 v145, 16, v145
    v_mul_u32_u24 v146, 12, v145
    v_sub_u32 v146, v147, v146
    v_lshlrev_b32 v146, 4, v146
    v_mul_u32_u24 v148, 208, v145
    v_add_u32 v148, v148, v146
    v_mul_u32_u24 v152, 1152, v145
    v_add_u32 v152, v152, v146
    v_add_u32 v147, 512, v144
    v_mul_u32_u24 v145, 5462, v147
    v_lshrrev_b32 v145, 16, v145
    v_mul_u32_u24 v146, 12, v145
    v_sub_u32 v146, v147, v146
    v_lshlrev_b32 v146, 4, v146
    v_mul_u32_u24 v149, 208, v145
    v_add_u32 v149, v149, v146
    v_mul_u32_u24 v153, 1152, v145
    v_add_u32 v153, v153, v146
    v_add_u32 v147, 1024, v144
    v_mul_u32_u24 v145, 5462, v147
    v_lshrrev_b32 v145, 16, v145
    v_mul_u32_u24 v146, 12, v145
    v_sub_u32 v146, v147, v146
    v_lshlrev_b32 v146, 4, v146
    v_mul_u32_u24 v150, 208, v145
    v_add_u32 v150, v150, v146
    v_mul_u32_u24 v154, 1152, v145
    v_add_u32 v154, v154, v146
K1q_st2:
    ds_read_b128 v[32:35], v148
    ds_read_b128 v[36:39], v149
    ds_read_b128 v[40:43], v150
    s_waitcnt lgkmcnt(2)
    buffer_store_dwordx4 v[32:35], v152, s[16:19], s33 offen
    s_waitcnt lgkmcnt(1)
    buffer_store_dwordx4 v[36:39], v153, s[16:19], s33 offen
    s_waitcnt lgkmcnt(0)
    buffer_store_dwordx4 v[40:43], v154, s[16:19], s33 offen
    s_endpgm
K1_af:
    s_sub_u32 s3, s2, 96
    s_lshr_b32 s27, s3, 3
    s_and_b32 s28, s3, 7
    s_lshl_b32 s28, s28, 1
    s_cmp_ge_u32 s27, 6
    s_cselect_b32 s29, 1, 0
    s_add_u32 s28, s28, s29
    s_lshl_b32 s31, s28, 7
    s_mul_i32 s29, s29, 6
    s_sub_u32 s27, s27, s29
    s_mul_i32 s32, s27, 96
    s_getpc_b64 s[52:53]
K1_pc1:
    s_add_u32 s52, s52, TTAB-K1_pc1
    s_addc_u32 s53, s53, 0
    s_waitcnt lgkmcnt(0)
    s_mov_b32 s8, s36
    s_mov_b32 s9, s37
    s_mov_b32 s10, 2359296
    s_mov_b32 s11, 0x00020000
    s_mov_b32 s12, s52
    s_mov_b32 s13, s53
    s_mov_b32 s14, 663552
    s_mov_b32 s15, 0x00020000
    s_add_u32 s16, s50, 2621440
    s_addc_u32 s17, s51, 0
    s_mov_b32 s18, 2359296
    s_mov_b32 s19, 0x00020000
    s_lshl_b32 s33, s32, 12
    s_lshl_b32 s34, s31, 2
    s_add_u32 s33, s33, s34
    s_cmp_ge_u32 s35, 4
    s_cbranch_scc1 K1a_ld
    s_mul_i32 s27, s32, 683
    s_lshr_b32 s27, s27, 16
    s_lshr_b32 s28, s31, 7
    s_and_b32 s28, s28, 1
    s_cmp_ge_u32 s30, 2
    s_cbranch_scc1 K1a_pf1
    s_lshl_b32 s29, s30, 6
    v_add_u32 v144, s29, v0
    v_mul_u32_u24 v145, 13108, v144
    v_lshrrev_b32 v145, 16, v145
    v_mul_u32_u24 v146, 5, v145
    v_sub_u32 v146, v144, v146
    s_mul_i32 s29, s27, 22
    s_add_u32 s29, s29, s31
    v_add_u32 v145, s29, v145
    v_mul_u32_u24 v145, 1152, v145
    v_lshl_add_u32 v145, v146, 7, v145
    buffer_load_dword v156, v145, s[8:11], 0 offen offset:512
K1a_pf1:
    s_lshl_b32 s29, s30, 6
    v_add_u32 v144, s29, v0
    s_mul_i32 s29, s28, 240
    v_add_u32 v144, s29, v144
    v_mul_u32_u24 v145, 13108, v144
    v_lshrrev_b32 v145, 16, v145
    v_mul_u32_u24 v146, 5, v145
    v_sub_u32 v146, v144, v146
    v_add_u32 v145, s32, v145
    v_mul_u32_u24 v145, 1152, v145
    v_lshl_add_u32 v145, v146, 7, v145
    buffer_load_dword v157, v145, s[12:15], 0 offen offset:512
    v_and_b32 v144, 31, v0
    v_lshrrev_b32 v145, 5, v0
    v_lshrrev_b32 v146, 1, v144
    v_and_b32 v146, 7, v146
    v_xor_b32 v146, v146, v145
    v_lshlrev_b32 v147, 7, v144
    s_lshl_b32 s27, s30, 12
    v_add_u32 v147, s27, v147
    v_xor_b32 v148, 0, v146
    v_lshl_add_u32 v12, v148, 4, v147
    v_xor_b32 v148, 2, v146
    v_lshl_add_u32 v13, v148, 4, v147
    v_xor_b32 v148, 4, v146
    v_lshl_add_u32 v14, v148, 4, v147
    v_xor_b32 v148, 6, v146
    v_lshl_add_u32 v15, v148, 4, v147
    v_and_b32 v144, 31, v0
    v_lshrrev_b32 v145, 5, v0
    v_lshrrev_b32 v146, 1, v144
    v_and_b32 v146, 7, v146
    v_xor_b32 v146, v146, v145
    v_lshlrev_b32 v147, 7, v144
    v_add_u32 v147, 16384, v147
    v_xor_b32 v148, 0, v146
    v_lshl_add_u32 v16, v148, 4, v147
    v_xor_b32 v148, 2, v146
    v_lshl_add_u32 v17, v148, 4, v147
    v_xor_b32 v148, 4, v146
    v_lshl_add_u32 v18, v148, 4, v147
    v_xor_b32 v148, 6, v146
    v_lshl_add_u32 v19, v148, 4, v147
    v_mov_b32 v96, 0
    v_mov_b32 v97, 0
    v_mov_b32 v98, 0
    v_mov_b32 v99, 0
    v_mov_b32 v100, 0
    v_mov_b32 v101, 0
    v_mov_b32 v102, 0
    v_mov_b32 v103, 0
    v_mov_b32 v104, 0
    v_mov_b32 v105, 0
    v_mov_b32 v106, 0
    v_mov_b32 v107, 0
    v_mov_b32 v108, 0
    v_mov_b32 v109, 0
    v_mov_b32 v110, 0
    v_mov_b32 v111, 0
    v_mov_b32 v112, 0
    v_mov_b32 v113, 0
    v_mov_b32 v114, 0
    v_mov_b32 v115, 0
    v_mov_b32 v116, 0
    v_mov_b32 v117, 0
    v_mov_b32 v118, 0
    v_mov_b32 v119, 0
    v_mov_b32 v120, 0
    v_mov_b32 v121, 0
    v_mov_b32 v122, 0
    v_mov_b32 v123, 0
    v_mov_b32 v124, 0
    v_mov_b32 v125, 0
    v_mov_b32 v126, 0
    v_mov_b32 v127, 0
    v_mov_b32 v128, 0
    v_mov_b32 v129, 0
    v_mov_b32 v130, 0
    v_mov_b32 v131, 0
    v_mov_b32 v132, 0
    v_mov_b32 v133, 0
    v_mov_b32 v134, 0
    v_mov_b32 v135, 0
    v_mov_b32 v136, 0
    v_mov_b32 v137, 0
    v_mov_b32 v138, 0
    v_mov_b32 v139, 0
    v_mov_b32 v140, 0
    v_mov_b32 v141, 0
    v_mov_b32 v142, 0
    v_mov_b32 v143, 0
    s_mov_b32 s21, 0
    s_mov_b32 s20, 0
    v_add_u32 v20, s21, v12
    v_add_u32 v21, s21, v13
    v_add_u32 v22, s21, v14
    v_add_u32 v23, s21, v15
    v_add_u32 v24, s21, v16
    v_add_u32 v25, s21, v17
    v_add_u32 v26, s21, v18
    v_add_u32 v27, s21, v19
    s_barrier
    ds_read_b128 v[32:35], v20
    ds_read_b128 v[36:39], v24 offset:0
    ds_read_b128 v[40:43], v24 offset:4096
    ds_read_b128 v[44:47], v24 offset:8192
    ds_read_b128 v[48:51], v21
    ds_read_b128 v[52:55], v25 offset:0
    ds_read_b128 v[56:59], v25 offset:4096
    ds_read_b128 v[60:63], v25 offset:8192
K1a_loop:
    s_barrier
    s_waitcnt lgkmcnt(4)
    v_mfma_f32_32x32x16_bf16 v[96:111], v[36:39], v[32:35], v[96:111]
    ds_read_b128 v[64:67], v22
    ds_read_b128 v[68:71], v26 offset:0
    v_mfma_f32_32x32x16_bf16 v[112:127], v[40:43], v[32:35], v[112:127]
    ds_read_b128 v[72:75], v26 offset:4096
    ds_read_b128 v[76:79], v26 offset:8192
    v_mfma_f32_32x32x16_bf16 v[128:143], v[44:47], v[32:35], v[128:143]
    s_waitcnt lgkmcnt(4)
    v_mfma_f32_32x32x16_bf16 v[96:111], v[52:55], v[48:51], v[96:111]
    ds_read_b128 v[80:83], v23
    ds_read_b128 v[84:87], v27 offset:0
    v_mfma_f32_32x32x16_bf16 v[112:127], v[56:59], v[48:51], v[112:127]
    ds_read_b128 v[88:91], v27 offset:4096
    ds_read_b128 v[92:95], v27 offset:8192
    v_mfma_f32_32x32x16_bf16 v[128:143], v[60:63], v[48:51], v[128:143]
    s_add_u32 s21, s21, 28672
    s_cmp_ge_u32 s21, 143360
    s_cselect_b32 s21, 0, s21
    v_add_u32 v20, s21, v12
    v_add_u32 v21, s21, v13
    v_add_u32 v22, s21, v14
    v_add_u32 v23, s21, v15
    v_add_u32 v24, s21, v16
    v_add_u32 v25, s21, v17
    v_add_u32 v26, s21, v18
    v_add_u32 v27, s21, v19
    s_waitcnt lgkmcnt(4)
    v_mfma_f32_32x32x16_bf16 v[96:111], v[68:71], v[64:67], v[96:111]
    ds_read_b128 v[32:35], v20
    ds_read_b128 v[36:39], v24 offset:0
    v_mfma_f32_32x32x16_bf16 v[112:127], v[72:75], v[64:67], v[112:127]
    ds_read_b128 v[40:43], v24 offset:4096
    ds_read_b128 v[44:47], v24 offset:8192
    v_mfma_f32_32x32x16_bf16 v[128:143], v[76:79], v[64:67], v[128:143]
    s_waitcnt lgkmcnt(4)
    v_mfma_f32_32x32x16_bf16 v[96:111], v[84:87], v[80:83], v[96:111]
    ds_read_b128 v[48:51], v21
    ds_read_b128 v[52:55], v25 offset:0
    v_mfma_f32_32x32x16_bf16 v[112:127], v[88:91], v[80:83], v[112:127]
    ds_read_b128 v[56:59], v25 offset:4096
    ds_read_b128 v[60:63], v25 offset:8192
    v_mfma_f32_32x32x16_bf16 v[128:143], v[92:95], v[80:83], v[128:143]
    s_add_u32 s20, s20, 1
    s_cmp_lt_u32 s20, 9
    s_cbranch_scc1 K1a_loop
    s_waitcnt lgkmcnt(0)
    s_nop 7
    s_nop 7
    s_waitcnt vmcnt(0)
    v_and_b32 v144, 31, v0
    s_lshl_b32 s27, s30, 5
    v_add_u32 v144, s27, v144
    v_lshlrev_b32 v144, 2, v144
    v_lshrrev_b32 v145, 5, v0
    v_mul_u32_u24 v145, 1152, v145
    v_add_u32 v144, v144, v145
    v_cvt_pk_bf16_f32 v146, v96, v97
    s_barrier
    ds_write_b32 v144, v146 offset:0
    v_cvt_pk_bf16_f32 v147, v98, v99
    ds_write_b32 v144, v147 offset:576
    v_cvt_pk_bf16_f32 v148, v100, v101
    ds_write_b32 v144, v148 offset:2304
    v_cvt_pk_bf16_f32 v149, v102, v103
    ds_write_b32 v144, v149 offset:2880
    v_cvt_pk_bf16_f32 v150, v104, v105
    ds_write_b32 v144, v150 offset:4608
    v_cvt_pk_bf16_f32 v151, v106, v107
    ds_write_b32 v144, v151 offset:5184
    v_cvt_pk_bf16_f32 v152, v108, v109
    ds_write_b32 v144, v152 offset:6912
    v_cvt_pk_bf16_f32 v153, v110, v111
    ds_write_b32 v144, v153 offset:7488
    v_cvt_pk_bf16_f32 v146, v112, v113
    ds_write_b32 v144, v146 offset:9216
    v_cvt_pk_bf16_f32 v147, v114, v115
    ds_write_b32 v144, v147 offset:9792
    v_cvt_pk_bf16_f32 v148, v116, v117
    ds_write_b32 v144, v148 offset:11520
    v_cvt_pk_bf16_f32 v149, v118, v119
    ds_write_b32 v144, v149 offset:12096
    v_cvt_pk_bf16_f32 v150, v120, v121
    ds_write_b32 v144, v150 offset:13824
    v_cvt_pk_bf16_f32 v151, v122, v123
    ds_write_b32 v144, v151 offset:14400
    v_cvt_pk_bf16_f32 v152, v124, v125
    ds_write_b32 v144, v152 offset:16128
    v_cvt_pk_bf16_f32 v153, v126, v127
    ds_write_b32 v144, v153 offset:16704
    v_cvt_pk_bf16_f32 v146, v128, v129
    ds_write_b32 v144, v146 offset:18432
    v_cvt_pk_bf16_f32 v147, v130, v131
    ds_write_b32 v144, v147 offset:19008
    v_cvt_pk_bf16_f32 v148, v132, v133
    ds_write_b32 v144, v148 offset:20736
    v_cvt_pk_bf16_f32 v149, v134, v135
    ds_write_b32 v144, v149 offset:21312
    v_cvt_pk_bf16_f32 v150, v136, v137
    ds_write_b32 v144, v150 offset:23040
    v_cvt_pk_bf16_f32 v151, v138, v139
    ds_write_b32 v144, v151 offset:23616
    v_cvt_pk_bf16_f32 v152, v140, v141
    ds_write_b32 v144, v152 offset:25344
    v_cvt_pk_bf16_f32 v153, v142, v143
    ds_write_b32 v144, v153 offset:25920
    s_waitcnt lgkmcnt(0)
    s_barrier
    s_branch K1a_st
K1a_ld:
    v_lshrrev_b32 v144, 3, v0
    v_and_b32 v145, 7, v0
    v_add_u32 v146, 0, v144
    v_lshrrev_b32 v147, 1, v146
    v_and_b32 v147, 7, v147
    v_xor_b32 v147, v147, v145
    s_lshl_b32 s27, s30, 5
    s_add_u32 s27, s27, s31
    v_add_u32 v146, s27, v146
    s_movk_i32 s28, 1152
    v_mul_lo_u32 v146, v146, s28
    v_lshl_add_u32 v2, v147, 4, v146
    v_add_u32 v146, 8, v144
    v_lshrrev_b32 v147, 1, v146
    v_and_b32 v147, 7, v147
    v_xor_b32 v147, v147, v145
    s_lshl_b32 s27, s30, 5
    s_add_u32 s27, s27, s31
    v_add_u32 v146, s27, v146
    s_movk_i32 s28, 1152
    v_mul_lo_u32 v146, v146, s28
    v_lshl_add_u32 v3, v147, 4, v146
    v_add_u32 v146, 16, v144
    v_lshrrev_b32 v147, 1, v146
    v_and_b32 v147, 7, v147
    v_xor_b32 v147, v147, v145
    s_lshl_b32 s27, s30, 5
    s_add_u32 s27, s27, s31
    v_add_u32 v146, s27, v146
    s_movk_i32 s28, 1152
    v_mul_lo_u32 v146, v146, s28
    v_lshl_add_u32 v4, v147, 4, v146
    v_add_u32 v146, 24, v144
    v_lshrrev_b32 v147, 1, v146
    v_and_b32 v147, 7, v147
    v_xor_b32 v147, v147, v145
    s_lshl_b32 s27, s30, 5
    s_add_u32 s27, s27, s31
    v_add_u32 v146, s27, v146
    s_movk_i32 s28, 1152
    v_mul_lo_u32 v146, v146, s28
    v_lshl_add_u32 v5, v147, 4, v146
    v_lshrrev_b32 v144, 3, v0
    v_and_b32 v145, 7, v0
    s_lshl_b32 s27, s30, 3
    v_add_u32 v146, s27, v144
    v_lshrrev_b32 v147, 1, v146
    v_and_b32 v147, 7, v147
    v_xor_b32 v147, v147, v145
    v_add_u32 v146, s32, v146
    s_movk_i32 s28, 1152
    v_mul_lo_u32 v146, v146, s28
    v_lshl_add_u32 v6, v147, 4, v146
    v_add_u32 v7, 36864, v6
    v_add_u32 v8, 73728, v6
    s_mov_b32 s22, 0
    s_mov_b32 s23, 0
    s_mov_b32 s24, 0
    s_mov_b32 s20, 0
K1a_pro:
    s_lshl_b32 s27, s30, 12
    s_add_u32 s27, s27, s22
    s_add_u32 m0, s27, 0
    s_nop 0
    buffer_load_dwordx4 v2, s[8:11], s23 offen lds
    s_add_u32 m0, s27, 1024
    s_nop 0
    buffer_load_dwordx4 v3, s[8:11], s23 offen lds
    s_add_u32 m0, s27, 2048
    s_nop 0
    buffer_load_dwordx4 v4, s[8:11], s23 offen lds
    s_add_u32 m0, s27, 3072
    s_nop 0
    buffer_load_dwordx4 v5, s[8:11], s23 offen lds
    s_lshl_b32 s27, s30, 10
    s_add_u32 s27, s27, s22
    s_add_u32 m0, s27, 16384
    s_nop 0
    buffer_load_dwordx4 v6, s[12:15], s24 offen lds
    s_add_u32 m0, s27, 20480
    s_nop 0
    buffer_load_dwordx4 v7, s[12:15], s24 offen lds
    s_add_u32 m0, s27, 24576
    s_nop 0
    buffer_load_dwordx4 v8, s[12:15], s24 offen lds
    s_add_u32 s22, s22, 28672
    s_add_u32 s23, s23, 128
    s_add_u32 s24, s24, 128
    s_add_u32 s20, s20, 1
    s_cmp_lt_u32 s20, 4
    s_cbranch_scc1 K1a_pro
    s_mov_b32 s20, 0
    s_waitcnt vmcnt(21)
    s_barrier
K1a_lloop:
    s_waitcnt vmcnt(14)
    s_barrier
    s_lshl_b32 s27, s30, 12
    s_add_u32 s27, s27, s22
    s_add_u32 m0, s27, 0
    s_nop 0
    buffer_load_dwordx4 v2, s[8:11], s23 offen lds
    s_add_u32 m0, s27, 1024
    s_nop 0
    buffer_load_dwordx4 v3, s[8:11], s23 offen lds
    s_add_u32 m0, s27, 2048
    s_nop 0
    buffer_load_dwordx4 v4, s[8:11], s23 offen lds
    s_add_u32 m0, s27, 3072
    s_nop 0
    buffer_load_dwordx4 v5, s[8:11], s23 offen lds
    s_lshl_b32 s27, s30, 10
    s_add_u32 s27, s27, s22
    s_add_u32 m0, s27, 16384
    s_nop 0
    buffer_load_dwordx4 v6, s[12:15], s24 offen lds
    s_add_u32 m0, s27, 20480
    s_nop 0
    buffer_load_dwordx4 v7, s[12:15], s24 offen lds
    s_add_u32 m0, s27, 24576
    s_nop 0
    buffer_load_dwordx4 v8, s[12:15], s24 offen lds
    s_add_u32 s22, s22, 28672
    s_cmp_ge_u32 s22, 143360
    s_cselect_b32 s22, 0, s22
    s_add_u32 s23, s23, 128
    s_add_u32 s24, s24, 128
    s_add_u32 s20, s20, 1
    s_cmp_lt_u32 s20, 5
    s_cbranch_scc1 K1a_lloop
    s_waitcnt vmcnt(14)
    s_barrier
    s_waitcnt vmcnt(7)
    s_barrier
    s_waitcnt vmcnt(0)
    s_barrier
    s_barrier
    s_lshl_b32 s27, s35, 6
    v_add_u32 v144, s27, v0
    v_add_u32 v147, 0, v144
    v_lshrrev_b32 v145, 5, v147
    v_and_b32 v146, 31, v147
    v_lshlrev_b32 v146, 4, v146
    v_mul_u32_u24 v148, 576, v145
    v_add_u32 v148, v148, v146
    v_mul_u32_u24 v152, 8192, v145
    v_add_u32 v152, v152, v146
    v_add_u32 v147, 512, v144
    v_lshrrev_b32 v145, 5, v147
    v_and_b32 v146, 31, v147
    v_lshlrev_b32 v146, 4, v146
    v_mul_u32_u24 v149, 576, v145
    v_add_u32 v149, v149, v146
    v_mul_u32_u24 v153, 8192, v145
    v_add_u32 v153, v153, v146
    v_add_u32 v147, 1024, v144
    v_lshrrev_b32 v145, 5, v147
    v_and_b32 v146, 31, v147
    v_lshlrev_b32 v146, 4, v146
    v_mul_u32_u24 v150, 576, v145
    v_add_u32 v150, v150, v146
    v_mul_u32_u24 v154, 8192, v145
    v_add_u32 v154, v154, v146
    s_barrier
    s_barrier
    s_branch K1a_st2
K1a_st:
    s_lshl_b32 s27, s35, 6
    v_add_u32 v144, s27, v0
    v_add_u32 v147, 0, v144
    v_lshrrev_b32 v145, 5, v147
    v_and_b32 v146, 31, v147
    v_lshlrev_b32 v146, 4, v146
    v_mul_u32_u24 v148, 576, v145
    v_add_u32 v148, v148, v146
    v_mul_u32_u24 v152, 8192, v145
    v_add_u32 v152, v152, v146
    v_add_u32 v147, 512, v144
    v_lshrrev_b32 v145, 5, v147
    v_and_b32 v146, 31, v147
    v_lshlrev_b32 v146, 4, v146
    v_mul_u32_u24 v149, 576, v145
    v_add_u32 v149, v149, v146
    v_mul_u32_u24 v153, 8192, v145
    v_add_u32 v153, v153, v146
    v_add_u32 v147, 1024, v144
    v_lshrrev_b32 v145, 5, v147
    v_and_b32 v146, 31, v147
    v_lshlrev_b32 v146, 4, v146
    v_mul_u32_u24 v150, 576, v145
    v_add_u32 v150, v150, v146
    v_mul_u32_u24 v154, 8192, v145
    v_add_u32 v154, v154, v146
K1a_st2:
    ds_read_b128 v[32:35], v148
    ds_read_b128 v[36:39], v149
    ds_read_b128 v[40:43], v150
    s_waitcnt lgkmcnt(2)
    buffer_store_dwordx4 v[32:35], v152, s[16:19], s33 offen
    s_waitcnt lgkmcnt(1)
    buffer_store_dwordx4 v[36:39], v153, s[16:19], s33 offen
    s_waitcnt lgkmcnt(0)
    buffer_store_dwordx4 v[40:43], v154, s[16:19], s33 offen
    s_endpgm
K1_kv:
    s_sub_u32 s3, s2, 192
    s_lshr_b32 s27, s3, 3
    s_and_b32 s3, s3, 7
    s_lshl_b32 s3, s3, 1
    s_add_u32 s3, s3, s27
    s_lshl_b32 s31, s3, 7
    s_waitcnt lgkmcnt(0)
    s_mov_b32 s8, s42
    s_mov_b32 s9, s43
    s_mov_b32 s10, 2359296
    s_mov_b32 s11, 0x00020000
    s_cmp_lt_u32 s30, 2
    s_cselect_b32 s52, s46, s48
    s_cselect_b32 s53, s47, s49
    s_mov_b32 s12, s52
    s_mov_b32 s13, s53
    s_mov_b32 s14, 20736
    s_mov_b32 s15, 0x00020000
    s_add_u32 s16, s50, 2359296
    s_addc_u32 s17, s51, 0
    s_mov_b32 s18, 425984
    s_mov_b32 s19, 0x00020000
    s_cmp_lt_u32 s35, 4
    s_cbranch_scc1 K1kv_cp
    v_lshrrev_b32 v144, 3, v0
    v_and_b32 v145, 7, v0
    v_add_u32 v146, 0, v144
    v_lshrrev_b32 v147, 1, v146
    v_and_b32 v147, 7, v147
    v_xor_b32 v147, v147, v145
    s_lshl_b32 s27, s30, 5
    s_add_u32 s27, s27, s31
    v_add_u32 v146, s27, v146
    s_movk_i32 s28, 1152
    v_mul_lo_u32 v146, v146, s28
    v_lshl_add_u32 v2, v147, 4, v146
    v_add_u32 v146, 8, v144
    v_lshrrev_b32 v147, 1, v146
    v_and_b32 v147, 7, v147
    v_xor_b32 v147, v147, v145
    s_lshl_b32 s27, s30, 5
    s_add_u32 s27, s27, s31
    v_add_u32 v146, s27, v146
    s_movk_i32 s28, 1152
    v_mul_lo_u32 v146, v146, s28
    v_lshl_add_u32 v3, v147, 4, v146
    v_add_u32 v146, 16, v144
    v_lshrrev_b32 v147, 1, v146
    v_and_b32 v147, 7, v147
    v_xor_b32 v147, v147, v145
    s_lshl_b32 s27, s30, 5
    s_add_u32 s27, s27, s31
    v_add_u32 v146, s27, v146
    s_movk_i32 s28, 1152
    v_mul_lo_u32 v146, v146, s28
    v_lshl_add_u32 v4, v147, 4, v146
    v_add_u32 v146, 24, v144
    v_lshrrev_b32 v147, 1, v146
    v_and_b32 v147, 7, v147
    v_xor_b32 v147, v147, v145
    s_lshl_b32 s27, s30, 5
    s_add_u32 s27, s27, s31
    v_add_u32 v146, s27, v146
    s_movk_i32 s28, 1152
    v_mul_lo_u32 v146, v146, s28
    v_lshl_add_u32 v5, v147, 4, v146
    s_and_b32 s27, s30, 1
    s_mul_i32 s27, s27, 320
    s_movk_i32 s28, 6554
    v_add_u32 v144, s27, v0
    v_add_u32 v144, 0, v144
    v_mul_lo_u32 v145, v144, s28
    v_lshrrev_b32 v145, 16, v145
    v_mul_u32_u24 v146, 10, v145
    v_sub_u32 v146, v144, v146
    v_min_u32 v146, 8, v146
    v_mul_u32_u24 v145, 36, v145
    v_lshl_add_u32 v6, v146, 2, v145
    v_add_u32 v144, s27, v0
    v_add_u32 v144, 64, v144
    v_mul_lo_u32 v145, v144, s28
    v_lshrrev_b32 v145, 16, v145
    v_mul_u32_u24 v146, 10, v145
    v_sub_u32 v146, v144, v146
    v_min_u32 v146, 8, v146
    v_mul_u32_u24 v145, 36, v145
    v_lshl_add_u32 v7, v146, 2, v145
    v_add_u32 v144, s27, v0
    v_add_u32 v144, 128, v144
    v_mul_lo_u32 v145, v144, s28
    v_lshrrev_b32 v145, 16, v145
    v_mul_u32_u24 v146, 10, v145
    v_sub_u32 v146, v144, v146
    v_min_u32 v146, 8, v146
    v_mul_u32_u24 v145, 36, v145
    v_lshl_add_u32 v8, v146, 2, v145
    v_add_u32 v144, s27, v0
    v_add_u32 v144, 192, v144
    v_mul_lo_u32 v145, v144, s28
    v_lshrrev_b32 v145, 16, v145
    v_mul_u32_u24 v146, 10, v145
    v_sub_u32 v146, v144, v146
    v_min_u32 v146, 8, v146
    v_mul_u32_u24 v145, 36, v145
    v_lshl_add_u32 v9, v146, 2, v145
    v_add_u32 v144, s27, v0
    v_add_u32 v144, 256, v144
    v_mul_lo_u32 v145, v144, s28
    v_lshrrev_b32 v145, 16, v145
    v_mul_u32_u24 v146, 10, v145
    v_sub_u32 v146, v144, v146
    v_min_u32 v146, 8, v146
    v_mul_u32_u24 v145, 36, v145
    v_lshl_add_u32 v10, v146, 2, v145
    s_mov_b32 s22, 0
    s_mov_b32 s23, 0
    s_mov_b32 s24, 0
    s_mov_b32 s20, 0
K1kv_pro:
    s_lshl_b32 s27, s30, 12
    s_add_u32 s27, s27, s22
    s_add_u32 m0, s27, 0
    s_nop 0
    buffer_load_dwordx4 v2, s[8:11], s23 offen lds
    s_add_u32 m0, s27, 1024
    s_nop 0
    buffer_load_dwordx4 v3, s[8:11], s23 offen lds
    s_add_u32 m0, s27, 2048
    s_nop 0
    buffer_load_dwordx4 v4, s[8:11], s23 offen lds
    s_add_u32 m0, s27, 3072
    s_nop 0
    buffer_load_dwordx4 v5, s[8:11], s23 offen lds
    s_mul_i32 s27, s30, 1280
    s_add_u32 s27, s27, s22
    s_add_u32 m0, s27, 16384
    s_nop 0
    buffer_load_dword v6, s[12:15], s24 offen lds
    s_add_u32 m0, s27, 16640
    s_nop 0
    buffer_load_dword v7, s[12:15], s24 offen lds
    s_add_u32 m0, s27, 16896
    s_nop 0
    buffer_load_dword v8, s[12:15], s24 offen lds
    s_add_u32 m0, s27, 17152
    s_nop 0
    buffer_load_dword v9, s[12:15], s24 offen lds
    s_add_u32 m0, s27, 17408
    s_nop 0
    buffer_load_dword v10, s[12:15], s24 offen lds
    s_add_u32 s22, s22, 28672
    s_add_u32 s23, s23, 128
    s_add_u32 s24, s24, 2304
    s_add_u32 s20, s20, 1
    s_cmp_lt_u32 s20, 4
    s_cbranch_scc1 K1kv_pro
    s_mov_b32 s20, 0
    s_waitcnt vmcnt(27)
    s_barrier
K1kv_lloop:
    s_waitcnt vmcnt(18)
    s_barrier
    s_lshl_b32 s27, s30, 12
    s_add_u32 s27, s27, s22
    s_add_u32 m0, s27, 0
    s_nop 0
    buffer_load_dwordx4 v2, s[8:11], s23 offen lds
    s_add_u32 m0, s27, 1024
    s_nop 0
    buffer_load_dwordx4 v3, s[8:11], s23 offen lds
    s_add_u32 m0, s27, 2048
    s_nop 0
    buffer_load_dwordx4 v4, s[8:11], s23 offen lds
    s_add_u32 m0, s27, 3072
    s_nop 0
    buffer_load_dwordx4 v5, s[8:11], s23 offen lds
    s_mul_i32 s27, s30, 1280
    s_add_u32 s27, s27, s22
    s_add_u32 m0, s27, 16384
    s_nop 0
    buffer_load_dword v6, s[12:15], s24 offen lds
    s_add_u32 m0, s27, 16640
    s_nop 0
    buffer_load_dword v7, s[12:15], s24 offen lds
    s_add_u32 m0, s27, 16896
    s_nop 0
    buffer_load_dword v8, s[12:15], s24 offen lds
    s_add_u32 m0, s27, 17152
    s_nop 0
    buffer_load_dword v9, s[12:15], s24 offen lds
    s_add_u32 m0, s27, 17408
    s_nop 0
    buffer_load_dword v10, s[12:15], s24 offen lds
    s_add_u32 s22, s22, 28672
    s_cmp_ge_u32 s22, 143360
    s_cselect_b32 s22, 0, s22
    s_add_u32 s23, s23, 128
    s_add_u32 s24, s24, 2304
    s_add_u32 s20, s20, 1
    s_cmp_lt_u32 s20, 5
    s_cbranch_scc1 K1kv_lloop
    s_waitcnt vmcnt(18)
    s_barrier
    s_waitcnt vmcnt(9)
    s_barrier
    s_waitcnt vmcnt(0)
    s_barrier
    s_barrier
    s_endpgm
K1kv_cp:
    v_and_b32 v144, 31, v0
    v_lshrrev_b32 v145, 5, v0
    v_lshrrev_b32 v146, 1, v144
    v_and_b32 v146, 7, v146
    v_xor_b32 v146, v146, v145
    v_lshlrev_b32 v147, 7, v144
    s_lshl_b32 s27, s30, 12
    v_add_u32 v147, s27, v147
    v_xor_b32 v148, 0, v146
    v_lshl_add_u32 v12, v148, 4, v147
    v_xor_b32 v148, 2, v146
    v_lshl_add_u32 v13, v148, 4, v147
    v_xor_b32 v148, 4, v146
    v_lshl_add_u32 v14, v148, 4, v147
    v_xor_b32 v148, 6, v146
    v_lshl_add_u32 v15, v148, 4, v147
    v_lshrrev_b32 v144, 5, v0
    v_lshlrev_b32 v144, 3, v144
    v_bfe_u32 v145, v0, 2, 2
    v_add_u32 v144, v144, v145
    v_mul_u32_u24 v144, 40, v144
    v_bfe_u32 v145, v0, 4, 1
    v_lshl_add_u32 v144, v145, 5, v144
    v_and_b32 v145, 3, v0
    v_lshl_add_u32 v144, v145, 3, v144
    v_add_u32 v16, 16384, v144
    v_mov_b32 v96, 0
    v_mov_b32 v97, 0
    v_mov_b32 v98, 0
    v_mov_b32 v99, 0
    v_mov_b32 v100, 0
    v_mov_b32 v101, 0
    v_mov_b32 v102, 0
    v_mov_b32 v103, 0
    v_mov_b32 v104, 0
    v_mov_b32 v105, 0
    v_mov_b32 v106, 0
    v_mov_b32 v107, 0
    v_mov_b32 v108, 0
    v_mov_b32 v109, 0
    v_mov_b32 v110, 0
    v_mov_b32 v111, 0
    v_mov_b32 v112, 0
    v_mov_b32 v113, 0
    v_mov_b32 v114, 0
    v_mov_b32 v115, 0
    v_mov_b32 v116, 0
    v_mov_b32 v117, 0
    v_mov_b32 v118, 0
    v_mov_b32 v119, 0
    v_mov_b32 v120, 0
    v_mov_b32 v121, 0
    v_mov_b32 v122, 0
    v_mov_b32 v123, 0
    v_mov_b32 v124, 0
    v_mov_b32 v125, 0
    v_mov_b32 v126, 0
    v_mov_b32 v127, 0
    s_mov_b32 s21, 0
    s_mov_b32 s20, 0
    v_add_u32 v20, s21, v12
    v_add_u32 v21, s21, v13
    v_add_u32 v22, s21, v14
    v_add_u32 v23, s21, v15
    v_add_u32 v24, s21, v16
    s_barrier
    ds_read_b128 v[32:35], v20
    ds_read_b64_tr_b16 v[36:37], v24 offset:0
    ds_read_b64_tr_b16 v[38:39], v24 offset:160
    ds_read_b64_tr_b16 v[40:41], v24 offset:2560
    ds_read_b64_tr_b16 v[42:43], v24 offset:2720
    ds_read_b128 v[48:51], v21
    ds_read_b64_tr_b16 v[52:53], v24 offset:640
    ds_read_b64_tr_b16 v[54:55], v24 offset:800
    ds_read_b64_tr_b16 v[56:57], v24 offset:3200
    ds_read_b64_tr_b16 v[58:59], v24 offset:3360
K1kv_loop:
    s_barrier
    s_waitcnt lgkmcnt(5)
    v_mfma_f32_32x32x16_bf16 v[96:111], v[36:39], v[32:35], v[96:111]
    ds_read_b128 v[64:67], v22
    ds_read_b64_tr_b16 v[68:69], v24 offset:1280
    ds_read_b64_tr_b16 v[70:71], v24 offset:1440
    v_mfma_f32_32x32x16_bf16 v[112:127], v[32:35], v[40:43], v[112:127]
    ds_read_b64_tr_b16 v[72:73], v24 offset:3840
    ds_read_b64_tr_b16 v[74:75], v24 offset:4000
    s_waitcnt lgkmcnt(5)
    v_mfma_f32_32x32x16_bf16 v[96:111], v[52:55], v[48:51], v[96:111]
    ds_read_b128 v[80:83], v23
    ds_read_b64_tr_b16 v[84:85], v24 offset:1920
    ds_read_b64_tr_b16 v[86:87], v24 offset:2080
    v_mfma_f32_32x32x16_bf16 v[112:127], v[48:51], v[56:59], v[112:127]
    ds_read_b64_tr_b16 v[88:89], v24 offset:4480
    ds_read_b64_tr_b16 v[90:91], v24 offset:4640
    s_add_u32 s21, s21, 28672
    s_cmp_ge_u32 s21, 143360
    s_cselect_b32 s21, 0, s21
    v_add_u32 v20, s21, v12
    v_add_u32 v21, s21, v13
    v_add_u32 v22, s21, v14
    v_add_u32 v23, s21, v15
    v_add_u32 v24, s21, v16
    s_waitcnt lgkmcnt(5)
    v_mfma_f32_32x32x16_bf16 v[96:111], v[68:71], v[64:67], v[96:111]
    ds_read_b128 v[32:35], v20
    ds_read_b64_tr_b16 v[36:37], v24 offset:0
    ds_read_b64_tr_b16 v[38:39], v24 offset:160
    v_mfma_f32_32x32x16_bf16 v[112:127], v[64:67], v[72:75], v[112:127]
    ds_read_b64_tr_b16 v[40:41], v24 offset:2560
    ds_read_b64_tr_b16 v[42:43], v24 offset:2720
    s_waitcnt lgkmcnt(5)
    v_mfma_f32_32x32x16_bf16 v[96:111], v[84:87], v[80:83], v[96:111]
    ds_read_b128 v[48:51], v21
    ds_read_b64_tr_b16 v[52:53], v24 offset:640
    ds_read_b64_tr_b16 v[54:55], v24 offset:800
    v_mfma_f32_32x32x16_bf16 v[112:127], v[80:83], v[88:91], v[112:127]
    ds_read_b64_tr_b16 v[56:57], v24 offset:3200
    ds_read_b64_tr_b16 v[58:59], v24 offset:3360
    s_add_u32 s20, s20, 1
    s_cmp_lt_u32 s20, 9
    s_cbranch_scc1 K1kv_loop
    s_waitcnt lgkmcnt(0)
    s_nop 7
    s_nop 7
    s_lshl_b32 s33, s3, 2
    s_add_u32 s33, s33, s30
    s_mul_i32 s34, s33, 2560
    v_cvt_pk_bf16_f32 v144, v96, v97
    v_cvt_pk_bf16_f32 v145, v98, v99
    v_cvt_pk_bf16_f32 v146, v100, v101
    v_cvt_pk_bf16_f32 v147, v102, v103
    v_lshlrev_b32 v152, 4, v0
    buffer_store_dwordx4 v[144:147], v152, s[16:19], s34 offen
    v_cvt_pk_bf16_f32 v148, v104, v105
    v_mov_b32 v149, 0x3f80
    v_lshlrev_b32 v153, 3, v0
    v_mul_f32 v150, v96, v96
    v_fmac_f32 v150, v97, v97
    v_fmac_f32 v150, v98, v98
    v_fmac_f32 v150, v99, v99
    v_fmac_f32 v150, v100, v100
    v_fmac_f32 v150, v101, v101
    v_fmac_f32 v150, v102, v102
    v_fmac_f32 v150, v103, v103
    v_mul_f32 v151, v104, v104
    v_fmac_f32 v151, v105, v105
    v_cmp_gt_u32 vcc, 32, v0
    s_nop 1
    v_cndmask_b32 v151, 0, v151, vcc
    v_add_f32 v150, v150, v151
    s_and_saveexec_b64 s[54:55], vcc
    buffer_store_dwordx2 v[148:149], v153, s[16:19], s34 offen offset:1024
    s_mov_b64 exec, s[54:55]
    v_mov_b32 v151, v150
    s_nop 1
    v_permlane32_swap_b32 v150, v151
    v_add_f32 v150, v150, v151
    ds_swizzle_b32 v151, v150 offset:1055
    s_waitcnt lgkmcnt(0)
    v_max_f32 v150, v150, v151
    ds_swizzle_b32 v151, v150 offset:2079
    s_waitcnt lgkmcnt(0)
    v_max_f32 v150, v150, v151
    ds_swizzle_b32 v151, v150 offset:4127
    s_waitcnt lgkmcnt(0)
    v_max_f32 v150, v150, v151
    ds_swizzle_b32 v151, v150 offset:8223
    s_waitcnt lgkmcnt(0)
    v_max_f32 v150, v150, v151
    ds_swizzle_b32 v151, v150 offset:16415
    s_waitcnt lgkmcnt(0)
    v_max_f32 v150, v150, v151
    s_lshl_b32 s35, s33, 2
    s_add_u32 s35, s35, 196608
    v_mov_b32 v154, 0
    v_cmp_eq_u32 vcc, 0, v0
    s_and_saveexec_b64 s[54:55], vcc
    buffer_store_dword v150, v154, s[16:19], s35 offen
    s_mov_b64 exec, s[54:55]
    v_and_b32 v152, 31, v0
    v_lshrrev_b32 v153, 5, v0
    v_mul_u32_u24 v153, 20, v153
    v_add_u32 v153, v153, v152
    v_lshlrev_b32 v153, 4, v153
    v_cmp_eq_u32 s[56:57], 18, v152
    v_cmp_eq_u32 s[58:59], 19, v152
    v_cmp_ge_u32 vcc, 19, v152
    v_mov_b32 v154, 0x3f803f80
    v_cvt_pk_bf16_f32 v144, v112, v113
    v_cndmask_b32 v144, v144, v154, s[56:57]
    v_cndmask_b32 v144, v144, 0, s[58:59]
    v_cvt_pk_bf16_f32 v145, v114, v115
    v_cndmask_b32 v145, v145, v154, s[56:57]
    v_cndmask_b32 v145, v145, 0, s[58:59]
    v_cvt_pk_bf16_f32 v146, v116, v117
    v_cndmask_b32 v146, v146, v154, s[56:57]
    v_cndmask_b32 v146, v146, 0, s[58:59]
    v_cvt_pk_bf16_f32 v147, v118, v119
    v_cndmask_b32 v147, v147, v154, s[56:57]
    v_cndmask_b32 v147, v147, 0, s[58:59]
    v_cvt_pk_bf16_f32 v148, v120, v121
    v_cndmask_b32 v148, v148, v154, s[56:57]
    v_cndmask_b32 v148, v148, 0, s[58:59]
    v_cvt_pk_bf16_f32 v149, v122, v123
    v_cndmask_b32 v149, v149, v154, s[56:57]
    v_cndmask_b32 v149, v149, 0, s[58:59]
    v_cvt_pk_bf16_f32 v150, v124, v125
    v_cndmask_b32 v150, v150, v154, s[56:57]
    v_cndmask_b32 v150, v150, 0, s[58:59]
    v_cvt_pk_bf16_f32 v151, v126, v127
    v_cndmask_b32 v151, v151, v154, s[56:57]
    v_cndmask_b32 v151, v151, 0, s[58:59]
    s_and_saveexec_b64 s[54:55], vcc
    buffer_store_dwordx4 v[144:147], v153, s[16:19], s34 offen offset:1280
    buffer_store_dwordx4 v[148:151], v153, s[16:19], s34 offen offset:1920
    s_mov_b64 exec, s[54:55]
    s_endpgm
K1_wt:
    s_sub_u32 s3, s2, 208
    s_waitcnt lgkmcnt(0)
    s_mov_b32 s8, s38
    s_mov_b32 s9, s39
    s_mov_b32 s10, 1183744
    s_mov_b32 s11, 0x00020000
    s_mov_b32 s12, s40
    s_mov_b32 s13, s41
    s_mov_b32 s14, 1183744
    s_mov_b32 s15, 0x00020000
    s_add_u32 s16, s50, 4980736
    s_addc_u32 s17, s51, 0
    s_mov_b32 s18, 2367488
    s_mov_b32 s19, 0x00020000
    v_lshlrev_b32 v2, 4, v0
    s_mov_b32 s26, s10
    s_mov_b32 s27, s11
    s_mul_i32 s22, s3, 3
    s_add_u32 s22, s22, 0
    s_mul_i32 s22, s22, 9248
    s_add_u32 s20, s35, 0
    s_cmp_lt_u32 s20, 10
    s_cselect_b32 s24, s8, s12
    s_cselect_b32 s25, s9, s13
    s_cselect_b32 s21, 0, 10
    s_sub_u32 s21, s20, s21
    s_lshl_b32 s21, s21, 10
    s_add_u32 s33, s22, s21
    s_lshl_b32 s20, s20, 10
    s_add_u32 m0, s20, 0
    s_nop 0
    buffer_load_dwordx4 v2, s[24:27], s33 offen lds
    s_add_u32 s20, s35, 8
    s_cmp_lt_u32 s20, 10
    s_cselect_b32 s24, s8, s12
    s_cselect_b32 s25, s9, s13
    s_cselect_b32 s21, 0, 10
    s_sub_u32 s21, s20, s21
    s_lshl_b32 s21, s21, 10
    s_add_u32 s33, s22, s21
    s_lshl_b32 s20, s20, 10
    s_add_u32 m0, s20, 0
    s_nop 0
    buffer_load_dwordx4 v2, s[24:27], s33 offen lds
    s_cmp_ge_u32 s35, 4
    s_cbranch_scc1 K1_wt_sk0
    s_add_u32 s20, s35, 16
    s_cmp_lt_u32 s20, 10
    s_cselect_b32 s24, s8, s12
    s_cselect_b32 s25, s9, s13
    s_cselect_b32 s21, 0, 10
    s_sub_u32 s21, s20, s21
    s_lshl_b32 s21, s21, 10
    s_add_u32 s33, s22, s21
    s_lshl_b32 s20, s20, 10
    s_add_u32 m0, s20, 0
    s_nop 0
    buffer_load_dwordx4 v2, s[24:27], s33 offen lds
K1_wt_sk0:
    s_mul_i32 s22, s3, 3
    s_add_u32 s22, s22, 1
    s_mul_i32 s22, s22, 9248
    s_add_u32 s20, s35, 0
    s_cmp_lt_u32 s20, 10
    s_cselect_b32 s24, s8, s12
    s_cselect_b32 s25, s9, s13
    s_cselect_b32 s21, 0, 10
    s_sub_u32 s21, s20, s21
    s_lshl_b32 s21, s21, 10
    s_add_u32 s33, s22, s21
    s_lshl_b32 s20, s20, 10
    s_add_u32 m0, s20, 20480
    s_nop 0
    buffer_load_dwordx4 v2, s[24:27], s33 offen lds
    s_add_u32 s20, s35, 8
    s_cmp_lt_u32 s20, 10
    s_cselect_b32 s24, s8, s12
    s_cselect_b32 s25, s9, s13
    s_cselect_b32 s21, 0, 10
    s_sub_u32 s21, s20, s21
    s_lshl_b32 s21, s21, 10
    s_add_u32 s33, s22, s21
    s_lshl_b32 s20, s20, 10
    s_add_u32 m0, s20, 20480
    s_nop 0
    buffer_load_dwordx4 v2, s[24:27], s33 offen lds
    s_cmp_ge_u32 s35, 4
    s_cbranch_scc1 K1_wt_sk1
    s_add_u32 s20, s35, 16
    s_cmp_lt_u32 s20, 10
    s_cselect_b32 s24, s8, s12
    s_cselect_b32 s25, s9, s13
    s_cselect_b32 s21, 0, 10
    s_sub_u32 s21, s20, s21
    s_lshl_b32 s21, s21, 10
    s_add_u32 s33, s22, s21
    s_lshl_b32 s20, s20, 10
    s_add_u32 m0, s20, 20480
    s_nop 0
    buffer_load_dwordx4 v2, s[24:27], s33 offen lds
K1_wt_sk1:
    s_mul_i32 s22, s3, 3
    s_add_u32 s22, s22, 2
    s_mul_i32 s22, s22, 9248
    s_add_u32 s20, s35, 0
    s_cmp_lt_u32 s20, 10
    s_cselect_b32 s24, s8, s12
    s_cselect_b32 s25, s9, s13
    s_cselect_b32 s21, 0, 10
    s_sub_u32 s21, s20, s21
    s_lshl_b32 s21, s21, 10
    s_add_u32 s33, s22, s21
    s_lshl_b32 s20, s20, 10
    s_add_u32 m0, s20, 40960
    s_nop 0
    buffer_load_dwordx4 v2, s[24:27], s33 offen lds
    s_add_u32 s20, s35, 8
    s_cmp_lt_u32 s20, 10
    s_cselect_b32 s24, s8, s12
    s_cselect_b32 s25, s9, s13
    s_cselect_b32 s21, 0, 10
    s_sub_u32 s21, s20, s21
    s_lshl_b32 s21, s21, 10
    s_add_u32 s33, s22, s21
    s_lshl_b32 s20, s20, 10
    s_add_u32 m0, s20, 40960
    s_nop 0
    buffer_load_dwordx4 v2, s[24:27], s33 offen lds
    s_cmp_ge_u32 s35, 4
    s_cbranch_scc1 K1_wt_sk2
    s_add_u32 s20, s35, 16
    s_cmp_lt_u32 s20, 10
    s_cselect_b32 s24, s8, s12
    s_cselect_b32 s25, s9, s13
    s_cselect_b32 s21, 0, 10
    s_sub_u32 s21, s20, s21
    s_lshl_b32 s21, s21, 10
    s_add_u32 s33, s22, s21
    s_lshl_b32 s20, s20, 10
    s_add_u32 m0, s20, 40960
    s_nop 0
    buffer_load_dwordx4 v2, s[24:27], s33 offen lds
K1_wt_sk2:
    v_and_b32 v3, 15, v0
    v_lshrrev_b32 v4, 4, v0
    s_lshl_b32 s20, s35, 2
    v_add_u32 v4, s20, v4
    v_mul_u32_u24 v5, 578, v3
    v_lshl_add_u32 v5, v4, 1, v5
    v_lshlrev_b32 v6, 13, v4
    v_lshl_add_u32 v6, v3, 2, v6
    v_mov_b32 v10, 0
    v_mov_b32 v11, 0
    v_mov_b32 v12, 0
    v_mov_b32 v13, 0
    v_mov_b32 v14, 0
    v_mov_b32 v15, 0
    v_mov_b32 v16, 0
    v_mov_b32 v17, 0
    v_mov_b32 v18, 0
    v_mov_b32 v19, 0
    v_mov_b32 v20, 0
    v_mov_b32 v21, 0
    v_mov_b32 v22, 0
    v_mov_b32 v23, 0
    v_mov_b32 v24, 0
    v_mov_b32 v25, 0
    v_mov_b32 v26, 0
    v_mov_b32 v27, 0
    v_mov_b32 v28, 0
    v_mov_b32 v29, 0
    v_add_u32 v30, 2359296, v6
    s_waitcnt vmcnt(0)
    s_barrier
    s_mov_b32 s21, 0
K1_wt_task:
    s_mul_i32 s22, s3, 3
    s_add_u32 s22, s22, s21
    s_cmp_ge_u32 s22, 128
    s_cbranch_scc1 K1_wt_done
    s_lshl_b32 s22, s22, 6
    s_mul_i32 s23, s21, 20480
    v_add_u32 v7, s23, v5
    ds_read_u16 v10, v7 offset:0
    ds_read_u16_d16_hi v11, v7 offset:10240
    ds_read_u16 v12, v7 offset:64
    ds_read_u16_d16_hi v13, v7 offset:10304
    ds_read_u16 v14, v7 offset:128
    ds_read_u16_d16_hi v15, v7 offset:10368
    ds_read_u16 v16, v7 offset:192
    ds_read_u16_d16_hi v17, v7 offset:10432
    ds_read_u16 v18, v7 offset:256
    ds_read_u16_d16_hi v19, v7 offset:10496
    ds_read_u16 v20, v7 offset:320
    ds_read_u16_d16_hi v21, v7 offset:10560
    ds_read_u16 v22, v7 offset:384
    ds_read_u16_d16_hi v23, v7 offset:10624
    ds_read_u16 v24, v7 offset:448
    ds_read_u16_d16_hi v25, v7 offset:10688
    ds_read_u16 v26, v7 offset:512
    ds_read_u16_d16_hi v27, v7 offset:10752
    ds_read_u16 v28, v7 offset:576
    ds_read_u16_d16_hi v29, v7 offset:10816
    s_waitcnt lgkmcnt(15)
    v_or_b32 v32, v10, v11
    s_add_u32 s33, s22, 0
    buffer_store_dword v32, v6, s[16:19], s33 offen
    s_waitcnt lgkmcnt(15)
    v_or_b32 v33, v12, v13
    s_add_u32 s33, s22, 262144
    buffer_store_dword v33, v6, s[16:19], s33 offen
    s_waitcnt lgkmcnt(14)
    v_or_b32 v34, v14, v15
    s_add_u32 s33, s22, 524288
    buffer_store_dword v34, v6, s[16:19], s33 offen
    s_waitcnt lgkmcnt(12)
    v_or_b32 v35, v16, v17
    s_add_u32 s33, s22, 786432
    buffer_store_dword v35, v6, s[16:19], s33 offen
    s_waitcnt lgkmcnt(10)
    v_or_b32 v36, v18, v19
    s_add_u32 s33, s22, 1048576
    buffer_store_dword v36, v6, s[16:19], s33 offen
    s_waitcnt lgkmcnt(8)
    v_or_b32 v37, v20, v21
    s_add_u32 s33, s22, 1310720
    buffer_store_dword v37, v6, s[16:19], s33 offen
    s_waitcnt lgkmcnt(6)
    v_or_b32 v38, v22, v23
    s_add_u32 s33, s22, 1572864
    buffer_store_dword v38, v6, s[16:19], s33 offen
    s_waitcnt lgkmcnt(4)
    v_or_b32 v39, v24, v25
    s_add_u32 s33, s22, 1835008
    buffer_store_dword v39, v6, s[16:19], s33 offen
    s_waitcnt lgkmcnt(2)
    v_or_b32 v40, v26, v27
    s_add_u32 s33, s22, 2097152
    buffer_store_dword v40, v6, s[16:19], s33 offen
    s_waitcnt lgkmcnt(0)
    v_or_b32 v41, v28, v29
    buffer_store_dword v41, v30, s[16:19], s22 offen
    s_add_u32 s21, s21, 1
    s_cmp_lt_u32 s21, 3
    s_cbranch_scc1 K1_wt_task
K1_wt_done:
    s_lshl_b32 s20, s3, 3
    s_add_u32 s20, s20, s35
    s_lshl_b32 s20, s20, 6
    v_add_u32 v2, s20, v0
    v_lshlrev_b32 v2, 7, v2
    s_load_dwordx2 s[36:37], s[0:1], 56
    s_getpc_b64 s[38:39]
K1_pc2:
    s_add_u32 s38, s38, K2_base-K1_pc2
    s_addc_u32 s39, s39, 0
    s_waitcnt lgkmcnt(0)
    s_mov_b32 s8, s36
    s_mov_b32 s9, s37
    s_mov_b32 s10, 663552
    s_mov_b32 s11, 0x00020000
    s_mov_b32 s12, s38
    s_mov_b32 s13, s39
    s_mov_b32 s14, TTAB-K2_base
    s_mov_b32 s15, 0x00020000
    buffer_load_dword v3, v2, s[8:11], 0 offen
    v_subrev_u32 v4, 663552, v2
    buffer_load_dword v5, v4, s[12:15], 0 offen
    s_waitcnt vmcnt(0)
K1_end:
    s_endpgm

.globl k2_kernel
.p2align 8
.type k2_kernel,@function
k2_kernel:
K2_base:
    s_cmp_ge_u32 s2, 256
    s_cbranch_scc1 K2_end
    s_load_dwordx2 s[40:41], s[0:1], 80
    v_lshrrev_b32 v1, 6, v0
    s_nop 0
    v_readfirstlane_b32 s3, v1
    v_and_b32 v0, 63, v0
    s_nop 2
    s_cmp_ge_u32 s3, 8
    s_cbranch_scc1 K2_fft
    s_and_b32 s4, s2, 7
    s_lshl_b32 s4, s4, 3
    s_lshr_b32 s5, s2, 5
    s_add_u32 s4, s4, s5
    s_lshr_b32 s5, s2, 3
    s_and_b32 s5, s5, 3
    s_lshl_b32 s5, s5, 3
    s_add_u32 s5, s5, s3
    s_waitcnt lgkmcnt(0)
    s_mov_b32 s8, s40
    s_mov_b32 s9, s41
    s_mov_b32 s10, 2359296
    s_mov_b32 s11, 0x00020000
    s_add_u32 s12, s40, 2359296
    s_addc_u32 s13, s41, 0
    s_mov_b32 s14, 163840
    s_mov_b32 s15, 0x00020000
    s_add_u32 s16, s40, 12320768
    s_addc_u32 s17, s41, 0
    s_mov_b32 s18, 2359296
    s_mov_b32 s19, 0x00020000
    s_add_u32 s28, s40, 2555904
    s_addc_u32 s29, s41, 0
    s_mov_b32 s30, 256
    s_mov_b32 s31, 0x00020000
    v_lshlrev_b32 v102, 4, v0
    v_lshlrev_b32 v116, 2, v0
    buffer_load_dword v117, v116, s[28:31], 0 offen
    s_mul_i32 s20, s3, 2560
    v_and_b32 v1, 31, v0
    s_lshl_b32 s6, s4, 5
    v_add_u32 v104, s6, v1
    s_movk_i32 s7, 1152
    v_mul_lo_u32 v104, v104, s7
    v_lshrrev_b32 v105, 5, v0
    v_lshl_add_u32 v103, v105, 3, v104
    s_mul_i32 s7, s5, 36
    buffer_load_dwordx2 v[2:3], v103, s[8:11], s7 offen
    buffer_load_dwordx2 v[4:5], v103, s[8:11], s7 offen offset:16
    buffer_load_dword v6, v104, s[8:11], s7 offen offset:32
    s_mov_b32 s22, s20
    s_mov_b32 s23, s20
    s_add_u32 m0, s23, 0
    s_add_u32 s27, s22, 0
    buffer_load_dwordx4 v102, s[12:15], s27 offen lds
    s_add_u32 m0, s23, 1024
    s_add_u32 s27, s22, 1024
    buffer_load_dwordx4 v102, s[12:15], s27 offen lds
    s_mov_b32 exec_hi, 0
    s_add_u32 m0, s23, 2048
    s_add_u32 s27, s22, 2048
    buffer_load_dwordx4 v102, s[12:15], s27 offen lds
    s_mov_b32 exec_hi, -1
    s_add_u32 s22, s20, 20480
    s_add_u32 s23, s20, 20480
    s_add_u32 m0, s23, 0
    s_add_u32 s27, s22, 0
    buffer_load_dwordx4 v102, s[12:15], s27 offen lds
    s_add_u32 m0, s23, 1024
    s_add_u32 s27, s22, 1024
    buffer_load_dwordx4 v102, s[12:15], s27 offen lds
    v_lshlrev_b32 v96, 4, v0
    v_lshlrev_b32 v97, 3, v1
    v_add_u32 v97, 1024, v97
    v_mov_b32 v106, 19
    v_cmp_gt_u32 vcc, 19, v1
    s_nop 1
    v_cndmask_b32 v106, v106, v1, vcc
    v_mul_u32_u24 v107, 20, v105
    v_add_u32 v106, v106, v107
    v_lshlrev_b32 v106, 4, v106
    v_add_u32 v98, 1280, v106
    v_add_u32 v99, 20480, v96
    v_add_u32 v100, 20480, v97
    v_add_u32 v101, 20480, v98
    v_mov_b32 v112, v96
    v_mov_b32 v113, v97
    v_mov_b32 v114, v98
    v_mov_b32 v48, 0
    v_mov_b32 v49, 0
    v_mov_b32 v50, 0
    v_mov_b32 v51, 0
    v_mov_b32 v52, 0
    v_mov_b32 v53, 0
    v_mov_b32 v54, 0
    v_mov_b32 v55, 0
    v_mov_b32 v56, 0
    v_mov_b32 v57, 0
    v_mov_b32 v58, 0
    v_mov_b32 v59, 0
    v_mov_b32 v60, 0
    v_mov_b32 v61, 0
    v_mov_b32 v62, 0
    v_mov_b32 v63, 0
    s_waitcnt vmcnt(2)
    s_nop 1
    v_max_u32_dpp v117, v117, v117 row_shr:1 row_mask:0xf bank_mask:0xf
    s_nop 1
    v_max_u32_dpp v117, v117, v117 row_shr:2 row_mask:0xf bank_mask:0xf
    s_nop 1
    v_max_u32_dpp v117, v117, v117 row_shr:4 row_mask:0xf bank_mask:0xf
    s_nop 1
    v_max_u32_dpp v117, v117, v117 row_shr:8 row_mask:0xf bank_mask:0xf
    s_nop 1
    v_max_u32_dpp v117, v117, v117 row_bcast:15 row_mask:0xa bank_mask:0xf
    s_nop 1
    v_max_u32_dpp v117, v117, v117 row_bcast:31 row_mask:0xc bank_mask:0xf
    s_nop 1
    v_readlane_b32 s44, v117, 63
    v_cmp_gt_u32 vcc, 32, v0
    v_mov_b32 v104, 0
    s_nop 0
    v_cndmask_b32 v6, v104, v6, vcc
    v_dot2_f32_bf16 v104, v2, v2, v104
    s_nop 2
    v_dot2_f32_bf16 v104, v3, v3, v104
    s_nop 2
    v_dot2_f32_bf16 v104, v4, v4, v104
    s_nop 2
    v_dot2_f32_bf16 v104, v5, v5, v104
    s_nop 2
    v_dot2_f32_bf16 v104, v6, v6, v104
    s_nop 2
    v_mov_b32 v105, v104
    s_nop 1
    v_permlane32_swap_b32 v104, v105
    v_add_f32 v104, v104, v105
    v_mul_f32 v104, s44, v104
    v_sqrt_f32 v104, v104
    s_nop 0
    v_mul_f32 v104, 0xbf820000, v104
    v_mov_b32 v105, 0
    v_cvt_pk_bf16_f32 v104, v104, v105
    v_cndmask_b32 v7, v105, v104, vcc
    s_barrier
    ds_read_b128 v[64:67], v96 offset:0
    ds_read_b64 v[68:69], v97 offset:0
    ds_read_b128 v[72:75], v96 offset:2560
    ds_read_b64 v[76:77], v97 offset:2560
    ds_read_b128 v[80:83], v98 offset:0
    ds_read_b128 v[84:87], v98 offset:640
    v_mov_b32 v44, 0
    v_mov_b32 v92, 0
    v_mov_b32 v45, 0
    v_mov_b32 v93, 0
    v_mov_b32 v46, 0
    v_mov_b32 v94, 0
    v_mov_b32 v47, 0
    v_mov_b32 v95, 0
    s_waitcnt lgkmcnt(4)
    v_mfma_f32_32x32x16_bf16 v[8:23], v[64:67], v[2:5], 0
    v_mfma_f32_32x32x8bf16_1k v[8:23], v[68:69], v[6:7], v[8:23]
    s_mov_b32 s24, 0
    s_mov_b32 s25, 40960
    s_nop 7
    s_nop 3
    .p2align 6
K2a_loop:
    s_waitcnt lgkmcnt(3)
    v_mfma_f32_32x32x16_bf16 v[24:39], v[72:75], v[2:5], 0
    ds_read_b128 v[64:67], v96 offset:5120
    s_mov_b32 exec_hi, 0
    s_add_u32 m0, s23, 2048
    s_add_u32 s27, s22, 2048
    buffer_load_dwordx4 v102, s[12:15], s27 offen lds
    s_mov_b32 exec_hi, -1
    v_exp_f32 v8, v8
    v_exp_f32 v9, v9
    v_exp_f32 v10, v10
    v_exp_f32 v11, v11
    v_exp_f32 v12, v12
    v_mfma_f32_32x32x16_bf16 v[48:63], v[92:95], v[44:47], v[48:63]
    ds_read_b64 v[68:69], v97 offset:5120
    v_exp_f32 v13, v13
    v_exp_f32 v14, v14
    v_exp_f32 v15, v15
    v_cvt_pk_bf16_f32 v40, v8, v9
    v_cvt_pk_bf16_f32 v41, v10, v11
    v_cvt_pk_bf16_f32 v42, v12, v13
    v_cvt_pk_bf16_f32 v43, v14, v15
    s_waitcnt lgkmcnt(4)
    v_mfma_f32_32x32x8bf16_1k v[24:39], v[76:77], v[6:7], v[24:39]
    ds_read_b128 v[88:91], v98 offset:2560
    v_exp_f32 v16, v16
    v_exp_f32 v17, v17
    v_exp_f32 v18, v18
    v_exp_f32 v19, v19
    s_waitcnt lgkmcnt(4)
    v_mfma_f32_32x32x16_bf16 v[48:63], v[80:83], v[40:43], v[48:63]
    ds_read_b128 v[92:95], v98 offset:3200
    v_exp_f32 v20, v20
    v_exp_f32 v21, v21
    v_exp_f32 v22, v22
    v_exp_f32 v23, v23
    v_cvt_pk_bf16_f32 v44, v16, v17
    v_cvt_pk_bf16_f32 v45, v18, v19
    v_cvt_pk_bf16_f32 v46, v20, v21
    v_cvt_pk_bf16_f32 v47, v22, v23
    s_waitcnt lgkmcnt(3)
    v_mfma_f32_32x32x16_bf16 v[8:23], v[64:67], v[2:5], 0
    ds_read_b128 v[72:75], v96 offset:7680
    v_exp_f32 v24, v24
    v_exp_f32 v25, v25
    v_exp_f32 v26, v26
    v_exp_f32 v27, v27
    v_exp_f32 v28, v28
    v_mfma_f32_32x32x16_bf16 v[48:63], v[84:87], v[44:47], v[48:63]
    ds_read_b64 v[76:77], v97 offset:7680
    v_exp_f32 v29, v29
    v_exp_f32 v30, v30
    v_exp_f32 v31, v31
    v_cvt_pk_bf16_f32 v40, v24, v25
    v_cvt_pk_bf16_f32 v41, v26, v27
    v_cvt_pk_bf16_f32 v42, v28, v29
    v_cvt_pk_bf16_f32 v43, v30, v31
    s_waitcnt lgkmcnt(4)
    v_mfma_f32_32x32x8bf16_1k v[8:23], v[68:69], v[6:7], v[8:23]
    ds_read_b128 v[80:83], v98 offset:5120
    v_exp_f32 v32, v32
    v_exp_f32 v33, v33
    v_exp_f32 v34, v34
    v_exp_f32 v35, v35
    s_waitcnt lgkmcnt(4)
    v_mfma_f32_32x32x16_bf16 v[48:63], v[88:91], v[40:43], v[48:63]
    ds_read_b128 v[84:87], v98 offset:5760
    v_exp_f32 v36, v36
    v_exp_f32 v37, v37
    v_exp_f32 v38, v38
    v_exp_f32 v39, v39
    v_cvt_pk_bf16_f32 v44, v32, v33
    v_cvt_pk_bf16_f32 v45, v34, v35
    v_cvt_pk_bf16_f32 v46, v36, v37
    v_cvt_pk_bf16_f32 v47, v38, v39
    s_waitcnt lgkmcnt(3)
    v_mfma_f32_32x32x16_bf16 v[24:39], v[72:75], v[2:5], 0
    ds_read_b128 v[64:67], v96 offset:10240
    v_exp_f32 v8, v8
    v_exp_f32 v9, v9
    v_exp_f32 v10, v10
    v_exp_f32 v11, v11
    v_exp_f32 v12, v12
    v_mfma_f32_32x32x16_bf16 v[48:63], v[92:95], v[44:47], v[48:63]
    ds_read_b64 v[68:69], v97 offset:10240
    v_exp_f32 v13, v13
    v_exp_f32 v14, v14
    v_exp_f32 v15, v15
    v_cvt_pk_bf16_f32 v40, v8, v9
    v_cvt_pk_bf16_f32 v41, v10, v11
    v_cvt_pk_bf16_f32 v42, v12, v13
    v_cvt_pk_bf16_f32 v43, v14, v15
    s_waitcnt lgkmcnt(4)
    v_mfma_f32_32x32x8bf16_1k v[24:39], v[76:77], v[6:7], v[24:39]
    ds_read_b128 v[88:91], v98 offset:7680
    v_exp_f32 v16, v16
    v_exp_f32 v17, v17
    v_exp_f32 v18, v18
    v_exp_f32 v19, v19
    s_waitcnt lgkmcnt(4)
    v_mfma_f32_32x32x16_bf16 v[48:63], v[80:83], v[40:43], v[48:63]
    ds_read_b128 v[92:95], v98 offset:8320
    v_exp_f32 v20, v20
    v_exp_f32 v21, v21
    v_exp_f32 v22, v22
    v_exp_f32 v23, v23
    v_cvt_pk_bf16_f32 v44, v16, v17
    v_cvt_pk_bf16_f32 v45, v18, v19
    v_cvt_pk_bf16_f32 v46, v20, v21
    v_cvt_pk_bf16_f32 v47, v22, v23
    s_waitcnt lgkmcnt(3)
    v_mfma_f32_32x32x16_bf16 v[8:23], v[64:67], v[2:5], 0
    ds_read_b128 v[72:75], v96 offset:12800
    v_exp_f32 v24, v24
    v_exp_f32 v25, v25
    v_exp_f32 v26, v26
    v_exp_f32 v27, v27
    v_exp_f32 v28, v28
    v_mfma_f32_32x32x16_bf16 v[48:63], v[84:87], v[44:47], v[48:63]
    ds_read_b64 v[76:77], v97 offset:12800
    v_exp_f32 v29, v29
    v_exp_f32 v30, v30
    v_exp_f32 v31, v31
    v_cvt_pk_bf16_f32 v40, v24, v25
    v_cvt_pk_bf16_f32 v41, v26, v27
    v_cvt_pk_bf16_f32 v42, v28, v29
    v_cvt_pk_bf16_f32 v43, v30, v31
    s_waitcnt lgkmcnt(4)
    v_mfma_f32_32x32x8bf16_1k v[8:23], v[68:69], v[6:7], v[8:23]
    ds_read_b128 v[80:83], v98 offset:10240
    v_exp_f32 v32, v32
    v_exp_f32 v33, v33
    v_exp_f32 v34, v34
    v_exp_f32 v35, v35
    s_waitcnt lgkmcnt(4)
    v_mfma_f32_32x32x16_bf16 v[48:63], v[88:91], v[40:43], v[48:63]
    ds_read_b128 v[84:87], v98 offset:10880
    v_exp_f32 v36, v36
    v_exp_f32 v37, v37
    v_exp_f32 v38, v38
    v_exp_f32 v39, v39
    v_cvt_pk_bf16_f32 v44, v32, v33
    v_cvt_pk_bf16_f32 v45, v34, v35
    v_cvt_pk_bf16_f32 v46, v36, v37
    v_cvt_pk_bf16_f32 v47, v38, v39
    s_waitcnt lgkmcnt(3)
    v_mfma_f32_32x32x16_bf16 v[24:39], v[72:75], v[2:5], 0
    ds_read_b128 v[64:67], v96 offset:15360
    v_exp_f32 v8, v8
    v_exp_f32 v9, v9
    v_exp_f32 v10, v10
    v_exp_f32 v11, v11
    v_exp_f32 v12, v12
    v_mfma_f32_32x32x16_bf16 v[48:63], v[92:95], v[44:47], v[48:63]
    ds_read_b64 v[68:69], v97 offset:15360
    v_exp_f32 v13, v13
    v_exp_f32 v14, v14
    v_exp_f32 v15, v15
    v_cvt_pk_bf16_f32 v40, v8, v9
    v_cvt_pk_bf16_f32 v41, v10, v11
    v_cvt_pk_bf16_f32 v42, v12, v13
    v_cvt_pk_bf16_f32 v43, v14, v15
    s_waitcnt lgkmcnt(4)
    v_mfma_f32_32x32x8bf16_1k v[24:39], v[76:77], v[6:7], v[24:39]
    ds_read_b128 v[88:91], v98 offset:12800
    v_exp_f32 v16, v16
    v_exp_f32 v17, v17
    v_exp_f32 v18, v18
    v_exp_f32 v19, v19
    s_waitcnt lgkmcnt(4)
    v_mfma_f32_32x32x16_bf16 v[48:63], v[80:83], v[40:43], v[48:63]
    ds_read_b128 v[92:95], v98 offset:13440
    v_exp_f32 v20, v20
    v_exp_f32 v21, v21
    v_exp_f32 v22, v22
    v_exp_f32 v23, v23
    v_cvt_pk_bf16_f32 v44, v16, v17
    v_cvt_pk_bf16_f32 v45, v18, v19
    v_cvt_pk_bf16_f32 v46, v20, v21
    v_cvt_pk_bf16_f32 v47, v22, v23
    s_waitcnt lgkmcnt(3)
    v_mfma_f32_32x32x16_bf16 v[8:23], v[64:67], v[2:5], 0
    ds_read_b128 v[72:75], v96 offset:17920
    v_exp_f32 v24, v24
    v_exp_f32 v25, v25
    v_exp_f32 v26, v26
    v_exp_f32 v27, v27
    v_exp_f32 v28, v28
    v_mfma_f32_32x32x16_bf16 v[48:63], v[84:87], v[44:47], v[48:63]
    ds_read_b64 v[76:77], v97 offset:17920
    v_exp_f32 v29, v29
    v_exp_f32 v30, v30
    v_exp_f32 v31, v31
    v_cvt_pk_bf16_f32 v40, v24, v25
    v_cvt_pk_bf16_f32 v41, v26, v27
    v_cvt_pk_bf16_f32 v42, v28, v29
    v_cvt_pk_bf16_f32 v43, v30, v31
    s_waitcnt lgkmcnt(4)
    v_mfma_f32_32x32x8bf16_1k v[8:23], v[68:69], v[6:7], v[8:23]
    ds_read_b128 v[80:83], v98 offset:15360
    v_exp_f32 v32, v32
    v_exp_f32 v33, v33
    v_exp_f32 v34, v34
    v_exp_f32 v35, v35
    s_waitcnt lgkmcnt(4)
    v_mfma_f32_32x32x16_bf16 v[48:63], v[88:91], v[40:43], v[48:63]
    ds_read_b128 v[84:87], v98 offset:16000
    v_exp_f32 v36, v36
    v_exp_f32 v37, v37
    v_exp_f32 v38, v38
    v_exp_f32 v39, v39
    v_cvt_pk_bf16_f32 v44, v32, v33
    v_cvt_pk_bf16_f32 v45, v34, v35
    v_cvt_pk_bf16_f32 v46, v36, v37
    v_cvt_pk_bf16_f32 v47, v38, v39
    s_waitcnt vmcnt(0) lgkmcnt(3)
    s_barrier
    s_add_u32 s22, s22, 20480
    s_add_u32 s23, s20, s25
    v_mfma_f32_32x32x16_bf16 v[24:39], v[72:75], v[2:5], 0
    ds_read_b128 v[64:67], v99 offset:0
    s_add_u32 m0, s23, 0
    s_add_u32 s27, s22, 0
    buffer_load_dwordx4 v102, s[12:15], s27 offen lds
    v_exp_f32 v8, v8
    v_exp_f32 v9, v9
    v_exp_f32 v10, v10
    v_exp_f32 v11, v11
    v_exp_f32 v12, v12
    v_mfma_f32_32x32x16_bf16 v[48:63], v[92:95], v[44:47], v[48:63]
    ds_read_b64 v[68:69], v100 offset:0
    v_exp_f32 v13, v13
    v_exp_f32 v14, v14
    v_exp_f32 v15, v15
    v_cvt_pk_bf16_f32 v40, v8, v9
    v_cvt_pk_bf16_f32 v41, v10, v11
    v_cvt_pk_bf16_f32 v42, v12, v13
    v_cvt_pk_bf16_f32 v43, v14, v15
    s_waitcnt lgkmcnt(4)
    v_mfma_f32_32x32x8bf16_1k v[24:39], v[76:77], v[6:7], v[24:39]
    ds_read_b128 v[88:91], v98 offset:17920
    v_exp_f32 v16, v16
    v_exp_f32 v17, v17
    v_exp_f32 v18, v18
    v_exp_f32 v19, v19
    s_waitcnt lgkmcnt(4)
    v_mfma_f32_32x32x16_bf16 v[48:63], v[80:83], v[40:43], v[48:63]
    ds_read_b128 v[92:95], v98 offset:18560
    v_exp_f32 v20, v20
    v_exp_f32 v21, v21
    v_exp_f32 v22, v22
    v_exp_f32 v23, v23
    v_cvt_pk_bf16_f32 v44, v16, v17
    v_cvt_pk_bf16_f32 v45, v18, v19
    v_cvt_pk_bf16_f32 v46, v20, v21
    v_cvt_pk_bf16_f32 v47, v22, v23
    s_waitcnt lgkmcnt(3)
    v_mfma_f32_32x32x16_bf16 v[8:23], v[64:67], v[2:5], 0
    ds_read_b128 v[72:75], v99 offset:2560
    s_add_u32 m0, s23, 1024
    s_add_u32 s27, s22, 1024
    buffer_load_dwordx4 v102, s[12:15], s27 offen lds
    v_exp_f32 v24, v24
    v_exp_f32 v25, v25
    v_exp_f32 v26, v26
    v_exp_f32 v27, v27
    v_exp_f32 v28, v28
    v_mfma_f32_32x32x16_bf16 v[48:63], v[84:87], v[44:47], v[48:63]
    ds_read_b64 v[76:77], v100 offset:2560
    v_exp_f32 v29, v29
    v_exp_f32 v30, v30
    v_exp_f32 v31, v31
    v_cvt_pk_bf16_f32 v40, v24, v25
    v_cvt_pk_bf16_f32 v41, v26, v27
    v_cvt_pk_bf16_f32 v42, v28, v29
    v_cvt_pk_bf16_f32 v43, v30, v31
    s_waitcnt lgkmcnt(4)
    v_mfma_f32_32x32x8bf16_1k v[8:23], v[68:69], v[6:7], v[8:23]
    ds_read_b128 v[80:83], v101 offset:0
    v_exp_f32 v32, v32
    v_exp_f32 v33, v33
    v_exp_f32 v34, v34
    v_exp_f32 v35, v35
    s_waitcnt lgkmcnt(4)
    v_mfma_f32_32x32x16_bf16 v[48:63], v[88:91], v[40:43], v[48:63]
    ds_read_b128 v[84:87], v101 offset:640
    v_exp_f32 v36, v36
    v_exp_f32 v37, v37
    v_exp_f32 v38, v38
    v_exp_f32 v39, v39
    v_cvt_pk_bf16_f32 v44, v32, v33
    v_cvt_pk_bf16_f32 v45, v34, v35
    v_cvt_pk_bf16_f32 v46, v36, v37
    v_cvt_pk_bf16_f32 v47, v38, v39
    v_mov_b32 v96, v99
    v_mov_b32 v97, v100
    v_mov_b32 v98, v101
    v_add_u32 v99, s25, v112
    v_add_u32 v100, s25, v113
    v_add_u32 v101, s25, v114
    s_add_u32 s25, s25, 20480
    s_cmp_ge_u32 s25, 61440
    s_cselect_b32 s25, 0, s25
    s_add_u32 s24, s24, 1
    s_cmp_lt_u32 s24, 8
    s_cbranch_scc1 K2a_loop
    s_waitcnt lgkmcnt(4)
    s_nop 1
    v_mfma_f32_32x32x16_bf16 v[48:63], v[92:95], v[44:47], v[48:63]
    s_waitcnt vmcnt(0) lgkmcnt(0)
    s_nop 7
    s_nop 7
    v_mov_b32 v104, v58
    v_mov_b32 v105, v58
    s_nop 1
    v_permlane32_swap_b32 v104, v105
    s_mov_b32 s26, 394264576
    v_cmp_nle_f32 vcc, s26, v104
    s_nop 1
    s_nop 3
    s_cbranch_vccnz K2a_slow
K2a_fin:
    v_rcp_f32 v104, v104
    s_nop 0
    v_mul_f32 v48, v48, v104
    v_mul_f32 v49, v49, v104
    v_mul_f32 v50, v50, v104
    v_mul_f32 v51, v51, v104
    v_mul_f32 v52, v52, v104
    v_mul_f32 v53, v53, v104
    v_mul_f32 v54, v54, v104
    v_mul_f32 v55, v55, v104
    v_mul_f32 v56, v56, v104
    v_mul_f32 v57, v57, v104
    v_cvt_pk_bf16_f32 v40, v48, v49
    v_cvt_pk_bf16_f32 v41, v50, v51
    v_cvt_pk_bf16_f32 v42, v52, v53
    v_cvt_pk_bf16_f32 v43, v54, v55
    v_cvt_pk_bf16_f32 v44, v56, v57
    buffer_store_dwordx2 v[40:41], v103, s[16:19], s7 offen
    buffer_store_dwordx2 v[42:43], v103, s[16:19], s7 offen offset:16
    v_cmp_gt_u32 vcc, 32, v0
    s_nop 1
    s_and_b64 exec, exec, vcc
    buffer_store_dword v44, v103, s[16:19], s7 offen offset:32
    s_endpgm
K2a_slow:
    v_lshlrev_b32 v108, 4, v0
    v_lshlrev_b32 v109, 3, v1
    v_add_u32 v109, 1024, v109
    v_mov_b32 v110, v114
    v_and_b32 v7, 0, v7
    v_mov_b32 v111, 0xff7fffff
    s_mov_b32 s26, 0
K2a_s1:
    buffer_load_dwordx4 v[64:67], v108, s[12:15], s26 offen
    buffer_load_dwordx2 v[68:69], v109, s[12:15], s26 offen
    s_waitcnt vmcnt(0)
    v_mfma_f32_32x32x16_bf16 v[8:23], v[64:67], v[2:5], 0
    v_mfma_f32_32x32x8bf16_1k v[8:23], v[68:69], v[6:7], v[8:23]
    s_nop 7
    s_nop 7
    v_max_f32 v111, v111, v8
    v_max_f32 v111, v111, v9
    v_max_f32 v111, v111, v10
    v_max_f32 v111, v111, v11
    v_max_f32 v111, v111, v12
    v_max_f32 v111, v111, v13
    v_max_f32 v111, v111, v14
    v_max_f32 v111, v111, v15
    v_max_f32 v111, v111, v16
    v_max_f32 v111, v111, v17
    v_max_f32 v111, v111, v18
    v_max_f32 v111, v111, v19
    v_max_f32 v111, v111, v20
    v_max_f32 v111, v111, v21
    v_max_f32 v111, v111, v22
    v_max_f32 v111, v111, v23
    s_add_u32 s26, s26, 2560
    s_cmp_lt_u32 s26, 163840
    s_cbranch_scc1 K2a_s1
    v_mov_b32 v104, v111
    s_nop 1
    v_permlane32_swap_b32 v104, v111
    v_max_f32 v111, v111, v104
    v_mov_b32 v48, 0
    v_mov_b32 v49, 0
    v_mov_b32 v50, 0
    v_mov_b32 v51, 0
    v_mov_b32 v52, 0
    v_mov_b32 v53, 0
    v_mov_b32 v54, 0
    v_mov_b32 v55, 0
    v_mov_b32 v56, 0
    v_mov_b32 v57, 0
    v_mov_b32 v58, 0
    v_mov_b32 v59, 0
    v_mov_b32 v60, 0
    v_mov_b32 v61, 0
    v_mov_b32 v62, 0
    v_mov_b32 v63, 0
    s_mov_b32 s26, 0
K2a_s2:
    buffer_load_dwordx4 v[64:67], v108, s[12:15], s26 offen
    buffer_load_dwordx2 v[68:69], v109, s[12:15], s26 offen
    buffer_load_dwordx4 v[80:83], v110, s[12:15], s26 offen
    buffer_load_dwordx4 v[84:87], v110, s[12:15], s26 offen offset:640
    s_waitcnt vmcnt(0)
    v_mfma_f32_32x32x16_bf16 v[8:23], v[64:67], v[2:5], 0
    v_mfma_f32_32x32x8bf16_1k v[8:23], v[68:69], v[6:7], v[8:23]
    s_nop 7
    s_nop 7
    v_sub_f32 v8, v8, v111
    v_exp_f32 v8, v8
    v_sub_f32 v9, v9, v111
    v_exp_f32 v9, v9
    v_sub_f32 v10, v10, v111
    v_exp_f32 v10, v10
    v_sub_f32 v11, v11, v111
    v_exp_f32 v11, v11
    v_sub_f32 v12, v12, v111
    v_exp_f32 v12, v12
    v_sub_f32 v13, v13, v111
    v_exp_f32 v13, v13
    v_sub_f32 v14, v14, v111
    v_exp_f32 v14, v14
    v_sub_f32 v15, v15, v111
    v_exp_f32 v15, v15
    v_sub_f32 v16, v16, v111
    v_exp_f32 v16, v16
    v_sub_f32 v17, v17, v111
    v_exp_f32 v17, v17
    v_sub_f32 v18, v18, v111
    v_exp_f32 v18, v18
    v_sub_f32 v19, v19, v111
    v_exp_f32 v19, v19
    v_sub_f32 v20, v20, v111
    v_exp_f32 v20, v20
    v_sub_f32 v21, v21, v111
    v_exp_f32 v21, v21
    v_sub_f32 v22, v22, v111
    v_exp_f32 v22, v22
    v_sub_f32 v23, v23, v111
    v_exp_f32 v23, v23
    s_nop 0
    v_cvt_pk_bf16_f32 v40, v8, v9
    v_cvt_pk_bf16_f32 v41, v10, v11
    v_cvt_pk_bf16_f32 v42, v12, v13
    v_cvt_pk_bf16_f32 v43, v14, v15
    v_cvt_pk_bf16_f32 v44, v16, v17
    v_cvt_pk_bf16_f32 v45, v18, v19
    v_cvt_pk_bf16_f32 v46, v20, v21
    v_cvt_pk_bf16_f32 v47, v22, v23
    s_nop 1
    v_mfma_f32_32x32x16_bf16 v[48:63], v[80:83], v[40:43], v[48:63]
    v_mfma_f32_32x32x16_bf16 v[48:63], v[84:87], v[44:47], v[48:63]
    s_add_u32 s26, s26, 2560
    s_cmp_lt_u32 s26, 163840
    s_cbranch_scc1 K2a_s2
    s_nop 7
    s_nop 7
    v_mov_b32 v104, v58
    v_mov_b32 v105, v58
    s_nop 1
    v_permlane32_swap_b32 v104, v105
    s_branch K2a_fin
K2_fft:
    s_sub_u32 s4, s3, 8
    s_and_b32 s5, s4, 1
    s_lshr_b32 s4, s4, 1
    s_lshl_b32 s6, s2, 1
    s_add_u32 s6, s6, s4
    s_cmp_ge_u32 s6, 289
    s_cbranch_scc1 K2_end
    s_setprio 0
    s_getpc_b64 s[24:25]
K2_pc1:
    s_add_u32 s24, s24, FTAB-K2_pc1
    s_addc_u32 s25, s25, 0
    s_waitcnt lgkmcnt(0)
    s_add_u32 s8, s40, 2621440
    s_addc_u32 s9, s41, 0
    s_mov_b32 s10, 2359296
    s_mov_b32 s11, 0x00020000
    s_add_u32 s12, s40, 4980736
    s_addc_u32 s13, s41, 0
    s_mov_b32 s14, 2367488
    s_mov_b32 s15, 0x00020000
    s_add_u32 s16, s40, 9961472
    s_addc_u32 s17, s41, 0
    s_mov_b32 s18, 2359296
    s_mov_b32 s19, 0x00020000
    s_mov_b32 s20, s24
    s_mov_b32 s21, s25
    s_mov_b32 s22, 81920
    s_mov_b32 s23, 0x00020000
    s_cmp_eq_u32 s6, 288
    s_cselect_b32 s7, 0, s6
    s_lshl_b32 s28, s7, 13
    s_add_u32 s29, s28, 4096
    v_and_b32 v1, 31, v0
    v_lshrrev_b32 v6, 5, v0
    v_lshlrev_b32 v7, 2, v1
    v_lshl_add_u32 v7, v6, 10, v7
    buffer_load_dword v8, v7, s[8:11], s28 offen offset:0
    buffer_load_dword v9, v7, s[8:11], s28 offen offset:256
    buffer_load_dword v10, v7, s[8:11], s28 offen offset:512
    buffer_load_dword v11, v7, s[8:11], s28 offen offset:768
    buffer_load_dword v12, v7, s[8:11], s28 offen offset:2048
    buffer_load_dword v13, v7, s[8:11], s28 offen offset:2304
    buffer_load_dword v14, v7, s[8:11], s28 offen offset:2560
    buffer_load_dword v15, v7, s[8:11], s28 offen offset:2816
    buffer_load_dword v16, v7, s[8:11], s29 offen offset:0
    buffer_load_dword v17, v7, s[8:11], s29 offen offset:256
    buffer_load_dword v18, v7, s[8:11], s29 offen offset:512
    buffer_load_dword v19, v7, s[8:11], s29 offen offset:768
    buffer_load_dword v20, v7, s[8:11], s29 offen offset:2048
    buffer_load_dword v21, v7, s[8:11], s29 offen offset:2304
    buffer_load_dword v22, v7, s[8:11], s29 offen offset:2560
    buffer_load_dword v23, v7, s[8:11], s29 offen offset:2816
    buffer_load_dword v24, v7, s[8:11], s28 offen offset:128
    buffer_load_dword v25, v7, s[8:11], s28 offen offset:384
    buffer_load_dword v26, v7, s[8:11], s28 offen offset:640
    buffer_load_dword v27, v7, s[8:11], s28 offen offset:896
    buffer_load_dword v28, v7, s[8:11], s28 offen offset:2176
    buffer_load_dword v29, v7, s[8:11], s28 offen offset:2432
    buffer_load_dword v30, v7, s[8:11], s28 offen offset:2688
    buffer_load_dword v31, v7, s[8:11], s28 offen offset:2944
    buffer_load_dword v32, v7, s[8:11], s29 offen offset:128
    buffer_load_dword v33, v7, s[8:11], s29 offen offset:384
    buffer_load_dword v34, v7, s[8:11], s29 offen offset:640
    buffer_load_dword v35, v7, s[8:11], s29 offen offset:896
    buffer_load_dword v36, v7, s[8:11], s29 offen offset:2176
    buffer_load_dword v37, v7, s[8:11], s29 offen offset:2432
    buffer_load_dword v38, v7, s[8:11], s29 offen offset:2688
    buffer_load_dword v39, v7, s[8:11], s29 offen offset:2944
    s_barrier
    v_lshlrev_b32 v5, 4, v0
    s_lshl_b32 s30, s5, 12
    s_add_u32 s30, s30, 0
    buffer_load_dwordx4 v[40:43], v5, s[20:23], s30 offen offset:0
    buffer_load_dwordx4 v[44:47], v5, s[20:23], s30 offen offset:1024
    buffer_load_dwordx4 v[48:51], v5, s[20:23], s30 offen offset:2048
    buffer_load_dwordx4 v[52:55], v5, s[20:23], s30 offen offset:3072
    s_mul_i32 s30, s5, 16384
    s_add_u32 s30, s30, 24576
    buffer_load_dwordx4 v[88:91], v5, s[20:23], s30 offen offset:0
    buffer_load_dwordx4 v[92:95], v5, s[20:23], s30 offen offset:1024
    buffer_load_dwordx4 v[96:99], v5, s[20:23], s30 offen offset:2048
    buffer_load_dwordx4 v[100:103], v5, s[20:23], s30 offen offset:3072
    s_mul_i32 s30, s5, 16384
    s_add_u32 s30, s30, 28672
    buffer_load_dwordx4 v[104:107], v5, s[20:23], s30 offen offset:0
    buffer_load_dwordx4 v[108:111], v5, s[20:23], s30 offen offset:1024
    buffer_load_dwordx4 v[112:115], v5, s[20:23], s30 offen offset:2048
    buffer_load_dwordx4 v[116:119], v5, s[20:23], s30 offen offset:3072
    s_mul_i32 s30, s5, 16384
    s_add_u32 s30, s30, 32768
    buffer_load_dwordx4 v[120:123], v5, s[20:23], s30 offen offset:0
    buffer_load_dwordx4 v[124:127], v5, s[20:23], s30 offen offset:1024
    buffer_load_dwordx4 v[128:131], v5, s[20:23], s30 offen offset:2048
    buffer_load_dwordx4 v[132:135], v5, s[20:23], s30 offen offset:3072
    s_mul_i32 s30, s5, 16384
    s_add_u32 s30, s30, 36864
    buffer_load_dwordx4 v[136:139], v5, s[20:23], s30 offen offset:0
    buffer_load_dwordx4 v[140:143], v5, s[20:23], s30 offen offset:1024
    buffer_load_dwordx4 v[144:147], v5, s[20:23], s30 offen offset:2048
    buffer_load_dwordx4 v[148:151], v5, s[20:23], s30 offen offset:3072
    v_and_b32 v2, 1, v0
    v_cmp_eq_u32 vcc, 1, v2
    v_mov_b32 v3, 0x80008000
    v_mov_b32 v4, 0
    s_nop 0
    v_cndmask_b32 v6, v4, v3, vcc
    v_cndmask_b32 v7, v3, v4, vcc
    v_mov_b32 v2, 0x80000000
    v_mov_b32 v3, 0
    v_cndmask_b32 v1, v2, v3, vcc
    s_mov_b32 s35, 0xffff0000
    s_waitcnt vmcnt(20)
    s_cmp_eq_u32 s6, 0
    s_cbranch_scc1 K2f_sp0
    s_cmp_eq_u32 s6, 288
    s_cbranch_scc0 K2f_nosp
    v_lshrrev_b32 v8, 16, v8
    v_lshrrev_b32 v9, 16, v9
    v_lshrrev_b32 v10, 16, v10
    v_lshrrev_b32 v11, 16, v11
    v_lshrrev_b32 v12, 16, v12
    v_lshrrev_b32 v13, 16, v13
    v_lshrrev_b32 v14, 16, v14
    v_lshrrev_b32 v15, 16, v15
    v_lshrrev_b32 v16, 16, v16
    v_lshrrev_b32 v17, 16, v17
    v_lshrrev_b32 v18, 16, v18
    v_lshrrev_b32 v19, 16, v19
    v_lshrrev_b32 v20, 16, v20
    v_lshrrev_b32 v21, 16, v21
    v_lshrrev_b32 v22, 16, v22
    v_lshrrev_b32 v23, 16, v23
    v_lshrrev_b32 v24, 16, v24
    v_lshrrev_b32 v25, 16, v25
    v_lshrrev_b32 v26, 16, v26
    v_lshrrev_b32 v27, 16, v27
    v_lshrrev_b32 v28, 16, v28
    v_lshrrev_b32 v29, 16, v29
    v_lshrrev_b32 v30, 16, v30
    v_lshrrev_b32 v31, 16, v31
    v_lshrrev_b32 v32, 16, v32
    v_lshrrev_b32 v33, 16, v33
    v_lshrrev_b32 v34, 16, v34
    v_lshrrev_b32 v35, 16, v35
    v_lshrrev_b32 v36, 16, v36
    v_lshrrev_b32 v37, 16, v37
    v_lshrrev_b32 v38, 16, v38
    v_lshrrev_b32 v39, 16, v39
    s_branch K2f_nosp
K2f_sp0:
    v_and_b32 v8, 0xffff, v8
    v_and_b32 v9, 0xffff, v9
    v_and_b32 v10, 0xffff, v10
    v_and_b32 v11, 0xffff, v11
    v_and_b32 v12, 0xffff, v12
    v_and_b32 v13, 0xffff, v13
    v_and_b32 v14, 0xffff, v14
    v_and_b32 v15, 0xffff, v15
    v_and_b32 v16, 0xffff, v16
    v_and_b32 v17, 0xffff, v17
    v_and_b32 v18, 0xffff, v18
    v_and_b32 v19, 0xffff, v19
    v_and_b32 v20, 0xffff, v20
    v_and_b32 v21, 0xffff, v21
    v_and_b32 v22, 0xffff, v22
    v_and_b32 v23, 0xffff, v23
    v_and_b32 v24, 0xffff, v24
    v_and_b32 v25, 0xffff, v25
    v_and_b32 v26, 0xffff, v26
    v_and_b32 v27, 0xffff, v27
    v_and_b32 v28, 0xffff, v28
    v_and_b32 v29, 0xffff, v29
    v_and_b32 v30, 0xffff, v30
    v_and_b32 v31, 0xffff, v31
    v_and_b32 v32, 0xffff, v32
    v_and_b32 v33, 0xffff, v33
    v_and_b32 v34, 0xffff, v34
    v_and_b32 v35, 0xffff, v35
    v_and_b32 v36, 0xffff, v36
    v_and_b32 v37, 0xffff, v37
    v_and_b32 v38, 0xffff, v38
    v_and_b32 v39, 0xffff, v39
K2f_nosp:
    s_waitcnt vmcnt(16)
    s_nop 1
    v_mfma_f32_32x32x16_bf16 v[56:71], v[8:11], v[40:43], 0
    v_mfma_f32_32x32x16_bf16 v[56:71], v[12:15], v[44:47], v[56:71]
    v_mfma_f32_32x32x16_bf16 v[56:71], v[16:19], v[48:51], v[56:71]
    v_mfma_f32_32x32x16_bf16 v[56:71], v[20:23], v[52:55], v[56:71]
    v_mfma_f32_32x32x16_bf16 v[72:87], v[24:27], v[40:43], 0
    v_mfma_f32_32x32x16_bf16 v[72:87], v[28:31], v[44:47], v[72:87]
    v_mfma_f32_32x32x16_bf16 v[72:87], v[32:35], v[48:51], v[72:87]
    v_mfma_f32_32x32x16_bf16 v[72:87], v[36:39], v[52:55], v[72:87]
    s_barrier
    s_waitcnt vmcnt(0)
    s_nop 7
    s_nop 3
    v_mul_f32 v2, v56, v88
    v_fmac_f32_dpp v2, v56, v89 quad_perm:[1,0,3,2] row_mask:0xf bank_mask:0xf
    v_mul_f32 v3, v57, v90
    v_fmac_f32_dpp v3, v57, v91 quad_perm:[1,0,3,2] row_mask:0xf bank_mask:0xf
    v_cvt_pk_bf16_f32 v8, v2, v3
    v_mul_f32 v2, v58, v92
    v_fmac_f32_dpp v2, v58, v93 quad_perm:[1,0,3,2] row_mask:0xf bank_mask:0xf
    v_mul_f32 v3, v59, v94
    v_fmac_f32_dpp v3, v59, v95 quad_perm:[1,0,3,2] row_mask:0xf bank_mask:0xf
    v_cvt_pk_bf16_f32 v9, v2, v3
    v_mul_f32 v2, v60, v96
    v_fmac_f32_dpp v2, v60, v97 quad_perm:[1,0,3,2] row_mask:0xf bank_mask:0xf
    v_mul_f32 v3, v61, v98
    v_fmac_f32_dpp v3, v61, v99 quad_perm:[1,0,3,2] row_mask:0xf bank_mask:0xf
    v_cvt_pk_bf16_f32 v10, v2, v3
    v_mul_f32 v2, v62, v100
    v_fmac_f32_dpp v2, v62, v101 quad_perm:[1,0,3,2] row_mask:0xf bank_mask:0xf
    v_mul_f32 v3, v63, v102
    v_fmac_f32_dpp v3, v63, v103 quad_perm:[1,0,3,2] row_mask:0xf bank_mask:0xf
    v_cvt_pk_bf16_f32 v11, v2, v3
    v_mul_f32 v2, v64, v104
    v_fmac_f32_dpp v2, v64, v105 quad_perm:[1,0,3,2] row_mask:0xf bank_mask:0xf
    v_mul_f32 v3, v65, v106
    v_fmac_f32_dpp v3, v65, v107 quad_perm:[1,0,3,2] row_mask:0xf bank_mask:0xf
    v_cvt_pk_bf16_f32 v12, v2, v3
    v_mul_f32 v2, v66, v108
    v_fmac_f32_dpp v2, v66, v109 quad_perm:[1,0,3,2] row_mask:0xf bank_mask:0xf
    v_mul_f32 v3, v67, v110
    v_fmac_f32_dpp v3, v67, v111 quad_perm:[1,0,3,2] row_mask:0xf bank_mask:0xf
    v_cvt_pk_bf16_f32 v13, v2, v3
    v_mul_f32 v2, v68, v112
    v_fmac_f32_dpp v2, v68, v113 quad_perm:[1,0,3,2] row_mask:0xf bank_mask:0xf
    v_mul_f32 v3, v69, v114
    v_fmac_f32_dpp v3, v69, v115 quad_perm:[1,0,3,2] row_mask:0xf bank_mask:0xf
    v_cvt_pk_bf16_f32 v14, v2, v3
    v_mul_f32 v2, v70, v116
    v_fmac_f32_dpp v2, v70, v117 quad_perm:[1,0,3,2] row_mask:0xf bank_mask:0xf
    v_mul_f32 v3, v71, v118
    v_fmac_f32_dpp v3, v71, v119 quad_perm:[1,0,3,2] row_mask:0xf bank_mask:0xf
    v_cvt_pk_bf16_f32 v15, v2, v3
    s_barrier
    v_mul_f32 v2, v72, v120
    v_fmac_f32_dpp v2, v72, v121 quad_perm:[1,0,3,2] row_mask:0xf bank_mask:0xf
    v_mul_f32 v3, v73, v122
    v_fmac_f32_dpp v3, v73, v123 quad_perm:[1,0,3,2] row_mask:0xf bank_mask:0xf
    v_cvt_pk_bf16_f32 v16, v2, v3
    v_mul_f32 v2, v74, v124
    v_fmac_f32_dpp v2, v74, v125 quad_perm:[1,0,3,2] row_mask:0xf bank_mask:0xf
    v_mul_f32 v3, v75, v126
    v_fmac_f32_dpp v3, v75, v127 quad_perm:[1,0,3,2] row_mask:0xf bank_mask:0xf
    v_cvt_pk_bf16_f32 v17, v2, v3
    v_mul_f32 v2, v76, v128
    v_fmac_f32_dpp v2, v76, v129 quad_perm:[1,0,3,2] row_mask:0xf bank_mask:0xf
    v_mul_f32 v3, v77, v130
    v_fmac_f32_dpp v3, v77, v131 quad_perm:[1,0,3,2] row_mask:0xf bank_mask:0xf
    v_cvt_pk_bf16_f32 v18, v2, v3
    v_mul_f32 v2, v78, v132
    v_fmac_f32_dpp v2, v78, v133 quad_perm:[1,0,3,2] row_mask:0xf bank_mask:0xf
    v_mul_f32 v3, v79, v134
    v_fmac_f32_dpp v3, v79, v135 quad_perm:[1,0,3,2] row_mask:0xf bank_mask:0xf
    v_cvt_pk_bf16_f32 v19, v2, v3
    v_mul_f32 v2, v80, v136
    v_fmac_f32_dpp v2, v80, v137 quad_perm:[1,0,3,2] row_mask:0xf bank_mask:0xf
    v_mul_f32 v3, v81, v138
    v_fmac_f32_dpp v3, v81, v139 quad_perm:[1,0,3,2] row_mask:0xf bank_mask:0xf
    v_cvt_pk_bf16_f32 v20, v2, v3
    v_mul_f32 v2, v82, v140
    v_fmac_f32_dpp v2, v82, v141 quad_perm:[1,0,3,2] row_mask:0xf bank_mask:0xf
    v_mul_f32 v3, v83, v142
    v_fmac_f32_dpp v3, v83, v143 quad_perm:[1,0,3,2] row_mask:0xf bank_mask:0xf
    v_cvt_pk_bf16_f32 v21, v2, v3
    v_mul_f32 v2, v84, v144
    v_fmac_f32_dpp v2, v84, v145 quad_perm:[1,0,3,2] row_mask:0xf bank_mask:0xf
    v_mul_f32 v3, v85, v146
    v_fmac_f32_dpp v3, v85, v147 quad_perm:[1,0,3,2] row_mask:0xf bank_mask:0xf
    v_cvt_pk_bf16_f32 v22, v2, v3
    v_mul_f32 v2, v86, v148
    v_fmac_f32_dpp v2, v86, v149 quad_perm:[1,0,3,2] row_mask:0xf bank_mask:0xf
    v_mul_f32 v3, v87, v150
    v_fmac_f32_dpp v3, v87, v151 quad_perm:[1,0,3,2] row_mask:0xf bank_mask:0xf
    v_cvt_pk_bf16_f32 v23, v2, v3
    s_nop 1
    v_xor_b32_dpp v24, v8, v6 quad_perm:[1,0,3,2] row_mask:0xf bank_mask:0xf
    v_xor_b32_dpp v25, v9, v6 quad_perm:[1,0,3,2] row_mask:0xf bank_mask:0xf
    v_xor_b32_dpp v26, v10, v6 quad_perm:[1,0,3,2] row_mask:0xf bank_mask:0xf
    v_xor_b32_dpp v27, v11, v6 quad_perm:[1,0,3,2] row_mask:0xf bank_mask:0xf
    v_xor_b32_dpp v28, v12, v6 quad_perm:[1,0,3,2] row_mask:0xf bank_mask:0xf
    v_xor_b32_dpp v29, v13, v6 quad_perm:[1,0,3,2] row_mask:0xf bank_mask:0xf
    v_xor_b32_dpp v30, v14, v6 quad_perm:[1,0,3,2] row_mask:0xf bank_mask:0xf
    v_xor_b32_dpp v31, v15, v6 quad_perm:[1,0,3,2] row_mask:0xf bank_mask:0xf
    v_xor_b32_dpp v32, v16, v6 quad_perm:[1,0,3,2] row_mask:0xf bank_mask:0xf
    v_xor_b32_dpp v33, v17, v6 quad_perm:[1,0,3,2] row_mask:0xf bank_mask:0xf
    v_xor_b32_dpp v34, v18, v6 quad_perm:[1,0,3,2] row_mask:0xf bank_mask:0xf
    v_xor_b32_dpp v35, v19, v6 quad_perm:[1,0,3,2] row_mask:0xf bank_mask:0xf
    v_xor_b32_dpp v36, v20, v6 quad_perm:[1,0,3,2] row_mask:0xf bank_mask:0xf
    v_xor_b32_dpp v37, v21, v6 quad_perm:[1,0,3,2] row_mask:0xf bank_mask:0xf
    v_xor_b32_dpp v38, v22, v6 quad_perm:[1,0,3,2] row_mask:0xf bank_mask:0xf
    v_xor_b32_dpp v39, v23, v6 quad_perm:[1,0,3,2] row_mask:0xf bank_mask:0xf
    s_mov_b32 s30, 8192
    buffer_load_dwordx4 v[88:91], v5, s[20:23], s30 offen offset:0
    buffer_load_dwordx4 v[92:95], v5, s[20:23], s30 offen offset:1024
    buffer_load_dwordx4 v[96:99], v5, s[20:23], s30 offen offset:2048
    buffer_load_dwordx4 v[100:103], v5, s[20:23], s30 offen offset:3072
    s_mov_b32 s30, 12288
    buffer_load_dwordx4 v[104:107], v5, s[20:23], s30 offen offset:0
    buffer_load_dwordx4 v[108:111], v5, s[20:23], s30 offen offset:1024
    buffer_load_dwordx4 v[112:115], v5, s[20:23], s30 offen offset:2048
    buffer_load_dwordx4 v[116:119], v5, s[20:23], s30 offen offset:3072
    s_mov_b32 s30, 16384
    buffer_load_dwordx4 v[120:123], v5, s[20:23], s30 offen offset:0
    buffer_load_dwordx4 v[124:127], v5, s[20:23], s30 offen offset:1024
    buffer_load_dwordx4 v[128:131], v5, s[20:23], s30 offen offset:2048
    buffer_load_dwordx4 v[132:135], v5, s[20:23], s30 offen offset:3072
    s_mov_b32 s30, 20480
    buffer_load_dwordx4 v[136:139], v5, s[20:23], s30 offen offset:0
    buffer_load_dwordx4 v[140:143], v5, s[20:23], s30 offen offset:1024
    buffer_load_dwordx4 v[144:147], v5, s[20:23], s30 offen offset:2048
    buffer_load_dwordx4 v[148:151], v5, s[20:23], s30 offen offset:3072
    v_and_b32 v2, 31, v0
    v_lshrrev_b32 v2, 1, v2
    s_lshl_b32 s30, s5, 4
    v_add_u32 v2, s30, v2
    v_lshlrev_b32 v2, 2, v2
    v_lshrrev_b32 v3, 5, v0
    v_lshl_add_u32 v4, v3, 9, v2
    s_lshl_b32 s30, s6, 13
    s_add_u32 s30, s30, 0
    buffer_load_dword v41, v4, s[12:15], s30 offen offset:0
    buffer_load_dword v43, v4, s[12:15], s30 offen offset:128
    buffer_load_dword v45, v4, s[12:15], s30 offen offset:256
    buffer_load_dword v47, v4, s[12:15], s30 offen offset:384
    s_lshl_b32 s30, s6, 13
    s_add_u32 s30, s30, 1024
    buffer_load_dword v49, v4, s[12:15], s30 offen offset:0
    buffer_load_dword v51, v4, s[12:15], s30 offen offset:128
    buffer_load_dword v53, v4, s[12:15], s30 offen offset:256
    buffer_load_dword v55, v4, s[12:15], s30 offen offset:384
    s_lshl_b32 s30, s6, 13
    s_add_u32 s30, s30, 2048
    buffer_load_dword v153, v4, s[12:15], s30 offen offset:0
    buffer_load_dword v155, v4, s[12:15], s30 offen offset:128
    buffer_load_dword v157, v4, s[12:15], s30 offen offset:256
    buffer_load_dword v159, v4, s[12:15], s30 offen offset:384
    s_lshl_b32 s30, s6, 13
    s_add_u32 s30, s30, 3072
    buffer_load_dword v161, v4, s[12:15], s30 offen offset:0
    buffer_load_dword v163, v4, s[12:15], s30 offen offset:128
    buffer_load_dword v165, v4, s[12:15], s30 offen offset:256
    buffer_load_dword v167, v4, s[12:15], s30 offen offset:384
    s_barrier
    s_waitcnt vmcnt(16)
    v_mfma_f32_32x32x16_bf16 v[56:71], v[88:91], v[8:11], 0
    v_mfma_f32_32x32x16_bf16 v[56:71], v[92:95], v[24:27], v[56:71]
    v_mfma_f32_32x32x16_bf16 v[56:71], v[96:99], v[12:15], v[56:71]
    v_mfma_f32_32x32x16_bf16 v[56:71], v[100:103], v[28:31], v[56:71]
    v_mfma_f32_32x32x16_bf16 v[56:71], v[104:107], v[16:19], v[56:71]
    v_mfma_f32_32x32x16_bf16 v[56:71], v[108:111], v[32:35], v[56:71]
    v_mfma_f32_32x32x16_bf16 v[56:71], v[112:115], v[20:23], v[56:71]
    v_mfma_f32_32x32x16_bf16 v[56:71], v[116:119], v[36:39], v[56:71]
    v_mfma_f32_32x32x16_bf16 v[72:87], v[120:123], v[8:11], 0
    v_mfma_f32_32x32x16_bf16 v[72:87], v[124:127], v[24:27], v[72:87]
    v_mfma_f32_32x32x16_bf16 v[72:87], v[128:131], v[12:15], v[72:87]
    v_mfma_f32_32x32x16_bf16 v[72:87], v[132:135], v[28:31], v[72:87]
    v_mfma_f32_32x32x16_bf16 v[72:87], v[136:139], v[16:19], v[72:87]
    v_mfma_f32_32x32x16_bf16 v[72:87], v[140:143], v[32:35], v[72:87]
    v_mfma_f32_32x32x16_bf16 v[72:87], v[144:147], v[20:23], v[72:87]
    v_mfma_f32_32x32x16_bf16 v[72:87], v[148:151], v[36:39], v[72:87]
    s_waitcnt vmcnt(0)
    s_nop 7
    s_nop 3
    v_lshlrev_b32 v40, 16, v41
    v_bitop3_b32 v41, v41, s35, v1 bitop3:0x6a
    v_mul_f32 v2, v56, v40
    v_fmac_f32_dpp v2, v56, v41 quad_perm:[1,0,3,2] row_mask:0xf bank_mask:0xf
    v_lshlrev_b32 v42, 16, v43
    v_bitop3_b32 v43, v43, s35, v1 bitop3:0x6a
    v_mul_f32 v3, v57, v42
    v_fmac_f32_dpp v3, v57, v43 quad_perm:[1,0,3,2] row_mask:0xf bank_mask:0xf
    v_cvt_pk_bf16_f32 v8, v2, v3
    v_lshlrev_b32 v44, 16, v45
    v_bitop3_b32 v45, v45, s35, v1 bitop3:0x6a
    v_mul_f32 v2, v58, v44
    v_fmac_f32_dpp v2, v58, v45 quad_perm:[1,0,3,2] row_mask:0xf bank_mask:0xf
    v_lshlrev_b32 v46, 16, v47
    v_bitop3_b32 v47, v47, s35, v1 bitop3:0x6a
    v_mul_f32 v3, v59, v46
    v_fmac_f32_dpp v3, v59, v47 quad_perm:[1,0,3,2] row_mask:0xf bank_mask:0xf
    v_cvt_pk_bf16_f32 v9, v2, v3
    v_lshlrev_b32 v48, 16, v49
    v_bitop3_b32 v49, v49, s35, v1 bitop3:0x6a
    v_mul_f32 v2, v60, v48
    v_fmac_f32_dpp v2, v60, v49 quad_perm:[1,0,3,2] row_mask:0xf bank_mask:0xf
    v_lshlrev_b32 v50, 16, v51
    v_bitop3_b32 v51, v51, s35, v1 bitop3:0x6a
    v_mul_f32 v3, v61, v50
    v_fmac_f32_dpp v3, v61, v51 quad_perm:[1,0,3,2] row_mask:0xf bank_mask:0xf
    v_cvt_pk_bf16_f32 v10, v2, v3
    v_lshlrev_b32 v52, 16, v53
    v_bitop3_b32 v53, v53, s35, v1 bitop3:0x6a
    v_mul_f32 v2, v62, v52
    v_fmac_f32_dpp v2, v62, v53 quad_perm:[1,0,3,2] row_mask:0xf bank_mask:0xf
    v_lshlrev_b32 v54, 16, v55
    v_bitop3_b32 v55, v55, s35, v1 bitop3:0x6a
    v_mul_f32 v3, v63, v54
    v_fmac_f32_dpp v3, v63, v55 quad_perm:[1,0,3,2] row_mask:0xf bank_mask:0xf
    v_cvt_pk_bf16_f32 v11, v2, v3
    v_lshlrev_b32 v152, 16, v153
    v_bitop3_b32 v153, v153, s35, v1 bitop3:0x6a
    v_mul_f32 v2, v64, v152
    v_fmac_f32_dpp v2, v64, v153 quad_perm:[1,0,3,2] row_mask:0xf bank_mask:0xf
    v_lshlrev_b32 v154, 16, v155
    v_bitop3_b32 v155, v155, s35, v1 bitop3:0x6a
    v_mul_f32 v3, v65, v154
    v_fmac_f32_dpp v3, v65, v155 quad_perm:[1,0,3,2] row_mask:0xf bank_mask:0xf
    v_cvt_pk_bf16_f32 v12, v2, v3
    v_lshlrev_b32 v156, 16, v157
    v_bitop3_b32 v157, v157, s35, v1 bitop3:0x6a
    v_mul_f32 v2, v66, v156
    v_fmac_f32_dpp v2, v66, v157 quad_perm:[1,0,3,2] row_mask:0xf bank_mask:0xf
    v_lshlrev_b32 v158, 16, v159
    v_bitop3_b32 v159, v159, s35, v1 bitop3:0x6a
    v_mul_f32 v3, v67, v158
    v_fmac_f32_dpp v3, v67, v159 quad_perm:[1,0,3,2] row_mask:0xf bank_mask:0xf
    v_cvt_pk_bf16_f32 v13, v2, v3
    v_lshlrev_b32 v160, 16, v161
    v_bitop3_b32 v161, v161, s35, v1 bitop3:0x6a
    v_mul_f32 v2, v68, v160
    v_fmac_f32_dpp v2, v68, v161 quad_perm:[1,0,3,2] row_mask:0xf bank_mask:0xf
    v_lshlrev_b32 v162, 16, v163
    v_bitop3_b32 v163, v163, s35, v1 bitop3:0x6a
    v_mul_f32 v3, v69, v162
    v_fmac_f32_dpp v3, v69, v163 quad_perm:[1,0,3,2] row_mask:0xf bank_mask:0xf
    v_cvt_pk_bf16_f32 v14, v2, v3
    v_lshlrev_b32 v164, 16, v165
    v_bitop3_b32 v165, v165, s35, v1 bitop3:0x6a
    v_mul_f32 v2, v70, v164
    v_fmac_f32_dpp v2, v70, v165 quad_perm:[1,0,3,2] row_mask:0xf bank_mask:0xf
    v_lshlrev_b32 v166, 16, v167
    v_bitop3_b32 v167, v167, s35, v1 bitop3:0x6a
    v_mul_f32 v3, v71, v166
    v_fmac_f32_dpp v3, v71, v167 quad_perm:[1,0,3,2] row_mask:0xf bank_mask:0xf
    v_cvt_pk_bf16_f32 v15, v2, v3
    s_lshl_b32 s30, s6, 13
    s_add_u32 s30, s30, 4096
    buffer_load_dword v41, v4, s[12:15], s30 offen offset:0
    buffer_load_dword v43, v4, s[12:15], s30 offen offset:128
    buffer_load_dword v45, v4, s[12:15], s30 offen offset:256
    buffer_load_dword v47, v4, s[12:15], s30 offen offset:384
    s_lshl_b32 s30, s6, 13
    s_add_u32 s30, s30, 5120
    buffer_load_dword v49, v4, s[12:15], s30 offen offset:0
    buffer_load_dword v51, v4, s[12:15], s30 offen offset:128
    buffer_load_dword v53, v4, s[12:15], s30 offen offset:256
    buffer_load_dword v55, v4, s[12:15], s30 offen offset:384
    s_lshl_b32 s30, s6, 13
    s_add_u32 s30, s30, 6144
    buffer_load_dword v153, v4, s[12:15], s30 offen offset:0
    buffer_load_dword v155, v4, s[12:15], s30 offen offset:128
    buffer_load_dword v157, v4, s[12:15], s30 offen offset:256
    buffer_load_dword v159, v4, s[12:15], s30 offen offset:384
    s_lshl_b32 s30, s6, 13
    s_add_u32 s30, s30, 7168
    buffer_load_dword v161, v4, s[12:15], s30 offen offset:0
    buffer_load_dword v163, v4, s[12:15], s30 offen offset:128
    buffer_load_dword v165, v4, s[12:15], s30 offen offset:256
    buffer_load_dword v167, v4, s[12:15], s30 offen offset:384
    s_barrier
    s_waitcnt vmcnt(0)
    v_lshlrev_b32 v40, 16, v41
    v_bitop3_b32 v41, v41, s35, v1 bitop3:0x6a
    v_mul_f32 v2, v72, v40
    v_fmac_f32_dpp v2, v72, v41 quad_perm:[1,0,3,2] row_mask:0xf bank_mask:0xf
    v_lshlrev_b32 v42, 16, v43
    v_bitop3_b32 v43, v43, s35, v1 bitop3:0x6a
    v_mul_f32 v3, v73, v42
    v_fmac_f32_dpp v3, v73, v43 quad_perm:[1,0,3,2] row_mask:0xf bank_mask:0xf
    v_cvt_pk_bf16_f32 v16, v2, v3
    v_lshlrev_b32 v44, 16, v45
    v_bitop3_b32 v45, v45, s35, v1 bitop3:0x6a
    v_mul_f32 v2, v74, v44
    v_fmac_f32_dpp v2, v74, v45 quad_perm:[1,0,3,2] row_mask:0xf bank_mask:0xf
    v_lshlrev_b32 v46, 16, v47
    v_bitop3_b32 v47, v47, s35, v1 bitop3:0x6a
    v_mul_f32 v3, v75, v46
    v_fmac_f32_dpp v3, v75, v47 quad_perm:[1,0,3,2] row_mask:0xf bank_mask:0xf
    v_cvt_pk_bf16_f32 v17, v2, v3
    v_lshlrev_b32 v48, 16, v49
    v_bitop3_b32 v49, v49, s35, v1 bitop3:0x6a
    v_mul_f32 v2, v76, v48
    v_fmac_f32_dpp v2, v76, v49 quad_perm:[1,0,3,2] row_mask:0xf bank_mask:0xf
    v_lshlrev_b32 v50, 16, v51
    v_bitop3_b32 v51, v51, s35, v1 bitop3:0x6a
    v_mul_f32 v3, v77, v50
    v_fmac_f32_dpp v3, v77, v51 quad_perm:[1,0,3,2] row_mask:0xf bank_mask:0xf
    v_cvt_pk_bf16_f32 v18, v2, v3
    v_lshlrev_b32 v52, 16, v53
    v_bitop3_b32 v53, v53, s35, v1 bitop3:0x6a
    v_mul_f32 v2, v78, v52
    v_fmac_f32_dpp v2, v78, v53 quad_perm:[1,0,3,2] row_mask:0xf bank_mask:0xf
    v_lshlrev_b32 v54, 16, v55
    v_bitop3_b32 v55, v55, s35, v1 bitop3:0x6a
    v_mul_f32 v3, v79, v54
    v_fmac_f32_dpp v3, v79, v55 quad_perm:[1,0,3,2] row_mask:0xf bank_mask:0xf
    v_cvt_pk_bf16_f32 v19, v2, v3
    v_lshlrev_b32 v152, 16, v153
    v_bitop3_b32 v153, v153, s35, v1 bitop3:0x6a
    v_mul_f32 v2, v80, v152
    v_fmac_f32_dpp v2, v80, v153 quad_perm:[1,0,3,2] row_mask:0xf bank_mask:0xf
    v_lshlrev_b32 v154, 16, v155
    v_bitop3_b32 v155, v155, s35, v1 bitop3:0x6a
    v_mul_f32 v3, v81, v154
    v_fmac_f32_dpp v3, v81, v155 quad_perm:[1,0,3,2] row_mask:0xf bank_mask:0xf
    v_cvt_pk_bf16_f32 v20, v2, v3
    v_lshlrev_b32 v156, 16, v157
    v_bitop3_b32 v157, v157, s35, v1 bitop3:0x6a
    v_mul_f32 v2, v82, v156
    v_fmac_f32_dpp v2, v82, v157 quad_perm:[1,0,3,2] row_mask:0xf bank_mask:0xf
    v_lshlrev_b32 v158, 16, v159
    v_bitop3_b32 v159, v159, s35, v1 bitop3:0x6a
    v_mul_f32 v3, v83, v158
    v_fmac_f32_dpp v3, v83, v159 quad_perm:[1,0,3,2] row_mask:0xf bank_mask:0xf
    v_cvt_pk_bf16_f32 v21, v2, v3
    v_lshlrev_b32 v160, 16, v161
    v_bitop3_b32 v161, v161, s35, v1 bitop3:0x6a
    v_mul_f32 v2, v84, v160
    v_fmac_f32_dpp v2, v84, v161 quad_perm:[1,0,3,2] row_mask:0xf bank_mask:0xf
    v_lshlrev_b32 v162, 16, v163
    v_bitop3_b32 v163, v163, s35, v1 bitop3:0x6a
    v_mul_f32 v3, v85, v162
    v_fmac_f32_dpp v3, v85, v163 quad_perm:[1,0,3,2] row_mask:0xf bank_mask:0xf
    v_cvt_pk_bf16_f32 v22, v2, v3
    v_lshlrev_b32 v164, 16, v165
    v_bitop3_b32 v165, v165, s35, v1 bitop3:0x6a
    v_mul_f32 v2, v86, v164
    v_fmac_f32_dpp v2, v86, v165 quad_perm:[1,0,3,2] row_mask:0xf bank_mask:0xf
    v_lshlrev_b32 v166, 16, v167
    v_bitop3_b32 v167, v167, s35, v1 bitop3:0x6a
    v_mul_f32 v3, v87, v166
    v_fmac_f32_dpp v3, v87, v167 quad_perm:[1,0,3,2] row_mask:0xf bank_mask:0xf
    v_cvt_pk_bf16_f32 v23, v2, v3
    s_nop 1
    v_xor_b32_dpp v24, v8, v7 quad_perm:[1,0,3,2] row_mask:0xf bank_mask:0xf
    v_xor_b32_dpp v25, v9, v7 quad_perm:[1,0,3,2] row_mask:0xf bank_mask:0xf
    v_xor_b32_dpp v26, v10, v7 quad_perm:[1,0,3,2] row_mask:0xf bank_mask:0xf
    v_xor_b32_dpp v27, v11, v7 quad_perm:[1,0,3,2] row_mask:0xf bank_mask:0xf
    v_xor_b32_dpp v28, v12, v7 quad_perm:[1,0,3,2] row_mask:0xf bank_mask:0xf
    v_xor_b32_dpp v29, v13, v7 quad_perm:[1,0,3,2] row_mask:0xf bank_mask:0xf
    v_xor_b32_dpp v30, v14, v7 quad_perm:[1,0,3,2] row_mask:0xf bank_mask:0xf
    v_xor_b32_dpp v31, v15, v7 quad_perm:[1,0,3,2] row_mask:0xf bank_mask:0xf
    v_xor_b32_dpp v32, v16, v7 quad_perm:[1,0,3,2] row_mask:0xf bank_mask:0xf
    v_xor_b32_dpp v33, v17, v7 quad_perm:[1,0,3,2] row_mask:0xf bank_mask:0xf
    v_xor_b32_dpp v34, v18, v7 quad_perm:[1,0,3,2] row_mask:0xf bank_mask:0xf
    v_xor_b32_dpp v35, v19, v7 quad_perm:[1,0,3,2] row_mask:0xf bank_mask:0xf
    v_xor_b32_dpp v36, v20, v7 quad_perm:[1,0,3,2] row_mask:0xf bank_mask:0xf
    v_xor_b32_dpp v37, v21, v7 quad_perm:[1,0,3,2] row_mask:0xf bank_mask:0xf
    v_xor_b32_dpp v38, v22, v7 quad_perm:[1,0,3,2] row_mask:0xf bank_mask:0xf
    v_xor_b32_dpp v39, v23, v7 quad_perm:[1,0,3,2] row_mask:0xf bank_mask:0xf
    s_lshl_b32 s30, s5, 13
    s_add_u32 s30, s30, 57344
    buffer_load_dwordx4 v[40:43], v5, s[20:23], s30 offen offset:0
    buffer_load_dwordx4 v[44:47], v5, s[20:23], s30 offen offset:1024
    buffer_load_dwordx4 v[48:51], v5, s[20:23], s30 offen offset:2048
    buffer_load_dwordx4 v[52:55], v5, s[20:23], s30 offen offset:3072
    s_lshl_b32 s30, s5, 13
    s_add_u32 s30, s30, 61440
    buffer_load_dwordx4 v[152:155], v5, s[20:23], s30 offen offset:0
    buffer_load_dwordx4 v[156:159], v5, s[20:23], s30 offen offset:1024
    buffer_load_dwordx4 v[160:163], v5, s[20:23], s30 offen offset:2048
    buffer_load_dwordx4 v[164:167], v5, s[20:23], s30 offen offset:3072
    v_mfma_f32_32x32x16_bf16 v[56:71], v[8:11], v[88:91], 0
    v_mfma_f32_32x32x16_bf16 v[56:71], v[24:27], v[92:95], v[56:71]
    v_mfma_f32_32x32x16_bf16 v[56:71], v[12:15], v[96:99], v[56:71]
    v_mfma_f32_32x32x16_bf16 v[56:71], v[28:31], v[100:103], v[56:71]
    v_mfma_f32_32x32x16_bf16 v[56:71], v[16:19], v[104:107], v[56:71]
    v_mfma_f32_32x32x16_bf16 v[56:71], v[32:35], v[108:111], v[56:71]
    v_mfma_f32_32x32x16_bf16 v[56:71], v[20:23], v[112:115], v[56:71]
    v_mfma_f32_32x32x16_bf16 v[56:71], v[36:39], v[116:119], v[56:71]
    v_mfma_f32_32x32x16_bf16 v[72:87], v[8:11], v[120:123], 0
    v_mfma_f32_32x32x16_bf16 v[72:87], v[24:27], v[124:127], v[72:87]
    v_mfma_f32_32x32x16_bf16 v[72:87], v[12:15], v[128:131], v[72:87]
    v_mfma_f32_32x32x16_bf16 v[72:87], v[28:31], v[132:135], v[72:87]
    v_mfma_f32_32x32x16_bf16 v[72:87], v[16:19], v[136:139], v[72:87]
    v_mfma_f32_32x32x16_bf16 v[72:87], v[32:35], v[140:143], v[72:87]
    v_mfma_f32_32x32x16_bf16 v[72:87], v[20:23], v[144:147], v[72:87]
    v_mfma_f32_32x32x16_bf16 v[72:87], v[36:39], v[148:151], v[72:87]
    s_barrier
    s_mov_b32 s30, 73728
    buffer_load_dwordx4 v[88:91], v5, s[20:23], s30 offen offset:0
    buffer_load_dwordx4 v[92:95], v5, s[20:23], s30 offen offset:1024
    buffer_load_dwordx4 v[96:99], v5, s[20:23], s30 offen offset:2048
    buffer_load_dwordx4 v[100:103], v5, s[20:23], s30 offen offset:3072
    s_mov_b32 s30, 77824
    buffer_load_dwordx4 v[104:107], v5, s[20:23], s30 offen offset:0
    buffer_load_dwordx4 v[108:111], v5, s[20:23], s30 offen offset:1024
    buffer_load_dwordx4 v[112:115], v5, s[20:23], s30 offen offset:2048
    buffer_load_dwordx4 v[116:119], v5, s[20:23], s30 offen offset:3072
    s_waitcnt vmcnt(8)
    s_nop 7
    s_cmp_eq_u32 s6, 0
    s_cbranch_scc1 K2f_hs
    s_cmp_eq_u32 s6, 288
    s_cbranch_scc0 K2f_nhs
K2f_hs:
    v_mul_f32 v40, 0.5, v40
    v_mul_f32 v41, 0.5, v41
    v_mul_f32 v42, 0.5, v42
    v_mul_f32 v43, 0.5, v43
    v_mul_f32 v44, 0.5, v44
    v_mul_f32 v45, 0.5, v45
    v_mul_f32 v46, 0.5, v46
    v_mul_f32 v47, 0.5, v47
    v_mul_f32 v48, 0.5, v48
    v_mul_f32 v49, 0.5, v49
    v_mul_f32 v50, 0.5, v50
    v_mul_f32 v51, 0.5, v51
    v_mul_f32 v52, 0.5, v52
    v_mul_f32 v53, 0.5, v53
    v_mul_f32 v54, 0.5, v54
    v_mul_f32 v55, 0.5, v55
    v_mul_f32 v152, 0.5, v152
    v_mul_f32 v153, 0.5, v153
    v_mul_f32 v154, 0.5, v154
    v_mul_f32 v155, 0.5, v155
    v_mul_f32 v156, 0.5, v156
    v_mul_f32 v157, 0.5, v157
    v_mul_f32 v158, 0.5, v158
    v_mul_f32 v159, 0.5, v159
    v_mul_f32 v160, 0.5, v160
    v_mul_f32 v161, 0.5, v161
    v_mul_f32 v162, 0.5, v162
    v_mul_f32 v163, 0.5, v163
    v_mul_f32 v164, 0.5, v164
    v_mul_f32 v165, 0.5, v165
    v_mul_f32 v166, 0.5, v166
    v_mul_f32 v167, 0.5, v167
K2f_nhs:
    v_mul_f32 v2, v56, v40
    v_mul_f32 v3, v57, v40
    v_fma_f32 v2, -v57, v41, v2
    v_fma_f32 v3, v56, v41, v3
    v_cvt_pk_bf16_f32 v8, v2, v3
    v_mul_f32 v2, v58, v42
    v_mul_f32 v3, v59, v42
    v_fma_f32 v2, -v59, v43, v2
    v_fma_f32 v3, v58, v43, v3
    v_cvt_pk_bf16_f32 v9, v2, v3
    v_mul_f32 v2, v60, v44
    v_mul_f32 v3, v61, v44
    v_fma_f32 v2, -v61, v45, v2
    v_fma_f32 v3, v60, v45, v3
    v_cvt_pk_bf16_f32 v10, v2, v3
    v_mul_f32 v2, v62, v46
    v_mul_f32 v3, v63, v46
    v_fma_f32 v2, -v63, v47, v2
    v_fma_f32 v3, v62, v47, v3
    v_cvt_pk_bf16_f32 v11, v2, v3
    v_mul_f32 v2, v64, v48
    v_mul_f32 v3, v65, v48
    v_fma_f32 v2, -v65, v49, v2
    v_fma_f32 v3, v64, v49, v3
    v_cvt_pk_bf16_f32 v12, v2, v3
    v_mul_f32 v2, v66, v50
    v_mul_f32 v3, v67, v50
    v_fma_f32 v2, -v67, v51, v2
    v_fma_f32 v3, v66, v51, v3
    v_cvt_pk_bf16_f32 v13, v2, v3
    v_mul_f32 v2, v68, v52
    v_mul_f32 v3, v69, v52
    v_fma_f32 v2, -v69, v53, v2
    v_fma_f32 v3, v68, v53, v3
    v_cvt_pk_bf16_f32 v14, v2, v3
    v_mul_f32 v2, v70, v54
    v_mul_f32 v3, v71, v54
    v_fma_f32 v2, -v71, v55, v2
    v_fma_f32 v3, v70, v55, v3
    v_cvt_pk_bf16_f32 v15, v2, v3
    v_mul_f32 v2, v72, v152
    v_mul_f32 v3, v73, v152
    v_fma_f32 v2, -v73, v153, v2
    v_fma_f32 v3, v72, v153, v3
    v_cvt_pk_bf16_f32 v16, v2, v3
    v_mul_f32 v2, v74, v154
    v_mul_f32 v3, v75, v154
    v_fma_f32 v2, -v75, v155, v2
    v_fma_f32 v3, v74, v155, v3
    v_cvt_pk_bf16_f32 v17, v2, v3
    v_mul_f32 v2, v76, v156
    v_mul_f32 v3, v77, v156
    v_fma_f32 v2, -v77, v157, v2
    v_fma_f32 v3, v76, v157, v3
    v_cvt_pk_bf16_f32 v18, v2, v3
    v_mul_f32 v2, v78, v158
    v_mul_f32 v3, v79, v158
    v_fma_f32 v2, -v79, v159, v2
    v_fma_f32 v3, v78, v159, v3
    v_cvt_pk_bf16_f32 v19, v2, v3
    v_mul_f32 v2, v80, v160
    v_mul_f32 v3, v81, v160
    v_fma_f32 v2, -v81, v161, v2
    v_fma_f32 v3, v80, v161, v3
    v_cvt_pk_bf16_f32 v20, v2, v3
    v_mul_f32 v2, v82, v162
    v_mul_f32 v3, v83, v162
    v_fma_f32 v2, -v83, v163, v2
    v_fma_f32 v3, v82, v163, v3
    v_cvt_pk_bf16_f32 v21, v2, v3
    v_mul_f32 v2, v84, v164
    v_mul_f32 v3, v85, v164
    v_fma_f32 v2, -v85, v165, v2
    v_fma_f32 v3, v84, v165, v3
    v_cvt_pk_bf16_f32 v22, v2, v3
    v_mul_f32 v2, v86, v166
    v_mul_f32 v3, v87, v166
    v_fma_f32 v2, -v87, v167, v2
    v_fma_f32 v3, v86, v167, v3
    v_cvt_pk_bf16_f32 v23, v2, v3
    s_sub_u32 s30, s3, 8
    s_lshl_b32 s30, s30, 11
    s_add_u32 s30, s30, 61440
    v_add_u32 v2, s30, v5
    s_cmp_eq_u32 s5, 0
    s_cbranch_scc1 K2f_w0
    ds_write_b128 v2, v[8:11]
    ds_write_b128 v2, v[12:15] offset:1024
    v_mov_b32 v32, v16
    v_mov_b32 v33, v17
    v_mov_b32 v34, v18
    v_mov_b32 v35, v19
    v_mov_b32 v36, v20
    v_mov_b32 v37, v21
    v_mov_b32 v38, v22
    v_mov_b32 v39, v23
    s_branch K2f_wj
K2f_w0:
    ds_write_b128 v2, v[16:19]
    ds_write_b128 v2, v[20:23] offset:1024
    v_mov_b32 v24, v8
    v_mov_b32 v25, v9
    v_mov_b32 v26, v10
    v_mov_b32 v27, v11
    v_mov_b32 v28, v12
    v_mov_b32 v29, v13
    v_mov_b32 v30, v14
    v_mov_b32 v31, v15
K2f_wj:
    s_waitcnt lgkmcnt(0)
    s_barrier
    v_xor_b32 v2, 2048, v2
    s_cmp_eq_u32 s5, 0
    s_cbranch_scc1 K2f_r0
    ds_read_b128 v[24:27], v2
    ds_read_b128 v[28:31], v2 offset:1024
    s_branch K2f_rj
K2f_r0:
    ds_read_b128 v[32:35], v2
    ds_read_b128 v[36:39], v2 offset:1024
K2f_rj:
    s_waitcnt vmcnt(0) lgkmcnt(0)
    v_mfma_f32_32x32x16_bf16 v[56:71], v[24:27], v[88:91], 0
    v_mfma_f32_32x32x16_bf16 v[56:71], v[28:31], v[92:95], v[56:71]
    v_mfma_f32_32x32x16_bf16 v[56:71], v[32:35], v[96:99], v[56:71]
    v_mfma_f32_32x32x16_bf16 v[56:71], v[36:39], v[100:103], v[56:71]
    v_mfma_f32_32x32x16_bf16 v[72:87], v[24:27], v[104:107], 0
    v_mfma_f32_32x32x16_bf16 v[72:87], v[28:31], v[108:111], v[72:87]
    v_mfma_f32_32x32x16_bf16 v[72:87], v[32:35], v[112:115], v[72:87]
    v_mfma_f32_32x32x16_bf16 v[72:87], v[36:39], v[116:119], v[72:87]
    v_and_b32 v2, 31, v0
    v_lshrrev_b32 v3, 1, v2
    v_lshlrev_b32 v3, 7, v3
    v_lshrrev_b32 v4, 5, v0
    v_lshl_add_u32 v3, v4, 3, v3
    v_and_b32 v2, 1, v2
    s_lshl_b32 s31, s5, 6
    s_add_u32 s31, s31, s28
    s_cmp_eq_u32 s6, 0
    s_cbranch_scc1 K2f_st0
    s_cmp_eq_u32 s6, 288
    s_cbranch_scc1 K2f_st288
    v_lshl_add_u32 v3, v2, 12, v3
    s_branch K2f_stj
K2f_st288:
    v_add_u32 v3, 4096, v3
K2f_st0:
    v_cmp_eq_u32 vcc, 0, v2
    s_nop 1
    s_and_b64 exec, exec, vcc
K2f_stj:
    s_nop 7
    v_cvt_pk_bf16_f32 v8, v56, v57
    v_cvt_pk_bf16_f32 v9, v58, v59
    buffer_store_dwordx2 v[8:9], v3, s[16:19], s31 offen offset:0
    v_cvt_pk_bf16_f32 v10, v60, v61
    v_cvt_pk_bf16_f32 v11, v62, v63
    buffer_store_dwordx2 v[10:11], v3, s[16:19], s31 offen offset:16
    v_cvt_pk_bf16_f32 v12, v64, v65
    v_cvt_pk_bf16_f32 v13, v66, v67
    buffer_store_dwordx2 v[12:13], v3, s[16:19], s31 offen offset:32
    v_cvt_pk_bf16_f32 v14, v68, v69
    v_cvt_pk_bf16_f32 v15, v70, v71
    buffer_store_dwordx2 v[14:15], v3, s[16:19], s31 offen offset:48
    v_cvt_pk_bf16_f32 v16, v72, v73
    v_cvt_pk_bf16_f32 v17, v74, v75
    buffer_store_dwordx2 v[16:17], v3, s[16:19], s31 offen offset:2048
    v_cvt_pk_bf16_f32 v18, v76, v77
    v_cvt_pk_bf16_f32 v19, v78, v79
    buffer_store_dwordx2 v[18:19], v3, s[16:19], s31 offen offset:2064
    v_cvt_pk_bf16_f32 v20, v80, v81
    v_cvt_pk_bf16_f32 v21, v82, v83
    buffer_store_dwordx2 v[20:21], v3, s[16:19], s31 offen offset:2080
    v_cvt_pk_bf16_f32 v22, v84, v85
    v_cvt_pk_bf16_f32 v23, v86, v87
    buffer_store_dwordx2 v[22:23], v3, s[16:19], s31 offen offset:2096
    s_endpgm
K2_end:
    s_endpgm

.globl k3_kernel
.p2align 8
.type k3_kernel,@function
k3_kernel:
    s_cmp_ge_u32 s2, 192
    s_cbranch_scc1 K3_end
    s_load_dwordx2 s[36:37], s[0:1], 56
    s_load_dwordx2 s[38:39], s[0:1], 64
    s_load_dwordx2 s[40:41], s[0:1], 80
    v_lshrrev_b32 v1, 6, v0
    s_nop 0
    v_readfirstlane_b32 s35, v1
    v_and_b32 v0, 63, v0
    s_and_b32 s30, s35, 3
    s_cmp_ge_u32 s2, 96
    s_cbranch_scc1 K3_ai
    s_lshr_b32 s27, s2, 3
    s_and_b32 s28, s2, 7
    s_lshl_b32 s28, s28, 1
    s_cmp_ge_u32 s27, 6
    s_cselect_b32 s29, 1, 0
    s_add_u32 s28, s28, s29
    s_lshl_b32 s31, s28, 7
    s_mul_i32 s29, s29, 6
    s_sub_u32 s27, s27, s29
    s_mul_i32 s32, s27, 96
    s_waitcnt lgkmcnt(0)
    s_add_u32 s8, s40, 12320768
    s_addc_u32 s9, s41, 0
    s_mov_b32 s10, 2359296
    s_mov_b32 s11, 0x00020000
    s_mov_b32 s12, s36
    s_mov_b32 s13, s37
    s_mov_b32 s14, 663552
    s_mov_b32 s15, 0x00020000
    s_mov_b32 s16, s38
    s_mov_b32 s17, s39
    s_mov_b32 s18, 4718592
    s_mov_b32 s19, 0x00020000
    s_mul_i32 s33, s31, 2304
    s_lshl_b32 s34, s32, 1
    s_add_u32 s33, s33, s34
    s_add_u32 s33, s33, 1152
    s_cmp_ge_u32 s35, 4
    s_cbranch_scc1 K3o_ld
    v_and_b32 v144, 31, v0
    v_lshrrev_b32 v145, 5, v0
    v_lshrrev_b32 v146, 1, v144
    v_and_b32 v146, 7, v146
    v_xor_b32 v146, v146, v145
    v_lshlrev_b32 v147, 7, v144
    s_lshl_b32 s27, s30, 12
    v_add_u32 v147, s27, v147
    v_xor_b32 v148, 0, v146
    v_lshl_add_u32 v12, v148, 4, v147
    v_xor_b32 v148, 2, v146
    v_lshl_add_u32 v13, v148, 4, v147
    v_xor_b32 v148, 4, v146
    v_lshl_add_u32 v14, v148, 4, v147
    v_xor_b32 v148, 6, v146
    v_lshl_add_u32 v15, v148, 4, v147
    v_lshrrev_b32 v144, 5, v0
    v_lshlrev_b32 v144, 3, v144
    v_bfe_u32 v145, v0, 2, 2
    v_add_u32 v144, v144, v145
    v_lshlrev_b32 v144, 6, v144
    v_bfe_u32 v145, v0, 4, 1
    v_lshl_add_u32 v144, v145, 5, v144
    v_and_b32 v145, 3, v0
    v_lshl_add_u32 v144, v145, 3, v144
    v_add_u32 v16, 16384, v144
    v_mov_b32 v96, 0
    v_mov_b32 v97, 0
    v_mov_b32 v98, 0
    v_mov_b32 v99, 0
    v_mov_b32 v100, 0
    v_mov_b32 v101, 0
    v_mov_b32 v102, 0
    v_mov_b32 v103, 0
    v_mov_b32 v104, 0
    v_mov_b32 v105, 0
    v_mov_b32 v106, 0
    v_mov_b32 v107, 0
    v_mov_b32 v108, 0
    v_mov_b32 v109, 0
    v_mov_b32 v110, 0
    v_mov_b32 v111, 0
    v_mov_b32 v112, 0
    v_mov_b32 v113, 0
    v_mov_b32 v114, 0
    v_mov_b32 v115, 0
    v_mov_b32 v116, 0
    v_mov_b32 v117, 0
    v_mov_b32 v118, 0
    v_mov_b32 v119, 0
    v_mov_b32 v120, 0
    v_mov_b32 v121, 0
    v_mov_b32 v122, 0
    v_mov_b32 v123, 0
    v_mov_b32 v124, 0
    v_mov_b32 v125, 0
    v_mov_b32 v126, 0
    v_mov_b32 v127, 0
    v_mov_b32 v128, 0
    v_mov_b32 v129, 0
    v_mov_b32 v130, 0
    v_mov_b32 v131, 0
    v_mov_b32 v132, 0
    v_mov_b32 v133, 0
    v_mov_b32 v134, 0
    v_mov_b32 v135, 0
    v_mov_b32 v136, 0
    v_mov_b32 v137, 0
    v_mov_b32 v138, 0
    v_mov_b32 v139, 0
    v_mov_b32 v140, 0
    v_mov_b32 v141, 0
    v_mov_b32 v142, 0
    v_mov_b32 v143, 0
    s_mov_b32 s21, 0
    s_mov_b32 s20, 0
    v_add_u32 v20, s21, v12
    v_add_u32 v21, s21, v13
    v_add_u32 v22, s21, v14
    v_add_u32 v23, s21, v15
    v_add_u32 v24, s21, v16
    s_barrier
    ds_read_b128 v[32:35], v20
    ds_read_b64_tr_b16 v[36:37], v24 offset:0
    ds_read_b64_tr_b16 v[38:39], v24 offset:256
    ds_read_b64_tr_b16 v[40:41], v24 offset:4096
    ds_read_b64_tr_b16 v[42:43], v24 offset:4352
    ds_read_b64_tr_b16 v[44:45], v24 offset:8192
    ds_read_b64_tr_b16 v[46:47], v24 offset:8448
    ds_read_b128 v[48:51], v21
    ds_read_b64_tr_b16 v[52:53], v24 offset:1024
    ds_read_b64_tr_b16 v[54:55], v24 offset:1280
    ds_read_b64_tr_b16 v[56:57], v24 offset:5120
    ds_read_b64_tr_b16 v[58:59], v24 offset:5376
    ds_read_b64_tr_b16 v[60:61], v24 offset:9216
    ds_read_b64_tr_b16 v[62:63], v24 offset:9472
K3o_loop:
    s_barrier
    s_waitcnt lgkmcnt(7)
    v_mfma_f32_32x32x16_bf16 v[96:111], v[36:39], v[32:35], v[96:111]
    ds_read_b128 v[64:67], v22
    ds_read_b64_tr_b16 v[68:69], v24 offset:2048
    ds_read_b64_tr_b16 v[70:71], v24 offset:2304
    v_mfma_f32_32x32x16_bf16 v[112:127], v[40:43], v[32:35], v[112:127]
    ds_read_b64_tr_b16 v[72:73], v24 offset:6144
    ds_read_b64_tr_b16 v[74:75], v24 offset:6400
    ds_read_b64_tr_b16 v[76:77], v24 offset:10240
    v_mfma_f32_32x32x16_bf16 v[128:143], v[44:47], v[32:35], v[128:143]
    ds_read_b64_tr_b16 v[78:79], v24 offset:10496
    s_waitcnt lgkmcnt(7)
    v_mfma_f32_32x32x16_bf16 v[96:111], v[52:55], v[48:51], v[96:111]
    ds_read_b128 v[80:83], v23
    ds_read_b64_tr_b16 v[84:85], v24 offset:3072
    ds_read_b64_tr_b16 v[86:87], v24 offset:3328
    v_mfma_f32_32x32x16_bf16 v[112:127], v[56:59], v[48:51], v[112:127]
    ds_read_b64_tr_b16 v[88:89], v24 offset:7168
    ds_read_b64_tr_b16 v[90:91], v24 offset:7424
    ds_read_b64_tr_b16 v[92:93], v24 offset:11264
    v_mfma_f32_32x32x16_bf16 v[128:143], v[60:63], v[48:51], v[128:143]
    ds_read_b64_tr_b16 v[94:95], v24 offset:11520
    s_add_u32 s21, s21, 28672
    s_cmp_ge_u32 s21, 143360
    s_cselect_b32 s21, 0, s21
    v_add_u32 v20, s21, v12
    v_add_u32 v21, s21, v13
    v_add_u32 v22, s21, v14
    v_add_u32 v23, s21, v15
    v_add_u32 v24, s21, v16
    s_waitcnt lgkmcnt(7)
    v_mfma_f32_32x32x16_bf16 v[96:111], v[68:71], v[64:67], v[96:111]
    ds_read_b128 v[32:35], v20
    ds_read_b64_tr_b16 v[36:37], v24 offset:0
    ds_read_b64_tr_b16 v[38:39], v24 offset:256
    v_mfma_f32_32x32x16_bf16 v[112:127], v[72:75], v[64:67], v[112:127]
    ds_read_b64_tr_b16 v[40:41], v24 offset:4096
    ds_read_b64_tr_b16 v[42:43], v24 offset:4352
    ds_read_b64_tr_b16 v[44:45], v24 offset:8192
    v_mfma_f32_32x32x16_bf16 v[128:143], v[76:79], v[64:67], v[128:143]
    ds_read_b64_tr_b16 v[46:47], v24 offset:8448
    s_waitcnt lgkmcnt(7)
    v_mfma_f32_32x32x16_bf16 v[96:111], v[84:87], v[80:83], v[96:111]
    ds_read_b128 v[48:51], v21
    ds_read_b64_tr_b16 v[52:53], v24 offset:1024
    ds_read_b64_tr_b16 v[54:55], v24 offset:1280
    v_mfma_f32_32x32x16_bf16 v[112:127], v[88:91], v[80:83], v[112:127]
    ds_read_b64_tr_b16 v[56:57], v24 offset:5120
    ds_read_b64_tr_b16 v[58:59], v24 offset:5376
    ds_read_b64_tr_b16 v[60:61], v24 offset:9216
    v_mfma_f32_32x32x16_bf16 v[128:143], v[92:95], v[80:83], v[128:143]
    ds_read_b64_tr_b16 v[62:63], v24 offset:9472
    s_add_u32 s20, s20, 1
    s_cmp_lt_u32 s20, 9
    s_cbranch_scc1 K3o_loop
    s_waitcnt lgkmcnt(0)
    s_nop 7
    s_nop 7
    v_and_b32 v144, 31, v0
    s_lshl_b32 s27, s30, 5
    v_add_u32 v144, s27, v144
    v_mul_u32_u24 v144, 208, v144
    v_lshrrev_b32 v145, 5, v0
    v_lshl_add_u32 v144, v145, 3, v144
    v_cvt_pk_bf16_f32 v146, v96, v97
    v_cvt_pk_bf16_f32 v147, v98, v99
    s_barrier
    ds_write_b64 v144, v[146:147] offset:0
    v_cvt_pk_bf16_f32 v148, v100, v101
    v_cvt_pk_bf16_f32 v149, v102, v103
    ds_write_b64 v144, v[148:149] offset:16
    v_cvt_pk_bf16_f32 v150, v104, v105
    v_cvt_pk_bf16_f32 v151, v106, v107
    ds_write_b64 v144, v[150:151] offset:32
    v_cvt_pk_bf16_f32 v152, v108, v109
    v_cvt_pk_bf16_f32 v153, v110, v111
    ds_write_b64 v144, v[152:153] offset:48
    v_cvt_pk_bf16_f32 v146, v112, v113
    v_cvt_pk_bf16_f32 v147, v114, v115
    ds_write_b64 v144, v[146:147] offset:64
    v_cvt_pk_bf16_f32 v148, v116, v117
    v_cvt_pk_bf16_f32 v149, v118, v119
    ds_write_b64 v144, v[148:149] offset:80
    v_cvt_pk_bf16_f32 v150, v120, v121
    v_cvt_pk_bf16_f32 v151, v122, v123
    ds_write_b64 v144, v[150:151] offset:96
    v_cvt_pk_bf16_f32 v152, v124, v125
    v_cvt_pk_bf16_f32 v153, v126, v127
    ds_write_b64 v144, v[152:153] offset:112
    v_cvt_pk_bf16_f32 v146, v128, v129
    v_cvt_pk_bf16_f32 v147, v130, v131
    ds_write_b64 v144, v[146:147] offset:128
    v_cvt_pk_bf16_f32 v148, v132, v133
    v_cvt_pk_bf16_f32 v149, v134, v135
    ds_write_b64 v144, v[148:149] offset:144
    v_cvt_pk_bf16_f32 v150, v136, v137
    v_cvt_pk_bf16_f32 v151, v138, v139
    ds_write_b64 v144, v[150:151] offset:160
    v_cvt_pk_bf16_f32 v152, v140, v141
    v_cvt_pk_bf16_f32 v153, v142, v143
    ds_write_b64 v144, v[152:153] offset:176
    s_waitcnt lgkmcnt(0)
    s_barrier
    s_branch K3o_st
K3o_ld:
    v_lshrrev_b32 v144, 3, v0
    v_and_b32 v145, 7, v0
    v_add_u32 v146, 0, v144
    v_lshrrev_b32 v147, 1, v146
    v_and_b32 v147, 7, v147
    v_xor_b32 v147, v147, v145
    s_lshl_b32 s27, s30, 5
    s_add_u32 s27, s27, s31
    v_add_u32 v146, s27, v146
    s_movk_i32 s28, 1152
    v_mul_lo_u32 v146, v146, s28
    v_lshl_add_u32 v2, v147, 4, v146
    v_add_u32 v146, 8, v144
    v_lshrrev_b32 v147, 1, v146
    v_and_b32 v147, 7, v147
    v_xor_b32 v147, v147, v145
    s_lshl_b32 s27, s30, 5
    s_add_u32 s27, s27, s31
    v_add_u32 v146, s27, v146
    s_movk_i32 s28, 1152
    v_mul_lo_u32 v146, v146, s28
    v_lshl_add_u32 v3, v147, 4, v146
    v_add_u32 v146, 16, v144
    v_lshrrev_b32 v147, 1, v146
    v_and_b32 v147, 7, v147
    v_xor_b32 v147, v147, v145
    s_lshl_b32 s27, s30, 5
    s_add_u32 s27, s27, s31
    v_add_u32 v146, s27, v146
    s_movk_i32 s28, 1152
    v_mul_lo_u32 v146, v146, s28
    v_lshl_add_u32 v4, v147, 4, v146
    v_add_u32 v146, 24, v144
    v_lshrrev_b32 v147, 1, v146
    v_and_b32 v147, 7, v147
    v_xor_b32 v147, v147, v145
    s_lshl_b32 s27, s30, 5
    s_add_u32 s27, s27, s31
    v_add_u32 v146, s27, v146
    s_movk_i32 s28, 1152
    v_mul_lo_u32 v146, v146, s28
    v_lshl_add_u32 v5, v147, 4, v146
    v_lshrrev_b32 v144, 2, v0
    v_and_b32 v145, 3, v0
    v_lshlrev_b32 v145, 4, v145
    s_mov_b32 s28, 1152
    s_lshl_b32 s27, s30, 4
    v_add_u32 v144, s27, v144
    v_mul_lo_u32 v146, v144, s28
    v_add_u32 v146, v146, v145
    s_lshl_b32 s27, s32, 1
    v_add_u32 v6, s27, v146
    v_add_u32 v7, 64, v6
    v_add_u32 v8, 128, v6
    s_mov_b32 s22, 0
    s_mov_b32 s23, 0
    s_mov_b32 s24, 0
    s_mov_b32 s20, 0
K3o_pro:
    s_lshl_b32 s27, s30, 12
    s_add_u32 s27, s27, s22
    s_add_u32 m0, s27, 0
    s_nop 0
    buffer_load_dwordx4 v2, s[8:11], s23 offen lds
    s_add_u32 m0, s27, 1024
    s_nop 0
    buffer_load_dwordx4 v3, s[8:11], s23 offen lds
    s_add_u32 m0, s27, 2048
    s_nop 0
    buffer_load_dwordx4 v4, s[8:11], s23 offen lds
    s_add_u32 m0, s27, 3072
    s_nop 0
    buffer_load_dwordx4 v5, s[8:11], s23 offen lds
    s_lshl_b32 s27, s30, 10
    s_add_u32 s27, s27, s22
    s_add_u32 m0, s27, 16384
    s_nop 0
    buffer_load_dwordx4 v6, s[12:15], s24 offen lds
    s_add_u32 m0, s27, 20480
    s_nop 0
    buffer_load_dwordx4 v7, s[12:15], s24 offen lds
    s_add_u32 m0, s27, 24576
    s_nop 0
    buffer_load_dwordx4 v8, s[12:15], s24 offen lds
    s_add_u32 s22, s22, 28672
    s_add_u32 s23, s23, 128
    s_add_u32 s24, s24, 73728
    s_add_u32 s20, s20, 1
    s_cmp_lt_u32 s20, 4
    s_cbranch_scc1 K3o_pro
    s_mov_b32 s20, 0
    s_waitcnt vmcnt(21)
    s_barrier
K3o_lloop:
    s_waitcnt vmcnt(14)
    s_barrier
    s_lshl_b32 s27, s30, 12
    s_add_u32 s27, s27, s22
    s_add_u32 m0, s27, 0
    s_nop 0
    buffer_load_dwordx4 v2, s[8:11], s23 offen lds
    s_add_u32 m0, s27, 1024
    s_nop 0
    buffer_load_dwordx4 v3, s[8:11], s23 offen lds
    s_add_u32 m0, s27, 2048
    s_nop 0
    buffer_load_dwordx4 v4, s[8:11], s23 offen lds
    s_add_u32 m0, s27, 3072
    s_nop 0
    buffer_load_dwordx4 v5, s[8:11], s23 offen lds
    s_lshl_b32 s27, s30, 10
    s_add_u32 s27, s27, s22
    s_add_u32 m0, s27, 16384
    s_nop 0
    buffer_load_dwordx4 v6, s[12:15], s24 offen lds
    s_add_u32 m0, s27, 20480
    s_nop 0
    buffer_load_dwordx4 v7, s[12:15], s24 offen lds
    s_add_u32 m0, s27, 24576
    s_nop 0
    buffer_load_dwordx4 v8, s[12:15], s24 offen lds
    s_add_u32 s22, s22, 28672
    s_cmp_ge_u32 s22, 143360
    s_cselect_b32 s22, 0, s22
    s_add_u32 s23, s23, 128
    s_add_u32 s24, s24, 73728
    s_add_u32 s20, s20, 1
    s_cmp_lt_u32 s20, 5
    s_cbranch_scc1 K3o_lloop
    s_waitcnt vmcnt(14)
    s_barrier
    s_waitcnt vmcnt(7)
    s_barrier
    s_waitcnt vmcnt(0)
    s_barrier
    s_barrier
    s_lshl_b32 s27, s35, 6
    v_add_u32 v144, s27, v0
    v_add_u32 v147, 0, v144
    v_mul_u32_u24 v145, 5462, v147
    v_lshrrev_b32 v145, 16, v145
    v_mul_u32_u24 v146, 12, v145
    v_sub_u32 v146, v147, v146
    v_lshlrev_b32 v146, 4, v146
    v_mul_u32_u24 v148, 208, v145
    v_add_u32 v148, v148, v146
    v_mul_u32_u24 v152, 2304, v145
    v_add_u32 v152, v152, v146
    v_add_u32 v147, 512, v144
    v_mul_u32_u24 v145, 5462, v147
    v_lshrrev_b32 v145, 16, v145
    v_mul_u32_u24 v146, 12, v145
    v_sub_u32 v146, v147, v146
    v_lshlrev_b32 v146, 4, v146
    v_mul_u32_u24 v149, 208, v145
    v_add_u32 v149, v149, v146
    v_mul_u32_u24 v153, 2304, v145
    v_add_u32 v153, v153, v146
    v_add_u32 v147, 1024, v144
    v_mul_u32_u24 v145, 5462, v147
    v_lshrrev_b32 v145, 16, v145
    v_mul_u32_u24 v146, 12, v145
    v_sub_u32 v146, v147, v146
    v_lshlrev_b32 v146, 4, v146
    v_mul_u32_u24 v150, 208, v145
    v_add_u32 v150, v150, v146
    v_mul_u32_u24 v154, 2304, v145
    v_add_u32 v154, v154, v146
    s_barrier
    s_barrier
    s_branch K3o_st2
K3o_st:
    s_lshl_b32 s27, s35, 6
    v_add_u32 v144, s27, v0
    v_add_u32 v147, 0, v144
    v_mul_u32_u24 v145, 5462, v147
    v_lshrrev_b32 v145, 16, v145
    v_mul_u32_u24 v146, 12, v145
    v_sub_u32 v146, v147, v146
    v_lshlrev_b32 v146, 4, v146
    v_mul_u32_u24 v148, 208, v145
    v_add_u32 v148, v148, v146
    v_mul_u32_u24 v152, 2304, v145
    v_add_u32 v152, v152, v146
    v_add_u32 v147, 512, v144
    v_mul_u32_u24 v145, 5462, v147
    v_lshrrev_b32 v145, 16, v145
    v_mul_u32_u24 v146, 12, v145
    v_sub_u32 v146, v147, v146
    v_lshlrev_b32 v146, 4, v146
    v_mul_u32_u24 v149, 208, v145
    v_add_u32 v149, v149, v146
    v_mul_u32_u24 v153, 2304, v145
    v_add_u32 v153, v153, v146
    v_add_u32 v147, 1024, v144
    v_mul_u32_u24 v145, 5462, v147
    v_lshrrev_b32 v145, 16, v145
    v_mul_u32_u24 v146, 12, v145
    v_sub_u32 v146, v147, v146
    v_lshlrev_b32 v146, 4, v146
    v_mul_u32_u24 v150, 208, v145
    v_add_u32 v150, v150, v146
    v_mul_u32_u24 v154, 2304, v145
    v_add_u32 v154, v154, v146
K3o_st2:
    ds_read_b128 v[32:35], v148
    ds_read_b128 v[36:39], v149
    ds_read_b128 v[40:43], v150
    s_waitcnt lgkmcnt(2)
    buffer_store_dwordx4 v[32:35], v152, s[16:19], s33 offen
    s_waitcnt lgkmcnt(1)
    buffer_store_dwordx4 v[36:39], v153, s[16:19], s33 offen
    s_waitcnt lgkmcnt(0)
    buffer_store_dwordx4 v[40:43], v154, s[16:19], s33 offen
    s_endpgm
K3_ai:
    s_sub_u32 s3, s2, 96
    s_lshr_b32 s27, s3, 3
    s_and_b32 s28, s3, 7
    s_lshl_b32 s28, s28, 1
    s_cmp_ge_u32 s27, 6
    s_cselect_b32 s29, 1, 0
    s_add_u32 s28, s28, s29
    s_lshl_b32 s31, s28, 7
    s_mul_i32 s29, s29, 6
    s_sub_u32 s27, s27, s29
    s_mul_i32 s32, s27, 96
    s_getpc_b64 s[52:53]
K3_pc1:
    s_add_u32 s52, s52, TTAB-K3_pc1
    s_addc_u32 s53, s53, 0
    s_waitcnt lgkmcnt(0)
    s_add_u32 s8, s40, 9961472
    s_addc_u32 s9, s41, 0
    s_mov_b32 s10, 2359296
    s_mov_b32 s11, 0x00020000
    s_mov_b32 s12, s52
    s_mov_b32 s13, s53
    s_mov_b32 s14, 663552
    s_mov_b32 s15, 0x00020000
    s_mov_b32 s16, s38
    s_mov_b32 s17, s39
    s_mov_b32 s18, 4718592
    s_mov_b32 s19, 0x00020000
    s_mul_i32 s33, s31, 2304
    s_lshl_b32 s34, s32, 1
    s_add_u32 s33, s33, s34
    s_cmp_ge_u32 s35, 4
    s_cbranch_scc1 K3a_ld
    v_lshrrev_b32 v144, 5, v0
    v_lshlrev_b32 v144, 3, v144
    v_bfe_u32 v145, v0, 2, 2
    v_add_u32 v144, v144, v145
    v_lshlrev_b32 v144, 6, v144
    v_bfe_u32 v145, v0, 4, 1
    v_lshl_add_u32 v144, v145, 5, v144
    v_and_b32 v145, 3, v0
    v_lshl_add_u32 v144, v145, 3, v144
    s_lshl_b32 s27, s30, 12
    v_add_u32 v12, s27, v144
    v_lshrrev_b32 v144, 5, v0
    v_lshlrev_b32 v144, 3, v144
    v_bfe_u32 v145, v0, 2, 2
    v_add_u32 v144, v144, v145
    v_lshlrev_b32 v144, 6, v144
    v_bfe_u32 v145, v0, 4, 1
    v_lshl_add_u32 v144, v145, 5, v144
    v_and_b32 v145, 3, v0
    v_lshl_add_u32 v144, v145, 3, v144
    v_add_u32 v16, 16384, v144
    v_mov_b32 v96, 0
    v_mov_b32 v97, 0
    v_mov_b32 v98, 0
    v_mov_b32 v99, 0
    v_mov_b32 v100, 0
    v_mov_b32 v101, 0
    v_mov_b32 v102, 0
    v_mov_b32 v103, 0
    v_mov_b32 v104, 0
    v_mov_b32 v105, 0
    v_mov_b32 v106, 0
    v_mov_b32 v107, 0
    v_mov_b32 v108, 0
    v_mov_b32 v109, 0
    v_mov_b32 v110, 0
    v_mov_b32 v111, 0
    v_mov_b32 v112, 0
    v_mov_b32 v113, 0
    v_mov_b32 v114, 0
    v_mov_b32 v115, 0
    v_mov_b32 v116, 0
    v_mov_b32 v117, 0
    v_mov_b32 v118, 0
    v_mov_b32 v119, 0
    v_mov_b32 v120, 0
    v_mov_b32 v121, 0
    v_mov_b32 v122, 0
    v_mov_b32 v123, 0
    v_mov_b32 v124, 0
    v_mov_b32 v125, 0
    v_mov_b32 v126, 0
    v_mov_b32 v127, 0
    v_mov_b32 v128, 0
    v_mov_b32 v129, 0
    v_mov_b32 v130, 0
    v_mov_b32 v131, 0
    v_mov_b32 v132, 0
    v_mov_b32 v133, 0
    v_mov_b32 v134, 0
    v_mov_b32 v135, 0
    v_mov_b32 v136, 0
    v_mov_b32 v137, 0
    v_mov_b32 v138, 0
    v_mov_b32 v139, 0
    v_mov_b32 v140, 0
    v_mov_b32 v141, 0
    v_mov_b32 v142, 0
    v_mov_b32 v143, 0
    s_mov_b32 s21, 0
    s_mov_b32 s20, 0
    v_add_u32 v20, s21, v12
    v_add_u32 v24, s21, v16
    s_barrier
    ds_read_b64_tr_b16 v[32:33], v20 offset:0
    ds_read_b64_tr_b16 v[34:35], v20 offset:256
    ds_read_b64_tr_b16 v[36:37], v24 offset:0
    ds_read_b64_tr_b16 v[38:39], v24 offset:256
    ds_read_b64_tr_b16 v[40:41], v24 offset:4096
    ds_read_b64_tr_b16 v[42:43], v24 offset:4352
    ds_read_b64_tr_b16 v[44:45], v24 offset:8192
    ds_read_b64_tr_b16 v[46:47], v24 offset:8448
    ds_read_b64_tr_b16 v[48:49], v20 offset:1024
    ds_read_b64_tr_b16 v[50:51], v20 offset:1280
    ds_read_b64_tr_b16 v[52:53], v24 offset:1024
    ds_read_b64_tr_b16 v[54:55], v24 offset:1280
    ds_read_b64_tr_b16 v[56:57], v24 offset:5120
    ds_read_b64_tr_b16 v[58:59], v24 offset:5376
    ds_read_b64_tr_b16 v[60:61], v24 offset:9216
    ds_read_b64_tr_b16 v[62:63], v24 offset:9472
K3a_loop:
    s_barrier
    s_waitcnt lgkmcnt(8)
    v_mfma_f32_32x32x16_bf16 v[96:111], v[36:39], v[32:35], v[96:111]
    ds_read_b64_tr_b16 v[64:65], v20 offset:2048
    ds_read_b64_tr_b16 v[66:67], v20 offset:2304
    ds_read_b64_tr_b16 v[68:69], v24 offset:2048
    v_mfma_f32_32x32x16_bf16 v[112:127], v[40:43], v[32:35], v[112:127]
    ds_read_b64_tr_b16 v[70:71], v24 offset:2304
    ds_read_b64_tr_b16 v[72:73], v24 offset:6144
    ds_read_b64_tr_b16 v[74:75], v24 offset:6400
    v_mfma_f32_32x32x16_bf16 v[128:143], v[44:47], v[32:35], v[128:143]
    ds_read_b64_tr_b16 v[76:77], v24 offset:10240
    ds_read_b64_tr_b16 v[78:79], v24 offset:10496
    s_waitcnt lgkmcnt(8)
    v_mfma_f32_32x32x16_bf16 v[96:111], v[52:55], v[48:51], v[96:111]
    ds_read_b64_tr_b16 v[80:81], v20 offset:3072
    ds_read_b64_tr_b16 v[82:83], v20 offset:3328
    ds_read_b64_tr_b16 v[84:85], v24 offset:3072
    v_mfma_f32_32x32x16_bf16 v[112:127], v[56:59], v[48:51], v[112:127]
    ds_read_b64_tr_b16 v[86:87], v24 offset:3328
    ds_read_b64_tr_b16 v[88:89], v24 offset:7168
    ds_read_b64_tr_b16 v[90:91], v24 offset:7424
    v_mfma_f32_32x32x16_bf16 v[128:143], v[60:63], v[48:51], v[128:143]
    ds_read_b64_tr_b16 v[92:93], v24 offset:11264
    ds_read_b64_tr_b16 v[94:95], v24 offset:11520
    s_add_u32 s21, s21, 28672
    s_cmp_ge_u32 s21, 143360
    s_cselect_b32 s21, 0, s21
    v_add_u32 v20, s21, v12
    v_add_u32 v24, s21, v16
    s_waitcnt lgkmcnt(8)
    v_mfma_f32_32x32x16_bf16 v[96:111], v[68:71], v[64:67], v[96:111]
    ds_read_b64_tr_b16 v[32:33], v20 offset:0
    ds_read_b64_tr_b16 v[34:35], v20 offset:256
    ds_read_b64_tr_b16 v[36:37], v24 offset:0
    v_mfma_f32_32x32x16_bf16 v[112:127], v[72:75], v[64:67], v[112:127]
    ds_read_b64_tr_b16 v[38:39], v24 offset:256
    ds_read_b64_tr_b16 v[40:41], v24 offset:4096
    ds_read_b64_tr_b16 v[42:43], v24 offset:4352
    v_mfma_f32_32x32x16_bf16 v[128:143], v[76:79], v[64:67], v[128:143]
    ds_read_b64_tr_b16 v[44:45], v24 offset:8192
    ds_read_b64_tr_b16 v[46:47], v24 offset:8448
    s_waitcnt lgkmcnt(8)
    v_mfma_f32_32x32x16_bf16 v[96:111], v[84:87], v[80:83], v[96:111]
    ds_read_b64_tr_b16 v[48:49], v20 offset:1024
    ds_read_b64_tr_b16 v[50:51], v20 offset:1280
    ds_read_b64_tr_b16 v[52:53], v24 offset:1024
    v_mfma_f32_32x32x16_bf16 v[112:127], v[88:91], v[80:83], v[112:127]
    ds_read_b64_tr_b16 v[54:55], v24 offset:1280
    ds_read_b64_tr_b16 v[56:57], v24 offset:5120
    ds_read_b64_tr_b16 v[58:59], v24 offset:5376
    v_mfma_f32_32x32x16_bf16 v[128:143], v[92:95], v[80:83], v[128:143]
    ds_read_b64_tr_b16 v[60:61], v24 offset:9216
    ds_read_b64_tr_b16 v[62:63], v24 offset:9472
    s_add_u32 s20, s20, 1
    s_cmp_lt_u32 s20, 9
    s_cbranch_scc1 K3a_loop
    s_waitcnt lgkmcnt(0)
    s_nop 7
    s_nop 7
    v_and_b32 v144, 31, v0
    s_lshl_b32 s27, s30, 5
    v_add_u32 v144, s27, v144
    v_mul_u32_u24 v144, 208, v144
    v_lshrrev_b32 v145, 5, v0
    v_lshl_add_u32 v144, v145, 3, v144
    v_cvt_pk_bf16_f32 v146, v96, v97
    v_cvt_pk_bf16_f32 v147, v98, v99
    s_barrier
    ds_write_b64 v144, v[146:147] offset:0
    v_cvt_pk_bf16_f32 v148, v100, v101
    v_cvt_pk_bf16_f32 v149, v102, v103
    ds_write_b64 v144, v[148:149] offset:16
    v_cvt_pk_bf16_f32 v150, v104, v105
    v_cvt_pk_bf16_f32 v151, v106, v107
    ds_write_b64 v144, v[150:151] offset:32
    v_cvt_pk_bf16_f32 v152, v108, v109
    v_cvt_pk_bf16_f32 v153, v110, v111
    ds_write_b64 v144, v[152:153] offset:48
    v_cvt_pk_bf16_f32 v146, v112, v113
    v_cvt_pk_bf16_f32 v147, v114, v115
    ds_write_b64 v144, v[146:147] offset:64
    v_cvt_pk_bf16_f32 v148, v116, v117
    v_cvt_pk_bf16_f32 v149, v118, v119
    ds_write_b64 v144, v[148:149] offset:80
    v_cvt_pk_bf16_f32 v150, v120, v121
    v_cvt_pk_bf16_f32 v151, v122, v123
    ds_write_b64 v144, v[150:151] offset:96
    v_cvt_pk_bf16_f32 v152, v124, v125
    v_cvt_pk_bf16_f32 v153, v126, v127
    ds_write_b64 v144, v[152:153] offset:112
    v_cvt_pk_bf16_f32 v146, v128, v129
    v_cvt_pk_bf16_f32 v147, v130, v131
    ds_write_b64 v144, v[146:147] offset:128
    v_cvt_pk_bf16_f32 v148, v132, v133
    v_cvt_pk_bf16_f32 v149, v134, v135
    ds_write_b64 v144, v[148:149] offset:144
    v_cvt_pk_bf16_f32 v150, v136, v137
    v_cvt_pk_bf16_f32 v151, v138, v139
    ds_write_b64 v144, v[150:151] offset:160
    v_cvt_pk_bf16_f32 v152, v140, v141
    v_cvt_pk_bf16_f32 v153, v142, v143
    ds_write_b64 v144, v[152:153] offset:176
    s_waitcnt lgkmcnt(0)
    s_barrier
    s_branch K3a_st
K3a_ld:
    v_lshrrev_b32 v144, 2, v0
    v_and_b32 v145, 3, v0
    v_lshlrev_b32 v145, 4, v145
    s_mov_b32 s28, 4096
    s_lshl_b32 s27, s30, 5
    s_add_u32 s27, s27, s31
    s_lshl_b32 s27, s27, 1
    v_mul_lo_u32 v146, v144, s28
    v_add_u32 v146, v146, v145
    v_add_u32 v2, s27, v146
    v_add_u32 v3, 65536, v2
    v_add_u32 v4, 131072, v2
    v_add_u32 v5, 196608, v2
    v_lshrrev_b32 v144, 2, v0
    v_and_b32 v145, 3, v0
    v_lshlrev_b32 v145, 4, v145
    s_mov_b32 s28, 1152
    s_lshl_b32 s27, s30, 4
    v_add_u32 v144, s27, v144
    v_mul_lo_u32 v146, v144, s28
    v_add_u32 v146, v146, v145
    s_lshl_b32 s27, s32, 1
    v_add_u32 v6, s27, v146
    v_add_u32 v7, 64, v6
    v_add_u32 v8, 128, v6
    s_mov_b32 s22, 0
    s_mov_b32 s23, 0
    s_mov_b32 s24, 0
    s_mov_b32 s20, 0
K3a_pro:
    s_lshl_b32 s27, s30, 12
    s_add_u32 s27, s27, s22
    s_add_u32 m0, s27, 0
    s_nop 0
    buffer_load_dwordx4 v2, s[8:11], s23 offen lds
    s_add_u32 m0, s27, 1024
    s_nop 0
    buffer_load_dwordx4 v3, s[8:11], s23 offen lds
    s_add_u32 m0, s27, 2048
    s_nop 0
    buffer_load_dwordx4 v4, s[8:11], s23 offen lds
    s_add_u32 m0, s27, 3072
    s_nop 0
    buffer_load_dwordx4 v5, s[8:11], s23 offen lds
    s_lshl_b32 s27, s30, 10
    s_add_u32 s27, s27, s22
    s_add_u32 m0, s27, 16384
    s_nop 0
    buffer_load_dwordx4 v6, s[12:15], s24 offen lds
    s_add_u32 m0, s27, 20480
    s_nop 0
    buffer_load_dwordx4 v7, s[12:15], s24 offen lds
    s_add_u32 m0, s27, 24576
    s_nop 0
    buffer_load_dwordx4 v8, s[12:15], s24 offen lds
    s_add_u32 s22, s22, 28672
    s_add_u32 s23, s23, 262144
    s_add_u32 s24, s24, 73728
    s_add_u32 s20, s20, 1
    s_cmp_lt_u32 s20, 4
    s_cbranch_scc1 K3a_pro
    s_mov_b32 s20, 0
    s_waitcnt vmcnt(21)
    s_barrier
K3a_lloop:
    s_waitcnt vmcnt(14)
    s_barrier
    s_lshl_b32 s27, s30, 12
    s_add_u32 s27, s27, s22
    s_add_u32 m0, s27, 0
    s_nop 0
    buffer_load_dwordx4 v2, s[8:11], s23 offen lds
    s_add_u32 m0, s27, 1024
    s_nop 0
    buffer_load_dwordx4 v3, s[8:11], s23 offen lds
    s_add_u32 m0, s27, 2048
    s_nop 0
    buffer_load_dwordx4 v4, s[8:11], s23 offen lds
    s_add_u32 m0, s27, 3072
    s_nop 0
    buffer_load_dwordx4 v5, s[8:11], s23 offen lds
    s_lshl_b32 s27, s30, 10
    s_add_u32 s27, s27, s22
    s_add_u32 m0, s27, 16384
    s_nop 0
    buffer_load_dwordx4 v6, s[12:15], s24 offen lds
    s_add_u32 m0, s27, 20480
    s_nop 0
    buffer_load_dwordx4 v7, s[12:15], s24 offen lds
    s_add_u32 m0, s27, 24576
    s_nop 0
    buffer_load_dwordx4 v8, s[12:15], s24 offen lds
    s_add_u32 s22, s22, 28672
    s_cmp_ge_u32 s22, 143360
    s_cselect_b32 s22, 0, s22
    s_add_u32 s23, s23, 262144
    s_add_u32 s24, s24, 73728
    s_add_u32 s20, s20, 1
    s_cmp_lt_u32 s20, 5
    s_cbranch_scc1 K3a_lloop
    s_waitcnt vmcnt(14)
    s_barrier
    s_waitcnt vmcnt(7)
    s_barrier
    s_waitcnt vmcnt(0)
    s_barrier
    s_barrier
    s_lshl_b32 s27, s35, 6
    v_add_u32 v144, s27, v0
    v_add_u32 v147, 0, v144
    v_mul_u32_u24 v145, 5462, v147
    v_lshrrev_b32 v145, 16, v145
    v_mul_u32_u24 v146, 12, v145
    v_sub_u32 v146, v147, v146
    v_lshlrev_b32 v146, 4, v146
    v_mul_u32_u24 v148, 208, v145
    v_add_u32 v148, v148, v146
    v_mul_u32_u24 v152, 2304, v145
    v_add_u32 v152, v152, v146
    v_add_u32 v147, 512, v144
    v_mul_u32_u24 v145, 5462, v147
    v_lshrrev_b32 v145, 16, v145
    v_mul_u32_u24 v146, 12, v145
    v_sub_u32 v146, v147, v146
    v_lshlrev_b32 v146, 4, v146
    v_mul_u32_u24 v149, 208, v145
    v_add_u32 v149, v149, v146
    v_mul_u32_u24 v153, 2304, v145
    v_add_u32 v153, v153, v146
    v_add_u32 v147, 1024, v144
    v_mul_u32_u24 v145, 5462, v147
    v_lshrrev_b32 v145, 16, v145
    v_mul_u32_u24 v146, 12, v145
    v_sub_u32 v146, v147, v146
    v_lshlrev_b32 v146, 4, v146
    v_mul_u32_u24 v150, 208, v145
    v_add_u32 v150, v150, v146
    v_mul_u32_u24 v154, 2304, v145
    v_add_u32 v154, v154, v146
    s_barrier
    s_barrier
    s_branch K3a_st2
K3a_st:
    s_lshl_b32 s27, s35, 6
    v_add_u32 v144, s27, v0
    v_add_u32 v147, 0, v144
    v_mul_u32_u24 v145, 5462, v147
    v_lshrrev_b32 v145, 16, v145
    v_mul_u32_u24 v146, 12, v145
    v_sub_u32 v146, v147, v146
    v_lshlrev_b32 v146, 4, v146
    v_mul_u32_u24 v148, 208, v145
    v_add_u32 v148, v148, v146
    v_mul_u32_u24 v152, 2304, v145
    v_add_u32 v152, v152, v146
    v_add_u32 v147, 512, v144
    v_mul_u32_u24 v145, 5462, v147
    v_lshrrev_b32 v145, 16, v145
    v_mul_u32_u24 v146, 12, v145
    v_sub_u32 v146, v147, v146
    v_lshlrev_b32 v146, 4, v146
    v_mul_u32_u24 v149, 208, v145
    v_add_u32 v149, v149, v146
    v_mul_u32_u24 v153, 2304, v145
    v_add_u32 v153, v153, v146
    v_add_u32 v147, 1024, v144
    v_mul_u32_u24 v145, 5462, v147
    v_lshrrev_b32 v145, 16, v145
    v_mul_u32_u24 v146, 12, v145
    v_sub_u32 v146, v147, v146
    v_lshlrev_b32 v146, 4, v146
    v_mul_u32_u24 v150, 208, v145
    v_add_u32 v150, v150, v146
    v_mul_u32_u24 v154, 2304, v145
    v_add_u32 v154, v154, v146
K3a_st2:
    ds_read_b128 v[32:35], v148
    ds_read_b128 v[36:39], v149
    ds_read_b128 v[40:43], v150
    s_waitcnt lgkmcnt(2)
    buffer_store_dwordx4 v[32:35], v152, s[16:19], s33 offen
    s_waitcnt lgkmcnt(1)
    buffer_store_dwordx4 v[36:39], v153, s[16:19], s33 offen
    s_waitcnt lgkmcnt(0)
    buffer_store_dwordx4 v[40:43], v154, s[16:19], s33 offen
    s_endpgm
K3_end:
    s_endpgm

.p2align 8
.type FTAB,@object
FTAB:
.quad 0x3f8000003f80,0x3f8000003f80,0x3f8080003f808000,0x3f8080003f808000,0x3e483f7b00003f80,0x3f0e3f553ec43f6d,0x3f7bbe483f808000,0x3f55bf0e3f6dbec4,0x3ec43f6d00003f80,0x3f6d3ec43f353f35,0x3f6dbec43f808000,0x3ec4bf6d3f35bf35,0x3f0e3f5500003f80,0x3f7bbe483f6d3ec4,0x3f55bf0e3f808000,0xbe48bf7b3ec4bf6d
.quad 0x3f353f3500003f80,0x3f35bf353f80248d,0x3f35bf353f808000,0xbf35bf35248dbf80,0x3f553f0e00003f80,0x3e48bf7b3f6dbec4,0x3f0ebf553f808000,0xbf7bbe48bec4bf6d,0x3f6d3ec400003f80,0xbec4bf6d3f35bf35,0x3ec4bf6d3f808000,0xbf6d3ec4bf35bf35,0x3f7b3e4800003f80,0xbf55bf0e3ec4bf6d,0x3e48bf7b3f808000,0xbf0e3f55bf6dbec4
.quad 0x3f80248d00003f80,0xbf80a554250dbf80,0x248dbf803f808000,0xa5543f80bf80a50d,0x3f7bbe4800003f80,0xbf553f0ebec4bf6d,0xbe48bf7b3f808000,0x3f0e3f55bf6d3ec4,0x3f6dbec400003f80,0xbec43f6dbf35bf35,0xbec4bf6d3f808000,0x3f6d3ec4bf353f35,0x3f55bf0e00003f80,0x3e483f7bbf6dbec4,0xbf0ebf553f808000,0x3f7bbe48bec43f6d
.quad 0x3f35bf3500003f80,0x3f353f35bf80a554,0xbf35bf353f808000,0x3f35bf35a5543f80,0x3f0ebf5500003f80,0x3f7b3e48bf6d3ec4,0xbf55bf0e3f808000,0x3e48bf7b3ec43f6d,0x3ec4bf6d00003f80,0x3f6dbec4bf353f35,0xbf6dbec43f808000,0xbec4bf6d3f353f35,0x3e48bf7b00003f80,0x3f0ebf55bec43f6d,0xbf7bbe483f808000,0xbf55bf0e3f6d3ec4
.quad 0x3f8000003f80,0x3f8000003f80,0x3f8080003f808000,0x3f8080003f808000,0x3f553f0e3f353f35,0x3f7b3e483f6d3ec4,0x3f0ebf553f35bf35,0x3e48bf7b3ec4bf6d,0x3f6dbec43f80248d,0x3ec4bf6d3f35bf35,0xbec4bf6d248dbf80,0xbf6dbec4bf35bf35,0x3e48bf7b3f35bf35,0xbf55bf0ebec4bf6d,0xbf7bbe48bf35bf35,0xbf0e3f55bf6d3ec4
.quad 0xbf35bf35250dbf80,0xbf353f35bf80a554,0xbf353f35bf80a50d,0x3f353f35a5543f80,0xbf7b3e48bf35bf35,0x3f0e3f55bec43f6d,0x3e483f7bbf353f35,0x3f55bf0e3f6d3ec4,0xbec43f6dbf80a554,0x3f6dbec43f353f35,0x3f6d3ec4a5543f80,0xbec4bf6d3f35bf35,0x3f0e3f55bf353f35,0xbe48bf7b3f6dbec4,0x3f55bf0e3f353f35,0xbf7b3e48bec4bf6d
.quad 0x3f8025b0a58d3f80,0xbf80a5f725d4bf80,0x25b0bf803f80258d,0xa5f73f80bf80a5d4,0x3f0ebf553f353f35,0xbe483f7bbf6dbec4,0xbf55bf0e3f35bf35,0x3f7b3e48bec43f6d,0xbec4bf6d3f8025b0,0x3f6d3ec4bf353f35,0xbf6d3ec425b0bf80,0x3ec4bf6d3f353f35,0xbf7bbe483f35bf35,0x3f0ebf553ec43f6d,0xbe483f7bbf35bf35,0xbf55bf0e3f6dbec4
.quad 0xbf353f3525d4bf80,0xbf35bf353f80261f,0x3f353f35bf80a5d4,0xbf353f35261fbf80,0x3e483f7bbf35bf35,0xbf553f0e3ec4bf6d,0x3f7bbe48bf353f35,0x3f0e3f55bf6dbec4,0x3f6d3ec4bf80a5f7,0x3ec43f6dbf35bf35,0x3ec4bf6da5f73f80,0x3f6dbec4bf353f35,0x3f55bf0ebf353f35,0x3f7bbe48bf6d3ec4,0xbf0ebf553f353f35,0xbe48bf7b3ec43f6d
.quad 0x3f8000003f80,0x3f8000003f80,0x3f8080003f808000,0x3f8080003f808000,0x3f7bbe483f80248d,0x3f55bf0e3f6dbec4,0xbe48bf7b248dbf80,0xbf0ebf55bec4bf6d,0xbec4bf6d250dbf80,0xbf6dbec4bf35bf35,0xbf6d3ec4bf80a50d,0xbec43f6dbf353f35,0xbf553f0ebf80a554,0x3e483f7bbec43f6d,0x3f0e3f55a5543f80,0x3f7bbe483f6d3ec4
.quad 0x3f353f35a58d3f80,0x3f35bf353f8025b0,0x3f35bf353f80258d,0xbf35bf3525b0bf80,0x3f0ebf553f8025b0,0xbf7bbe48bec4bf6d,0xbf55bf0e25b0bf80,0xbe483f7bbf6d3ec4,0xbf6dbec425d4bf80,0x3ec43f6dbf353f35,0xbec43f6dbf80a5d4,0x3f6dbec43f353f35,0xbe483f7bbf80a5f7,0x3f0ebf553f6d3ec4,0x3f7b3e48a5f73f80,0xbf55bf0e3ec4bf6d
.quad 0x3f80261fa60d3f80,0xbf80a7312630bf80,0x261fbf803f80260d,0xa7313f80bf80a630,0xbe48bf7b3f80261f,0x3f0e3f55bf6d3ec4,0xbf7b3e48261fbf80,0x3f55bf0e3ec43f6d,0xbf6d3ec42630bf80,0x3ec4bf6d3f353f35,0x3ec43f6dbf80a630,0xbf6dbec43f35bf35,0x3f0e3f55bf80a731,0xbf7b3e483ec4bf6d,0x3f55bf0ea7313f80,0x3e483f7bbf6dbec4
.quad 0x3f35bf35a6543f80,0x3f353f35bf80a742,0xbf35bf353f802654,0x3f35bf35a7423f80,0xbf55bf0e3f80a68d,0x3e48bf7b3ec43f6d,0xbf0e3f55a68dbf80,0xbf7bbe483f6dbec4,0xbec43f6d2677bf80,0xbf6d3ec43f35bf35,0x3f6d3ec4bf80a677,0x3ec43f6dbf35bf35,0x3f7b3e48bf80a742,0x3f553f0ebf6dbec4,0x3e48bf7ba7423f80,0x3f0ebf55bec43f6d
.quad 0x3f8000003f80,0x3f8000003f80,0x3f8080003f808000,0x3f8080003f808000,0x3f0ebf553f35bf35,0x3e48bf7b3ec4bf6d,0xbf55bf0ebf35bf35,0xbf7bbe48bf6dbec4,0xbf6d3ec4bf80a554,0xbec43f6dbf353f35,0x3ec43f6da5543f80,0x3f6d3ec43f353f35,0x3f7b3e483f353f35,0x3f0ebf553f6dbec4,0x3e48bf7b3f35bf35,0xbf55bf0ebec4bf6d
.quad 0xbf35bf3525d4bf80,0xbf353f35bf80a5f7,0xbf353f35bf80a5d4,0x3f353f35a5f73f80,0x3e483f7bbf353f35,0x3f55bf0e3f6d3ec4,0x3f7bbe483f353f35,0xbf0ebf553ec4bf6d,0x3ec4bf6d3f80261f,0xbf6d3ec4bf35bf35,0xbf6dbec4261fbf80,0x3ec43f6dbf353f35,0xbf553f0ebf35bf35,0x3f7bbe483ec43f6d,0x3f0e3f55bf353f35,0xbe48bf7b3f6dbec4
.quad 0x3f80a68da6543f80,0xbf80a7422677bf80,0xa68dbf803f802654,0xa7423f80bf80a677,0xbf55bf0e3f35bf35,0x3f7b3e48bec43f6d,0xbf0e3f55bf35bf35,0x3e48bf7b3f6d3ec4,0x3ec43f6dbf80a742,0xbf6dbec43f35bf35,0x3f6dbec4a7423f80,0xbec43f6dbf35bf35,0x3e48bf7b3f353f35,0x3f553f0ebf6d3ec4,0xbf7bbe483f35bf35,0x3f0ebf553ec43f6d
.quad 0xbf353f35269fbf80,0xbf35bf353f80a60d,0x3f353f35bf80a69f,0xbf353f35a60dbf80,0x3f7bbe48bf353f35,0x3f0e3f55bf6dbec4,0xbe48bf7b3f353f35,0x3f55bf0ebec43f6d,0xbf6dbec43f80a60d,0xbec4bf6d3f353f35,0xbec43f6da60dbf80,0xbf6d3ec43f35bf35,0x3f0e3f55bf35bf35,0x3e483f7bbec4bf6d,0x3f55bf0ebf353f35,0x3f7bbe48bf6d3ec4
.quad 0x3f8000003f80,0x3f8000003f80,0x3f8080003f808000,0x3f8080003f808000,0xbe48bf7b250dbf80,0xbf0ebf55bec4bf6d,0xbf7b3e48bf80a50d,0xbf553f0ebf6d3ec4,0x3ec43f6da58d3f80,0x3f6d3ec43f353f35,0x3f6dbec43f80258d,0x3ec4bf6d3f35bf35,0xbf0ebf5525d4bf80,0xbf7b3e48bf6dbec4,0xbf553f0ebf80a5d4,0x3e483f7bbec43f6d
.quad 0x3f353f35a60d3f80,0x3f35bf353f80261f,0x3f35bf353f80260d,0xbf35bf35261fbf80,0xbf55bf0e2630bf80,0xbe483f7bbf6d3ec4,0xbf0e3f55bf80a630,0x3f7b3e483ec43f6d,0x3f6d3ec4a6543f80,0xbec4bf6d3f35bf35,0x3ec4bf6d3f802654,0xbf6d3ec4bf35bf35,0xbf7bbe482677bf80,0x3f553f0ebec43f6d,0xbe483f7bbf80a677,0x3f0ebf553f6d3ec4
.quad 0x3f80a654a68d3f80,0xbf80a754269fbf80,0xa654bf803f80268d,0xa7543f80bf80a69f,0xbf7b3e48269fbf80,0x3f55bf0e3ec43f6d,0x3e483f7bbf80a69f,0xbf0ebf553f6dbec4,0x3f6dbec4a6b03f80,0xbec43f6dbf35bf35,0xbec4bf6d3f8026b0,0x3f6d3ec4bf353f35,0xbf553f0e27b1bf80,0xbe48bf7b3f6d3ec4,0x3f0e3f55bf80a7b1,0xbf7b3e483ec4bf6d
.quad 0x3f35bf35a6d43f80,0x3f353f35bf80a777,0xbf35bf353f8026d4,0x3f35bf35a7773f80,0xbf0e3f55a70dbf80,0xbf7bbe483f6dbec4,0x3f553f0ebf80270d,0xbe483f7bbec4bf6d,0x3ec4bf6da6f73f80,0x3f6dbec4bf353f35,0xbf6dbec43f8026f7,0xbec4bf6d3f353f35,0xbe483f7b27c2bf80,0xbf0e3f553ec4bf6d,0x3f7b3e48bf80a7c2,0x3f553f0ebf6dbec4
.quad 0x3f8000003f80,0x3f8000003f80,0x3f8080003f808000,0x3f8080003f808000,0xbf55bf0ebf35bf35,0xbf7bbe48bf6dbec4,0xbf0e3f55bf353f35,0xbe483f7bbec43f6d,0x3f6dbec43f8025b0,0x3ec4bf6d3f35bf35,0xbec4bf6d25b0bf80,0xbf6dbec4bf35bf35,0xbe483f7bbf353f35,0x3f553f0e3ec43f6d,0x3f7b3e483f353f35,0x3f0ebf553f6dbec4
.quad 0xbf35bf352630bf80,0xbf353f35bf80a731,0xbf353f35bf80a630,0x3f353f35a7313f80,0x3f7bbe483f353f35,0xbf0ebf553ec4bf6d,0xbe48bf7b3f35bf35,0xbf553f0ebf6dbec4,0xbec43f6dbf80a742,0x3f6dbec43f353f35,0x3f6d3ec4a7423f80,0xbec4bf6d3f35bf35,0xbf0ebf553f35bf35,0x3e483f7bbf6d3ec4,0xbf553f0ebf35bf35,0x3f7bbe483ec43f6d
.quad 0x3f80a60da6b03f80,0xbf80a76527b1bf80,0xa60dbf803f8026b0,0xa7653f80bf80a7b1,0xbf0e3f55bf35bf35,0x3e48bf7b3f6d3ec4,0x3f553f0ebf353f35,0xbf7bbe483ec4bf6d,0xbec4bf6d3f80a58e,0x3f6d3ec4bf353f35,0xbf6d3ec4a58ebf80,0x3ec4bf6d3f353f35,0x3f7b3e48bf353f35,0xbf0e3f55bec4bf6d,0x3e48bf7b3f353f35,0x3f553f0ebf6d3ec4
.quad 0xbf353f3527c2bf80,0xbf35bf353f802804,0x3f353f35bf80a7c2,0xbf353f352804bf80,0xbe48bf7b3f353f35,0x3f55bf0ebec43f6d,0xbf7b3e483f35bf35,0xbf0ebf553f6d3ec4,0x3f6d3ec4bf80a78d,0x3ec43f6dbf35bf35,0x3ec4bf6da78d3f80,0x3f6dbec4bf353f35,0xbf553f0e3f35bf35,0xbf7b3e483f6dbec4,0x3f0e3f55bf35bf35,0x3e483f7bbec4bf6d
.quad 0x3f8000003f80,0x3f8000003f80,0x3f8080003f808000,0x3f8080003f808000,0xbf7b3e48bf80a554,0xbf553f0ebf6d3ec4,0x3e483f7ba5543f80,0x3f0e3f553ec43f6d,0xbec4bf6d25d4bf80,0xbf6dbec4bf35bf35,0xbf6d3ec4bf80a5d4,0xbec43f6dbf353f35,0x3f55bf0e3f80261f,0xbe48bf7b3ec4bf6d,0xbf0ebf55261fbf80,0xbf7b3e48bf6dbec4
.quad 0x3f353f35a6543f80,0x3f35bf353f80a68d,0x3f35bf353f802654,0xbf35bf35a68dbf80,0xbf0e3f55bf80a742,0x3f7b3e483ec43f6d,0x3f553f0ea7423f80,0x3e48bf7b3f6dbec4,0xbf6dbec4269fbf80,0x3ec43f6dbf353f35,0xbec43f6dbf80a69f,0x3f6dbec43f353f35,0x3e48bf7b3f80a60d,0xbf0e3f55bf6dbec4,0xbf7bbe48a60dbf80,0x3f553f0ebec43f6d
.quad 0x3f80a58ea6d43f80,0xbf80a777a70dbf80,0xa58ebf803f8026d4,0xa7773f80bf80270d,0x3e483f7bbf80a777,0xbf0ebf553f6dbec4,0x3f7bbe48a7773f80,0xbf553f0ebec4bf6d,0xbf6d3ec427c2bf80,0x3ec4bf6d3f353f35,0x3ec43f6dbf80a7c2,0xbf6dbec43f35bf35,0xbf0ebf553f80258d,0x3f7bbe48bec43f6d,0xbf553f0e258dbf80,0xbe48bf7b3f6d3ec4
.quad 0x3f35bf35a71f3f80,0x3f353f35bf802754,0xbf35bf353f80271f,0x3f35bf3527543f80,0x3f553f0ebf80a796,0xbe483f7bbec4bf6d,0x3f0ebf55a7963f80,0x3f7b3e48bf6d3ec4,0xbec43f6da68dbf80,0xbf6d3ec43f35bf35,0x3f6d3ec4bf80268d,0x3ec43f6dbf35bf35,0xbf7bbe483f80268d,0xbf55bf0e3f6d3ec4,0xbe483f7b268dbf80,0xbf0e3f553ec4bf6d
.quad 0x3f8000003f80,0x3f8000003f80,0x3f8080003f808000,0x3f8080003f808000,0xbf0e3f55bf353f35,0xbe483f7bbec43f6d,0x3f553f0e3f353f35,0x3f7b3e483f6d3ec4,0xbf6d3ec4bf80a5f7,0xbec43f6dbf353f35,0x3ec43f6da5f73f80,0x3f6d3ec43f353f35,0xbf7bbe48bf35bf35,0xbf0e3f55bf6d3ec4,0xbe483f7bbf353f35,0x3f553f0e3ec43f6d
.quad 0xbf35bf352677bf80,0xbf353f35bf80a742,0xbf353f35bf80a677,0x3f353f35a7423f80,0xbe48bf7b3f35bf35,0xbf553f0ebf6dbec4,0xbf7b3e48bf35bf35,0x3f0e3f55bec43f6d,0x3ec4bf6d3f80a60d,0xbf6d3ec4bf35bf35,0xbf6dbec4a60dbf80,0x3ec43f6dbf353f35,0x3f55bf0e3f353f35,0xbf7b3e48bec4bf6d,0xbf0ebf553f35bf35,0x3e483f7bbf6d3ec4
.quad 0x3f80a137a6f73f80,0xbf80a78427c2bf80,0xa137bf803f8026f7,0xa7843f80bf80a7c2,0x3f553f0ebf353f35,0xbf7bbe483ec4bf6d,0x3f0ebf553f353f35,0xbe483f7bbf6dbec4,0x3ec43f6dbf80a78d,0xbf6dbec43f35bf35,0x3f6dbec4a78d3f80,0xbec43f6dbf35bf35,0xbe483f7bbf35bf35,0xbf55bf0e3f6dbec4,0x3f7b3e48bf353f35,0xbf0e3f55bec4bf6d
.quad 0xbf353f35a68dbf80,0xbf35bf353f802889,0x3f353f35bf80268d,0xbf353f352889bf80,0xbf7b3e483f35bf35,0xbf0ebf553f6d3ec4,0x3e483f7bbf35bf35,0xbf553f0e3ec4bf6d,0xbf6dbec43f802816,0xbec4bf6d3f353f35,0xbec43f6d2816bf80,0xbf6d3ec43f35bf35,0xbf0ebf553f353f35,0xbe48bf7b3ec43f6d,0xbf553f0e3f35bf35,0xbf7b3e483f6dbec4
.quad 0x250dbf8000003f80,0x25d4bf80a58d3f80,0xbf80a50d3f808000,0xbf80a5d43f80258d,0xbe48bf7b00003f80,0xbf0ebf553ec43f6d,0xbf7b3e483f808000,0xbf553f0e3f6dbec4,0xbec4bf6d00003f80,0xbf6dbec43f353f35,0xbf6d3ec43f808000,0xbec43f6d3f35bf35,0xbf0ebf5500003f80,0xbf7b3e483f6d3ec4,0xbf553f0e3f808000,0x3e483f7b3ec4bf6d
.quad 0xbf35bf3500003f80,0xbf353f353f8025b0,0xbf353f353f808000,0x3f353f3525b0bf80,0xbf55bf0e00003f80,0xbe483f7b3f6dbec4,0xbf0e3f553f808000,0x3f7b3e48bec4bf6d,0xbf6dbec400003f80,0x3ec43f6d3f35bf35,0xbec43f6d3f808000,0x3f6dbec4bf35bf35,0xbf7bbe4800003f80,0x3f553f0e3ec4bf6d,0xbe483f7b3f808000,0x3f0ebf55bf6dbec4
.quad 0xbf80a55400003f80,0x3f80261f25d4bf80,0xa5543f803f808000,0x261fbf80bf80a5d4,0xbf7b3e4800003f80,0x3f55bf0ebec4bf6d,0x3e483f7b3f808000,0xbf0ebf55bf6d3ec4,0xbf6d3ec400003f80,0x3ec4bf6dbf35bf35,0x3ec43f6d3f808000,0xbf6dbec4bf353f35,0xbf553f0e00003f80,0xbe48bf7bbf6dbec4,0x3f0e3f553f808000,0xbf7b3e48bec43f6d
.quad 0xbf353f3500003f80,0xbf35bf35bf80a5f7,0x3f353f353f808000,0xbf353f35a5f73f80,0xbf0e3f5500003f80,0xbf7bbe48bf6d3ec4,0x3f553f0e3f808000,0xbe483f7b3ec43f6d,0xbec43f6d00003f80,0xbf6d3ec4bf353f35,0x3f6d3ec43f808000,0x3ec43f6d3f353f35,0xbe483f7b00003f80,0xbf0e3f55bec43f6d,0x3f7b3e483f808000,0x3f553f0e3f6d3ec4
.quad 0x2630bf80a60d3f80,0x2677bf80a6543f80,0xbf80a6303f80260d,0xbf80a6773f802654,0xbf55bf0e3f353f35,0xbf7bbe483f6d3ec4,0xbf0e3f553f35bf35,0xbe483f7b3ec4bf6d,0xbf6d3ec43f80261f,0xbec43f6d3f35bf35,0x3ec43f6d261fbf80,0x3f6d3ec4bf35bf35,0xbe483f7b3f35bf35,0x3f553f0ebec4bf6d,0x3f7b3e48bf35bf35,0x3f0ebf55bf6d3ec4
.quad 0x3f353f352630bf80,0x3f35bf35bf80a742,0x3f35bf35bf80a630,0xbf35bf35a7423f80,0x3f7bbe48bf35bf35,0xbf0ebf55bec43f6d,0xbe48bf7bbf353f35,0xbf553f0e3f6d3ec4,0x3ec4bf6dbf80a731,0xbf6d3ec43f353f35,0xbf6dbec4a7313f80,0x3ec43f6d3f35bf35,0xbf0ebf55bf353f35,0x3e483f7b3f6dbec4,0xbf553f0e3f353f35,0x3f7bbe48bec4bf6d
.quad 0xbf80a742a6543f80,0x3f80a60d269fbf80,0xa7423f803f802654,0xa60dbf80bf80a69f,0xbf0e3f553f353f35,0x3e48bf7bbf6dbec4,0x3f553f0e3f35bf35,0xbf7bbe48bec43f6d,0x3ec43f6d3f80a68d,0xbf6dbec4bf353f35,0x3f6dbec4a68dbf80,0xbec43f6d3f353f35,0x3f7b3e483f35bf35,0xbf0e3f553ec43f6d,0x3e48bf7bbf35bf35,0x3f553f0e3f6dbec4
.quad 0x3f35bf352677bf80,0x3f353f353f80a60d,0xbf35bf35bf80a677,0x3f35bf35a60dbf80,0xbe48bf7bbf35bf35,0x3f55bf0e3ec4bf6d,0xbf7b3e48bf353f35,0xbf0ebf55bf6dbec4,0xbf6dbec4bf80a742,0xbec4bf6dbf35bf35,0xbec43f6da7423f80,0xbf6d3ec4bf353f35,0xbf553f0ebf353f35,0xbf7b3e48bf6d3ec4,0x3f0e3f553f353f35,0x3e483f7b3ec43f6d
.quad 0x269fbf80a68d3f80,0x27b1bf80a6b03f80,0xbf80a69f3f80268d,0xbf80a7b13f8026b0,0xbf7b3e483f80a654,0xbf553f0e3f6dbec4,0x3e483f7ba654bf80,0x3f0e3f55bec4bf6d,0x3ec43f6d269fbf80,0x3f6d3ec4bf35bf35,0x3f6dbec4bf80a69f,0x3ec4bf6dbf353f35,0x3f55bf0ebf80a754,0xbe48bf7bbec43f6d,0xbf0ebf55a7543f80,0xbf7b3e483f6d3ec4
.quad 0xbf35bf35a6b03f80,0xbf353f353f80a58e,0xbf353f353f8026b0,0x3f353f35a58ebf80,0xbf0e3f553f80a60d,0x3f7b3e48bec4bf6d,0x3f553f0ea60dbf80,0x3e48bf7bbf6d3ec4,0x3f6d3ec427b1bf80,0xbec4bf6dbf353f35,0x3ec4bf6dbf80a7b1,0xbf6d3ec43f353f35,0x3e48bf7bbf80a765,0xbf0e3f553f6d3ec4,0xbf7bbe48a7653f80,0x3f553f0e3ec4bf6d
.quad 0xbf80a777a6d43f80,0x3f80280427c2bf80,0xa7773f803f8026d4,0x2804bf80bf80a7c2,0x3e483f7b3f80a58e,0xbf0ebf55bf6d3ec4,0x3f7bbe48a58ebf80,0xbf553f0e3ec43f6d,0x3f6dbec4a70dbf80,0xbec43f6d3f353f35,0xbec4bf6dbf80270d,0x3f6d3ec43f35bf35,0xbf0ebf55bf80a777,0x3f7bbe483ec4bf6d,0xbf553f0ea7773f80,0xbe48bf7bbf6dbec4
.quad 0xbf353f35a6f73f80,0xbf35bf35bf80a78d,0x3f353f353f8026f7,0xbf353f35a78d3f80,0x3f553f0e3f80a137,0xbe483f7b3ec43f6d,0x3f0ebf55a137bf80,0x3f7b3e483f6dbec4,0x3ec4bf6d27c2bf80,0x3f6dbec43f35bf35,0xbf6dbec4bf80a7c2,0xbec4bf6dbf35bf35,0xbf7bbe48bf80a784,0xbf55bf0ebf6dbec4,0xbe483f7ba7843f80,0xbf0e3f55bec43f6d
.quad 0xa70dbf80a6d43f80,0x27c2bf80a6f73f80,0xbf80270d3f8026d4,0xbf80a7c23f8026f7,0xbf0e3f553f35bf35,0xbe483f7b3ec4bf6d,0x3f553f0ebf35bf35,0x3f7b3e48bf6dbec4,0x3f6dbec4bf80a777,0x3ec4bf6dbf353f35,0xbec4bf6da7773f80,0xbf6dbec43f353f35,0xbf7bbe483f353f35,0xbf0e3f553f6dbec4,0xbe483f7b3f35bf35,0x3f553f0ebec4bf6d
.quad 0x3f353f3527c2bf80,0x3f35bf35bf80a78d,0x3f35bf35bf80a7c2,0xbf35bf35a78d3f80,0xbe48bf7bbf353f35,0xbf553f0e3f6d3ec4,0xbf7b3e483f353f35,0x3f0e3f553ec4bf6d,0xbec43f6d3f80258d,0x3f6dbec4bf35bf35,0x3f6d3ec4258dbf80,0xbec4bf6dbf353f35,0x3f55bf0ebf35bf35,0xbf7b3e483ec43f6d,0xbf0ebf55bf353f35,0x3e483f7b3f6dbec4
.quad 0xbf802754a71f3f80,0x3f802889a68dbf80,0x27543f803f80271f,0x2889bf80bf80268d,0x3f553f0e3f35bf35,0xbf7bbe48bec43f6d,0x3f0ebf55bf35bf35,0xbe483f7b3f6d3ec4,0xbec4bf6dbf80a796,0x3f6d3ec43f35bf35,0xbf6d3ec4a7963f80,0x3ec4bf6dbf35bf35,0xbe483f7b3f353f35,0xbf55bf0ebf6d3ec4,0x3f7b3e483f35bf35,0xbf0e3f553ec43f6d
.quad 0x3f35bf35a68dbf80,0x3f353f353f802816,0xbf35bf35bf80268d,0x3f35bf352816bf80,0xbf7b3e48bf353f35,0xbf0ebf55bf6dbec4,0x3e483f7b3f353f35,0xbf553f0ebec43f6d,0x3f6d3ec43f80268d,0x3ec43f6d3f353f35,0x3ec4bf6d268dbf80,0x3f6dbec43f35bf35,0xbf0ebf55bf35bf35,0xbe48bf7bbec4bf6d,0xbf553f0ebf353f35,0xbf7b3e48bf6d3ec4
.quad 0xa6d4bf80a70d3f80,0x27d4bf80a71f3f80,0xbf8026d43f80270d,0xbf80a7d43f80271f,0x3e483f7ba6d4bf80,0x3f0e3f55bec4bf6d,0x3f7bbe48bf8026d4,0x3f55bf0ebf6d3ec4,0xbec4bf6da71f3f80,0xbf6dbec43f353f35,0xbf6d3ec43f80271f,0xbec43f6d3f35bf35,0x3f0e3f5527d4bf80,0x3f7bbe48bf6dbec4,0x3f55bf0ebf80a7d4,0xbe48bf7bbec43f6d
.quad 0xbf35bf35a7303f80,0xbf353f353f80268d,0xbf353f353f802730,0x3f353f35268dbf80,0x3f553f0ea68dbf80,0x3e48bf7bbf6d3ec4,0x3f0ebf55bf80268d,0xbf7bbe483ec43f6d,0xbf6dbec4a8313f80,0x3ec43f6d3f35bf35,0xbec43f6d3f802831,0x3f6dbec4bf35bf35,0x3f7b3e4827e5bf80,0xbf55bf0ebec43f6d,0x3e48bf7bbf80a7e5,0xbf0e3f553f6d3ec4
.quad 0xbf802828a7543f80,0x3f80281f27f7bf80,0x28283f803f802754,0x281fbf80bf80a7f7,0x3f7bbe48a60ebf80,0xbf553f0e3ec43f6d,0xbe48bf7bbf80260e,0x3f0e3f553f6dbec4,0xbf6d3ec4278d3f80,0x3ec4bf6dbf35bf35,0x3ec43f6d3f80a78d,0xbf6dbec4bf353f35,0x3f55bf0e27f7bf80,0x3e483f7b3f6d3ec4,0xbf0ebf55bf80a7f7,0x3f7bbe483ec4bf6d
.quad 0xbf353f35a7773f80,0xbf35bf35bf8026d4,0x3f353f353f802777,0xbf353f3526d43f80,0x3f0ebf55a1b7bf80,0x3f7b3e483f6dbec4,0xbf55bf0ebf8021b7,0x3e48bf7bbec4bf6d,0xbec43f6da8423f80,0xbf6d3ec4bf353f35,0x3f6d3ec43f802842,0x3ec43f6d3f353f35,0x3e48bf7b2804bf80,0x3f0ebf553ec4bf6d,0xbf7bbe48bf80a804,0xbf55bf0ebf6dbec4
.quad 0xa68dbf80a7303f80,0x27e5bf80a8313f80,0xbf80268d3f802730,0xbf80a7e53f802831,0x3f553f0ebf35bf35,0x3f7b3e48bf6dbec4,0x3f0ebf55bf353f35,0x3e48bf7bbec43f6d,0xbf6d3ec43f80268d,0xbec43f6d3f35bf35,0x3ec43f6d268dbf80,0x3f6d3ec4bf35bf35,0x3e48bf7bbf353f35,0xbf55bf0e3ec43f6d,0xbf7bbe483f353f35,0xbf0e3f553f6dbec4
.quad 0x3f353f35a60ebf80,0x3f35bf35bf80a85d,0x3f35bf35bf80260e,0xbf35bf35a85d3f80,0xbf7b3e483f353f35,0x3f0e3f553ec4bf6d,0x3e483f7b3f35bf35,0x3f55bf0ebf6dbec4,0x3ec4bf6dbf80270d,0xbf6d3ec43f353f35,0xbf6dbec4270d3f80,0x3ec43f6d3f35bf35,0x3f0e3f553f35bf35,0xbe48bf7bbf6d3ec4,0x3f55bf0ebf35bf35,0xbf7b3e483ec43f6d
.quad 0xbf8026d4a8423f80,0x3f8027302884bf80,0x26d43f803f802842,0x2730bf80bf80a884,0x3f0ebf55bf35bf35,0xbe483f7b3f6d3ec4,0xbf55bf0ebf353f35,0x3f7b3e483ec4bf6d,0x3ec43f6d3f802828,0xbf6dbec4bf353f35,0x3f6dbec42828bf80,0xbec43f6d3f353f35,0xbf7bbe48bf353f35,0x3f0ebf55bec4bf6d,0xbe483f7b3f353f35,0xbf55bf0ebf6d3ec4
.quad 0x3f35bf35280dbf80,0x3f353f353f80289a,0xbf35bf35bf80a80d,0x3f35bf35289abf80,0x3e483f7b3f353f35,0xbf553f0ebec43f6d,0x3f7bbe483f35bf35,0x3f0e3f553f6d3ec4,0xbf6dbec4bf80a7e5,0xbec4bf6dbf35bf35,0xbec43f6da7e53f80,0xbf6d3ec4bf353f35,0x3f55bf0e3f35bf35,0x3f7bbe483f6dbec4,0xbf0ebf55bf35bf35,0xbe48bf7bbec4bf6d
.quad 0xa60ebf80a7543f80,0x27f7bf80278d3f80,0xbf80260e3f802754,0xbf80a7f73f80a78d,0x3f7bbe48bf80a7b1,0x3f55bf0ebf6d3ec4,0xbe48bf7ba7b13f80,0xbf0ebf553ec43f6d,0x3ec43f6d27f7bf80,0x3f6d3ec4bf35bf35,0x3f6dbec4bf80a7f7,0x3ec4bf6dbf353f35,0xbf553f0e3f80281f,0x3e483f7b3ec4bf6d,0x3f0e3f55281fbf80,0x3f7bbe48bf6dbec4
.quad 0xbf35bf35a8423f80,0xbf353f353f80a7b1,0xbf353f353f802842,0x3f353f35a7b1bf80,0x3f0ebf55bf8026d4,0xbf7bbe483ec43f6d,0xbf55bf0e26d43f80,0xbe483f7b3f6dbec4,0x3f6d3ec4260dbf80,0xbec4bf6dbf353f35,0x3ec4bf6dbf80a60d,0xbf6d3ec43f353f35,0xbe483f7b3f802730,0x3f0ebf55bf6dbec4,0x3f7b3e482730bf80,0xbf55bf0ebec43f6d
.quad 0xbf80a7e5a79f3f80,0x3f802839a7d4bf80,0xa7e53f803f80279f,0x2839bf80bf8027d4,0xbe48bf7bbf80a7e5,0x3f0e3f553f6dbec4,0xbf7b3e48a7e53f80,0x3f55bf0ebec4bf6d,0x3f6dbec42816bf80,0xbec43f6d3f353f35,0xbec4bf6dbf80a816,0x3f6d3ec43f35bf35,0x3f0e3f553f802839,0xbf7b3e48bec43f6d,0x3f55bf0e2839bf80,0x3e483f7b3f6d3ec4
.quad 0xbf353f35270d3f80,0xbf35bf35bf8028be,0x3f353f353f80a70d,0xbf353f3528be3f80,0xbf55bf0ebf80a880,0x3e48bf7bbec4bf6d,0xbf0e3f55a8803f80,0xbf7bbe48bf6d3ec4,0x3ec4bf6d270dbf80,0x3f6dbec43f35bf35,0xbf6dbec4bf80a70d,0xbec4bf6dbf35bf35,0x3f7b3e483f8028a3,0x3f553f0e3f6d3ec4,0x3e48bf7b28a3bf80,0x3f0ebf553ec4bf6d
.quad 0xa1b7bf80a7773f80,0x2804bf80a8423f80,0xbf8021b73f802777,0xbf80a8043f802842,0x3f0ebf55bf353f35,0x3e48bf7bbec43f6d,0xbf55bf0e3f353f35,0xbf7bbe483f6d3ec4,0x3f6dbec4bf8026d4,0x3ec4bf6dbf353f35,0xbec4bf6d26d43f80,0xbf6dbec43f353f35,0x3f7b3e48bf35bf35,0x3f0ebf55bf6d3ec4,0x3e48bf7bbf353f35,0xbf55bf0e3ec43f6d
.quad 0x3f353f35280dbf80,0x3f35bf35bf80a7e5,0x3f35bf35bf80a80d,0xbf35bf35a7e53f80,0x3e483f7b3f35bf35,0x3f55bf0ebf6dbec4,0x3f7bbe48bf35bf35,0xbf0ebf55bec43f6d,0xbec43f6d3f802754,0x3f6dbec4bf35bf35,0x3f6d3ec42754bf80,0xbec4bf6dbf353f35,0xbf553f0e3f353f35,0x3f7bbe48bec4bf6d,0x3f0e3f553f35bf35,0xbe48bf7bbf6d3ec4
.quad 0xbf80a880270d3f80,0x3f8028a32909bf80,0xa8803f803f80a70d,0x28a3bf80bf80a909,0xbf55bf0ebf353f35,0x3f7b3e483ec4bf6d,0xbf0e3f553f353f35,0x3e48bf7bbf6dbec4,0xbec4bf6dbf80a804,0x3f6d3ec43f35bf35,0xbf6d3ec4a8043f80,0x3ec4bf6dbf35bf35,0x3e48bf7bbf35bf35,0x3f553f0e3f6dbec4,0xbf7bbe48bf353f35,0x3f0ebf55bec4bf6d
.quad 0x3f35bf352896bf80,0x3f353f353f8028ea,0xbf35bf35bf80a896,0x3f35bf3528eabf80,0x3f7bbe483f35bf35,0x3f0e3f553f6d3ec4,0xbe48bf7bbf35bf35,0x3f55bf0e3ec4bf6d,0x3f6d3ec43f80a731,0x3ec43f6d3f353f35,0x3ec4bf6da731bf80,0x3f6dbec43f35bf35,0x3f0e3f553f353f35,0x3e483f7b3ec43f6d,0x3f55bf0e3f35bf35,0x3f7bbe483f6dbec4
.quad 0x3f803f803f803f80,0x3f803f803f803f80,0x3f753f7b3f7f3f80,0x3ef13f0e3f223f35,0x3f553f6d3f7b3f80,0xbf0ebec4be48248d,0x3f223f553f753f80,0xbf7fbf7bbf62bf35,0x3ec43f353f6d3f80,0xbec4bf35bf6dbf80,0x3dc93f0e3f623f80,0x3f223e48be95bf35,0xbe483ec43f553f80,0x3f7b3f6d3f0ea554,0xbef13e483f463f80,0x3e953f553f7f3f35
.quad 0xbf35248d3f353f80,0xbf3525b03f353f80,0xbf62be483f223f80,0xbf75bf55bdc93f35,0xbf7bbec43f0e3f80,0xbe48bf6dbf5525b0,0xbf7fbf0e3ef13f80,0x3f46be48bf75bf35,0xbf6dbf353ec43f80,0x3f6d3f35bec4bf80,0xbf46bf553e953f80,0x3dc93f7b3ef1bf35,0xbf0ebf6d3e483f80,0xbf553ec43f7ba5f7,0xbe95bf7b3dc93f80,0xbf62bf0e3f463f35
.quad 0xa554bf80248d3f80,0xa731bf80261f3f80,0x3e95bf7bbdc93f80,0x3f62bf0ebf463f35,0x3f0ebf6dbe483f80,0x3f553ec4bf7b261f,0x3f46bf55be953f80,0xbdc93f7bbef1bf35,0x3f6dbf35bec43f80,0xbf6d3f353ec4bf80,0x3f7fbf0ebef13f80,0xbf46be483f75bf35,0x3f7bbec4bf0e3f80,0x3e48bf6d3f55a731,0x3f62be48bf223f80,0x3f75bf553dc93f35
.quad 0x3f35a554bf353f80,0x3f35a742bf353f80,0x3ef13e48bf463f80,0xbe953f55bf7f3f35,0x3e483ec4bf553f80,0xbf7b3f6dbf0ea68d,0xbdc93f0ebf623f80,0xbf223e483e95bf35,0xbec43f35bf6d3f80,0x3ec4bf353f6dbf80,0xbf223f55bf753f80,0x3f7fbf7b3f62bf35,0xbf553f6dbf7b3f80,0x3f0ebec43e48a742,0xbf753f7bbf7f3f80,0xbef13f0ebf223f35
.quad 0x3f803f803f803f80,0x3f803f803f803f80,0x3f463f553f623f6d,0x3dc93e483e953ec4,0x3e483ec43f0e3f35,0xbf7bbf6dbf55bf35,0xbef1be483dc93ec4,0xbe95bf0ebf46bf6d,0xbf6dbf35bec4248d,0x3f6d3f353ec4a554,0xbf75bf7bbf46bec4,0x3ef13f553f7f3f6d,0xbf0ebf6dbf7bbf35,0xbf55bec43e483f35,0x3dc9bf0ebf75bf6d,0xbf22bf7bbf62bec4
.quad 0x3f35a554bf35bf80,0x3f35a5f7bf35bf80,0x3f7f3f0ebe95bf6d,0x3f463f7b3ef1bec4,0x3f553f6d3e48bf35,0xbf0e3ec43f7b3f35,0x3e953f7b3f22bec4,0xbf62bf553dc93f6d,0xbec43f353f6da554,0x3ec4bf35bf6d261f,0xbf623e483f7f3ec4,0x3f753f0ebf22bf6d,0xbf7bbec43f553f35,0xbe483f6d3f0ebf35,0xbf22bf553ef13f6d,0xbf7fbe483f753ec4
.quad 0xa5f7bf8025b03f80,0xa742bf80a68d3f80,0x3f22bf55bef13f6d,0x3f7fbe48bf753ec4,0x3f7bbec4bf553f35,0x3e483f6dbf0ebf35,0x3f623e48bf7f3ec4,0xbf753f0e3f22bf6d,0x3ec43f35bf6d25b0,0xbec4bf353f6da742,0xbe953f7bbf22bec4,0x3f62bf55bdc93f6d,0xbf553f6dbe48bf35,0x3f0e3ec4bf7b3f35,0xbf7f3f0e3e95bf6d,0xbf463f7bbef1bec4
.quad 0xbf35261f3f35bf80,0xbf35a60d3f35bf80,0xbdc9bf0e3f75bf6d,0x3f22bf7b3f62bec4,0x3f0ebf6d3f7bbf35,0x3f55bec4be483f35,0x3f75bf7b3f46bec4,0xbef13f55bf7f3f6d,0x3f6dbf353ec4a5f7,0xbf6d3f35bec4a60d,0x3ef1be48bdc93ec4,0x3e95bf0e3f46bf6d,0xbe483ec4bf0e3f35,0x3f7bbf6d3f55bf35,0xbf463f55bf623f6d,0xbdc93e48be953ec4
.quad 0x0,0x0,0x3e953e483dc90000,0x3f623f553f463f35,0x3f0e3ec43e480000,0x3f553f6d3f7b3f80,0x3f463f0e3e950000,0xbdc93e483ef13f35,0x3f6d3f353ec40000,0xbf6dbf35bec4250d,0x3f7f3f553ef10000,0xbf46bf7bbf75bf35,0x3f7b3f6d3f0e0000,0x3e48bec4bf55bf80,0x3f623f7b3f220000,0x3f753f0ebdc9bf35
.quad 0x3f353f803f350000,0x3f353f803f35a58d,0x3ef13f7b3f460000,0xbe953f0e3f7f3f35,0x3e483f6d3f550000,0xbf7bbec43f0e3f80,0xbdc93f553f620000,0xbf22bf7bbe953f35,0xbec43f353f6d0000,0x3ec4bf35bf6d25d4,0xbf223f0e3f750000,0x3f7f3e48bf62bf35,0xbf553ec43f7b0000,0x3f0e3f6dbe48bf80,0xbf753e483f7f0000,0xbef13f553f22bf35
.quad 0xbf80250d3f800000,0xbf8026303f80a60d,0xbf75be483f7f0000,0xbef1bf553f223f35,0xbf55bec43f7b0000,0x3f0ebf6dbe483f80,0xbf22bf0e3f750000,0x3f7fbe48bf623f35,0xbec4bf353f6d0000,0x3ec43f35bf6d2630,0xbdc9bf553f620000,0xbf223f7bbe95bf35,0x3e48bf6d3f550000,0xbf7b3ec43f0ebf80,0x3ef1bf7b3f460000,0xbe95bf0e3f7fbf35
.quad 0x3f35bf803f350000,0x3f35bf803f35a654,0x3f62bf7b3f220000,0x3f75bf0ebdc93f35,0x3f7bbf6d3f0e0000,0x3e483ec4bf553f80,0x3f7fbf553ef10000,0xbf463f7bbf753f35,0x3f6dbf353ec40000,0xbf6d3f35bec42677,0x3f46bf0e3e950000,0xbdc9be483ef1bf35,0x3f0ebec43e480000,0x3f55bf6d3f7bbf80,0x3e95be483dc90000,0x3f62bf553f46bf35
.quad 0x0,0x0,0x3f223f0e3ef13ec4,0x3f7f3f7b3f753f6d,0x3f7b3f6d3f553f35,0x3e483ec43f0e3f35,0x3f623f7b3f7f3f6d,0xbf75bf55bf22bec4,0x3ec43f353f6d3f80,0xbec4bf35bf6dbf80,0xbe953e483f223f6d,0x3f623f0e3dc9bec4,0xbf55bec43e483f35,0x3f0e3f6d3f7b3f35,0xbf7fbf55be953ec4,0xbf46be483ef13f6d
.quad 0xbf35bf80bf35250d,0xbf35bf80bf3525d4,0xbdc9bf55bf75bec4,0x3f22be48bf62bf6d,0x3f0ebec4bf7bbf35,0x3f553f6d3e48bf35,0x3f753e48bf46bf6d,0xbef13f0e3f7f3ec4,0x3f6d3f35bec4bf80,0xbf6dbf353ec43f80,0x3ef13f7b3dc9bf6d,0x3e95bf55bf463ec4,0xbe483f6d3f0ebf35,0x3f7b3ec4bf55bf35,0xbf463f0e3f62bec4,0xbdc93f7b3e95bf6d
.quad 0xbf8025d43f80a58d,0xbf8026773f80a654,0xbf46bf0e3f623ec4,0xbdc9bf7b3e953f6d,0xbe48bf6d3f0e3f35,0x3f7bbec4bf553f35,0x3ef1bf7b3dc93f6d,0x3e953f55bf46bec4,0x3f6dbf35bec43f80,0xbf6d3f353ec4bf80,0x3f75be48bf463f6d,0xbef1bf0e3f7fbec4,0x3f0e3ec4bf7b3f35,0x3f55bf6d3e483f35,0xbdc93f55bf753ec4,0x3f223e48bf623f6d
.quad 0xbf353f80bf3525d4,0xbf353f80bf35269f,0xbf7f3f55be95bec4,0xbf463e483ef1bf6d,0xbf553ec43e48bf35,0x3f0ebf6d3f7bbf35,0xbe95be483f22bf6d,0x3f62bf0e3dc93ec4,0x3ec4bf353f6dbf80,0xbec43f35bf6d3f80,0x3f62bf7b3f7fbf6d,0xbf753f55bf223ec4,0x3f7bbf6d3f55bf35,0x3e48bec43f0ebf35,0x3f22bf0e3ef1bec4,0x3f7fbf7b3f75bf6d
.quad 0x3f803f803f803f80,0x3f803f803f803f80,0xbe95be48bdc9248d,0xbf62bf55bf46bf35,0xbf55bf6dbf7bbf80,0x3f0e3ec43e48a554,0x3f463f0e3e95a554,0xbdc93e483ef13f35,0x3ec43f353f6d3f80,0xbec4bf35bf6dbf80,0xbf7fbf55bef125b0,0x3f463f7b3f753f35,0x3e48bec4bf55bf80,0xbf7bbf6dbf0e261f,0x3f623f7b3f22a5f7,0x3f753f0ebdc9bf35
.quad 0xbf35261f3f353f80,0xbf35a68d3f353f80,0xbef1bf7bbf46261f,0x3e95bf0ebf7fbf35,0x3f7b3ec4bf0ebf80,0x3e483f6d3f55a742,0xbdc93f553f62a731,0xbf22bf7bbe953f35,0xbf6dbf353ec43f80,0x3f6d3f35bec4bf80,0x3f22bf0ebf75a68d,0xbf7fbe483f623f35,0x3f0e3f6dbe48bf80,0x3f55bec4bf7ba60d,0xbf753e483f7fa742,0xbef13f553f22bf35
.quad 0xa754bf80a6543f80,0xa777bf80a58e3f80,0x3f753e48bf7fa654,0x3ef13f55bf22bf35,0xbf0e3f6d3e48bf80,0xbf55bec43f7ba777,0xbf22bf0e3f75a754,0x3f7fbe48bf623f35,0x3f6dbf35bec43f80,0xbf6d3f353ec4bf80,0x3dc93f55bf62a60d,0x3f22bf7b3e953f35,0xbf7b3ec43f0ebf80,0xbe483f6dbf55258d,0x3ef1bf7b3f46a765,0xbe95bf0e3f7fbf35
.quad 0x3f35a777bf353f80,0x3f352754bf353f80,0xbf623f7bbf22a58e,0xbf753f0e3dc9bf35,0xbe48bec43f55bf80,0x3f7bbf6d3f0ea796,0x3f7fbf553ef1a777,0xbf463f7bbf753f35,0xbec43f35bf6d3f80,0x3ec4bf353f6dbf80,0xbf463f0ebe95a137,0x3dc93e48bef13f35,0x3f55bf6d3f7bbf80,0xbf0e3ec4be48268d,0x3e95be483dc9a784,0x3f62bf553f46bf35
.quad 0x3f803f803f803f80,0x3f803f803f803f80,0xbf22bf0ebef1bec4,0xbf7fbf7bbf75bf6d,0xbe48bec4bf0ebf35,0x3f7b3f6d3f553f35,0x3f623f7b3f7f3f6d,0xbf75bf55bf22bec4,0xbf6dbf35bec425b0,0x3f6d3f353ec4a5f7,0x3e95be48bf22bf6d,0xbf62bf0ebdc93ec4,0x3f0e3f6d3f7b3f35,0x3f553ec4be48bf35,0xbf7fbf55be953ec4,0xbf46be483ef13f6d
.quad 0x3f35a731bf35bf80,0x3f35a742bf35bf80,0x3dc93f553f753ec4,0xbf223e483f623f6d,0xbf55bf6dbe483f35,0x3f0ebec4bf7bbf35,0x3f753e48bf46bf6d,0xbef13f0e3f7f3ec4,0xbec43f353f6da742,0x3ec4bf35bf6da60d,0xbef1bf7bbdc93f6d,0xbe953f553f46bec4,0x3f7b3ec4bf55bf35,0x3e48bf6dbf0e3f35,0xbf463f0e3f62bec4,0xbdc93f7b3e95bf6d
.quad 0xa765bf80a60d3f80,0xa784bf80a1373f80,0x3f463f0ebf62bec4,0x3dc93f7bbe95bf6d,0xbf7b3ec43f55bf35,0xbe48bf6d3f0e3f35,0x3ef1bf7b3dc93f6d,0x3e953f55bf46bec4,0x3ec43f35bf6da58e,0xbec4bf353f6da78d,0xbf753e483f46bf6d,0x3ef13f0ebf7f3ec4,0x3f55bf6d3e483f35,0xbf0ebec43f7bbf35,0xbdc93f55bf753ec4,0x3f223e48bf623f6d
.quad 0xbf3528043f35bf80,0xbf3528893f35bf80,0x3f7fbf553e953ec4,0x3f46be48bef13f6d,0xbf0e3f6dbf7b3f35,0xbf553ec43e48bf35,0xbe95be483f22bf6d,0x3f62bf0e3dc93ec4,0x3f6dbf353ec4a78d,0xbf6d3f35bec42816,0xbf623f7bbf7f3f6d,0x3f75bf553f22bec4,0x3e48bec43f0ebf35,0xbf7b3f6dbf553f35,0x3f22bf0e3ef1bec4,0x3f7fbf7b3f75bf6d
.quad 0x0,0x0,0x3f753f7b3f7f3f80,0x3ef13f0e3f223f35,0xbf0ebec4be48250d,0xbf55bf6dbf7bbf80,0xbf22bf55bf75bf80,0x3f7f3f7b3f623f35,0x3f6d3f353ec4a58d,0xbf6dbf35bec425d4,0x3dc93f0e3f623f80,0x3f223e48be95bf35,0xbf7bbf6dbf0e25d4,0xbe483ec43f553f80,0x3ef1be48bf46bf80,0xbe95bf55bf7fbf35
.quad 0x3f353f803f35a60d,0x3f353f803f35a654,0xbf62be483f223f80,0xbf75bf55bdc93f35,0xbe48bf6dbf552630,0x3f7b3ec4bf0ebf80,0x3f7f3f0ebef1bf80,0xbf463e483f753f35,0xbec43f353f6da654,0x3ec4bf35bf6d269f,0xbf46bf553e953f80,0x3dc93f7b3ef1bf35,0x3f55bec4bf7b2677,0xbf0ebf6d3e483f80,0x3e953f7bbdc9bf80,0x3f623f0ebf46bf35
.quad 0xbf80269f3f80a68d,0xbf80a70d3f80a6d4,0x3e95bf7bbdc93f80,0x3f62bf0ebf463f35,0x3f553ec4bf7b269f,0xbf0e3f6d3e48bf80,0xbf463f553e95bf80,0x3dc9bf7b3ef13f35,0xbec4bf353f6da6b0,0x3ec43f35bf6d27c2,0x3f7fbf0ebef13f80,0xbf46be483f75bf35,0xbe483f6dbf5527b1,0x3f7bbec4bf0e3f80,0xbf623e483f22bf80,0xbf753f55bdc9bf35
.quad 0x3f35bf803f35a6d4,0x3f35bf803f35a71f,0x3ef13e48bf463f80,0xbe953f55bf7f3f35,0xbf7b3f6dbf0ea70d,0xbe48bec43f55bf80,0x3dc9bf0e3f62bf80,0x3f22be48be953f35,0x3f6dbf353ec4a6f7,0xbf6d3f35bec4a68d,0xbf223f55bf753f80,0x3f7fbf7b3f62bf35,0xbf0e3ec4be4827c2,0xbf553f6dbf7b3f80,0x3f75bf7b3f7fbf80,0x3ef1bf0e3f22bf35
.quad 0x0,0x0,0x3f463f553f623f6d,0x3dc93e483e953ec4,0xbf7bbf6dbf55bf35,0xbe48bec4bf0ebf35,0x3ef13e48bdc9bec4,0x3e953f0e3f463f6d,0x3ec43f353f6d3f80,0xbec4bf35bf6dbf80,0xbf75bf7bbf46bec4,0x3ef13f553f7f3f6d,0x3f553ec4be48bf35,0xbf0ebf6dbf7bbf35,0xbdc93f0e3f753f6d,0x3f223f7b3f623ec4
.quad 0xbf35bf80bf352630,0xbf35bf80bf352677,0x3f7f3f0ebe95bf6d,0x3f463f7b3ef1bec4,0xbf0e3ec43f7b3f35,0xbf55bf6dbe483f35,0xbe95bf7bbf223ec4,0x3f623f55bdc9bf6d,0x3f6d3f35bec4bf80,0xbf6dbf353ec43f80,0xbf623e483f7f3ec4,0x3f753f0ebf22bf6d,0x3e48bf6dbf0e3f35,0xbf7bbec43f553f35,0x3f223f55bef1bf6d,0x3f7f3e48bf75bec4
.quad 0xbf8027b13f80a6b0,0xbf8027c23f80a6f7,0x3f22bf55bef13f6d,0x3f7fbe48bf753ec4,0x3e483f6dbf0ebf35,0xbf7b3ec43f55bf35,0xbf62be483f7fbec4,0x3f75bf0ebf223f6d,0x3f6dbf35bec43f80,0xbf6d3f353ec4bf80,0xbe953f7bbf22bec4,0x3f62bf55bdc93f6d,0xbf0ebec43f7bbf35,0xbf553f6dbe48bf35,0x3f7fbf0ebe953f6d,0x3f46bf7b3ef13ec4
.quad 0xbf353f80bf3527c2,0xbf353f80bf35a68d,0xbdc9bf0e3f75bf6d,0x3f22bf7b3f62bec4,0x3f55bec4be483f35,0xbf0e3f6dbf7b3f35,0xbf753f7bbf463ec4,0x3ef1bf553f7fbf6d,0x3ec4bf353f6dbf80,0xbec43f35bf6d3f80,0x3ef1be48bdc93ec4,0x3e95bf0e3f46bf6d,0xbf7b3f6dbf553f35,0xbe483ec4bf0e3f35,0x3f46bf553f62bf6d,0x3dc9be483e95bec4
.quad 0x3f803f803f803f80,0x3f803f803f803f80,0xbf75bf7bbf7fbf80,0xbef1bf0ebf22bf35,0x3f553f6d3f7b3f80,0xbf0ebec4be4825b0,0xbf22bf55bf75bf80,0x3f7f3f7b3f623f35,0x3ec43f353f6d3f80,0xbec4bf35bf6dbf80,0xbdc9bf0ebf62bf80,0xbf22be483e953f35,0xbe483ec43f553f80,0x3f7b3f6d3f0ea742,0x3ef1be48bf46bf80,0xbe95bf55bf7fbf35
.quad 0xbf35a6543f353f80,0xbf35a60d3f353f80,0x3f623e48bf22bf80,0x3f753f553dc9bf35,0xbf7bbec43f0e3f80,0xbe48bf6dbf55a58e,0x3f7f3f0ebef1bf80,0xbf463e483f753f35,0xbf6dbf353ec43f80,0x3f6d3f35bec4bf80,0x3f463f55be95bf80,0xbdc9bf7bbef13f35,0xbf0ebf6d3e483f80,0xbf553ec43f7ba78d,0x3e953f7bbdc9bf80,0x3f623f0ebf46bf35
.quad 0xa78dbf80258d3f80,0xa79fbf80280d3f80,0xbe953f7b3dc9bf80,0xbf623f0e3f46bf35,0x3f0ebf6dbe483f80,0x3f553ec4bf7b268d,0xbf463f553e95bf80,0x3dc9bf7b3ef13f35,0x3f6dbf35bec43f80,0xbf6d3f353ec4bf80,0xbf7f3f0e3ef1bf80,0x3f463e48bf753f35,0x3f7bbec4bf0e3f80,0x3e48bf6d3f55270d,0xbf623e483f22bf80,0xbf753f55bdc9bf35
.quad 0x3f352828bf353f80,0x3f3526d4bf353f80,0xbef1be483f46bf80,0x3e95bf553f7fbf35,0x3e483ec4bf553f80,0xbf7b3f6dbf0e2828,0x3dc9bf0e3f62bf80,0x3f22be48be953f35,0xbec43f35bf6d3f80,0x3ec4bf353f6dbf80,0x3f22bf553f75bf80,0xbf7f3f7bbf623f35,0xbf553f6dbf7b3f80,0x3f0ebec43e48a7e5,0x3f75bf7b3f7fbf80,0x3ef1bf0e3f22bf35
.quad 0x3f803f803f803f80,0x3f803f803f803f80,0xbf46bf55bf62bf6d,0xbdc9be48be95bec4,0x3e483ec43f0e3f35,0xbf7bbf6dbf55bf35,0x3ef13e48bdc9bec4,0x3e953f0e3f463f6d,0xbf6dbf35bec4261f,0x3f6d3f353ec4a731,0x3f753f7b3f463ec4,0xbef1bf55bf7fbf6d,0xbf0ebf6dbf7bbf35,0xbf55bec43e483f35,0xbdc93f0e3f753f6d,0x3f223f7b3f623ec4
.quad 0x3f35a754bf35bf80,0x3f35a765bf35bf80,0xbf7fbf0e3e953f6d,0xbf46bf7bbef13ec4,0x3f553f6d3e48bf35,0xbf0e3ec43f7b3f35,0xbe95bf7bbf223ec4,0x3f623f55bdc9bf6d,0xbec43f353f6da777,0x3ec4bf35bf6d2804,0x3f62be48bf7fbec4,0xbf75bf0e3f223f6d,0xbf7bbec43f553f35,0xbe483f6d3f0ebf35,0x3f223f55bef1bf6d,0x3f7f3e48bf75bec4
.quad 0xa796bf80260d3f80,0x2731bf80268d3f80,0xbf223f553ef1bf6d,0xbf7f3e483f75bec4,0x3f7bbec4bf553f35,0x3e483f6dbf0ebf35,0xbf62be483f7fbec4,0x3f75bf0ebf223f6d,0x3ec43f35bf6d268d,0xbec4bf353f6da85d,0x3e95bf7b3f223ec4,0xbf623f553dc9bf6d,0xbf553f6dbe48bf35,0x3f0e3ec4bf7b3f35,0x3f7fbf0ebe953f6d,0x3f46bf7b3ef13ec4
.quad 0xbf35281f3f35bf80,0xbf3527303f35bf80,0x3dc93f0ebf753f6d,0xbf223f7bbf623ec4,0x3f0ebf6d3f7bbf35,0x3f55bec4be483f35,0xbf753f7bbf463ec4,0x3ef1bf553f7fbf6d,0x3f6dbf353ec426d4,0xbf6d3f35bec4289a,0xbef13e483dc9bec4,0xbe953f0ebf463f6d,0xbe483ec4bf0e3f35,0x3f7bbf6d3f55bf35,0x3f46bf553f62bf6d,0x3dc9be483e95bec4
.quad 0x0,0x0,0xbe95be48bdc9250d,0xbf62bf55bf46bf35,0x3f0e3ec43e48a58d,0x3f553f6d3f7b3f80,0xbf46bf0ebe9525d4,0x3dc9be48bef1bf35,0x3f6d3f353ec4a60d,0xbf6dbf35bec42630,0xbf7fbf55bef12630,0x3f463f7b3f753f35,0x3f7b3f6d3f0ea654,0x3e48bec4bf55bf80,0xbf62bf7bbf222677,0xbf75bf0e3dc93f35
.quad 0x3f353f803f35a68d,0x3f353f803f35a6b0,0xbef1bf7bbf46269f,0x3e95bf0ebf7fbf35,0x3e483f6d3f55a6b0,0xbf7bbec43f0e3f80,0x3dc9bf55bf6227b1,0x3f223f7b3e95bf35,0xbec43f353f6da6d4,0x3ec4bf35bf6d27c2,0x3f22bf0ebf75a70d,0xbf7fbe483f623f35,0xbf553ec43f7ba6f7,0x3f0e3f6dbe48bf80,0x3f75be48bf7f27c2,0x3ef1bf55bf223f35
.quad 0xbf80a6d43f80a70d,0xbf80a68d3f80a730,0x3f753e48bf7fa6d4,0x3ef13f55bf22bf35,0xbf55bec43f7ba71f,0x3f0ebf6dbe483f80,0x3f223f0ebf7527d4,0xbf7f3e483f62bf35,0xbec4bf353f6da730,0x3ec43f35bf6da60e,0x3dc93f55bf62a68d,0x3f22bf7b3e953f35,0x3e48bf6d3f55a831,0xbf7b3ec43f0ebf80,0xbef13f7bbf4627e5,0x3e953f0ebf7f3f35
.quad 0x3f35bf803f35a754,0x3f35bf803f35a842,0xbf623f7bbf22a60e,0xbf753f0e3dc9bf35,0x3f7bbf6d3f0e278d,0x3e483ec4bf553f80,0xbf7f3f55bef127f7,0x3f46bf7b3f75bf35,0x3f6dbf353ec4a777,0xbf6d3f35bec4280d,0xbf463f0ebe95a1b7,0x3dc93e48bef13f35,0x3f0ebec43e48a842,0x3f55bf6d3f7bbf80,0xbe953e48bdc92804,0xbf623f55bf463f35
.quad 0x0,0x0,0xbf22bf0ebef1bec4,0xbf7fbf7bbf75bf6d,0x3f7b3f6d3f553f35,0x3e483ec43f0e3f35,0xbf62bf7bbf7fbf6d,0x3f753f553f223ec4,0x3ec43f353f6d3f80,0xbec4bf35bf6dbf80,0x3e95be48bf22bf6d,0xbf62bf0ebdc93ec4,0xbf55bec43e483f35,0x3f0e3f6d3f7b3f35,0x3f7f3f553e95bec4,0x3f463e48bef1bf6d
.quad 0xbf35bf80bf35269f,0xbf35bf80bf3527b1,0x3dc93f553f753ec4,0xbf223e483f623f6d,0x3f0ebec4bf7bbf35,0x3f553f6d3e48bf35,0xbf75be483f463f6d,0x3ef1bf0ebf7fbec4,0x3f6d3f35bec4bf80,0xbf6dbf353ec43f80,0xbef1bf7bbdc93f6d,0xbe953f553f46bec4,0xbe483f6d3f0ebf35,0x3f7b3ec4bf55bf35,0x3f46bf0ebf623ec4,0x3dc9bf7bbe953f6d
.quad 0xbf8027d43f80a71f,0xbf8027e53f80a831,0x3f463f0ebf62bec4,0x3dc93f7bbe95bf6d,0xbe48bf6d3f0e3f35,0x3f7bbec4bf553f35,0xbef13f7bbdc9bf6d,0xbe95bf553f463ec4,0x3f6dbf35bec43f80,0xbf6d3f353ec4bf80,0xbf753e483f46bf6d,0x3ef13f0ebf7f3ec4,0x3f0e3ec4bf7b3f35,0x3f55bf6d3e483f35,0x3dc9bf553f75bec4,0xbf22be483f62bf6d
.quad 0xbf353f80bf3527f7,0xbf353f80bf352884,0x3f7fbf553e953ec4,0x3f46be48bef13f6d,0xbf553ec43e48bf35,0x3f0ebf6d3f7bbf35,0x3e953e48bf223f6d,0xbf623f0ebdc9bec4,0x3ec4bf353f6dbf80,0xbec43f35bf6d3f80,0xbf623f7bbf7f3f6d,0x3f75bf553f22bec4,0x3f7bbf6d3f55bf35,0x3e48bec43f0ebf35,0xbf223f0ebef13ec4,0xbf7f3f7bbf753f6d
.quad 0x3f803f803f803f80,0x3f803f803f803f80,0x3e953e483dc9a554,0x3f623f553f463f35,0xbf55bf6dbf7bbf80,0x3f0e3ec43e48a5f7,0xbf46bf0ebe95261f,0x3dc9be48bef1bf35,0x3ec43f353f6d3f80,0xbec4bf35bf6dbf80,0x3f7f3f553ef1a742,0xbf46bf7bbf75bf35,0x3e48bec4bf55bf80,0xbf7bbf6dbf0ea60d,0xbf62bf7bbf22a60d,0xbf75bf0e3dc93f35
.quad 0xbf35a58e3f353f80,0xbf35a1373f353f80,0x3ef13f7b3f46a777,0xbe953f0e3f7f3f35,0x3f7b3ec4bf0ebf80,0x3e483f6d3f55a78d,0x3dc9bf55bf62258d,0x3f223f7b3e95bf35,0xbf6dbf353ec43f80,0x3f6d3f35bec4bf80,0xbf223f0e3f75a796,0x3f7f3e48bf62bf35,0x3f0e3f6dbe48bf80,0x3f55bec4bf7b2816,0x3f75be48bf7f268d,0x3ef1bf55bf223f35
.quad 0xa7b1bf8028163f80,0xa7c2bf80281f3f80,0xbf75be483f7fa7b1,0xbef1bf553f223f35,0xbf0e3f6d3e48bf80,0xbf55bec43f7b26d4,0x3f223f0ebf75281f,0xbf7f3e483f62bf35,0x3f6dbf35bec43f80,0xbf6d3f353ec4bf80,0xbdc9bf553f6226d4,0xbf223f7bbe95bf35,0xbf7b3ec43f0ebf80,0xbe483f6dbf552754,0xbef13f7bbf462730,0x3e953f0ebf7f3f35
.quad 0x3f35a7e5bf353f80,0x3f35a880bf353f80,0x3f62bf7b3f22a7e5,0x3f75bf0ebdc93f35,0xbe48bec43f55bf80,0x3f7bbf6d3f0ea804,0xbf7f3f55bef12839,0x3f46bf7b3f75bf35,0xbec43f35bf6d3f80,0x3ec4bf353f6dbf80,0x3f46bf0e3e95a880,0xbdc9be483ef1bf35,0x3f55bf6d3f7bbf80,0xbf0e3ec4be48a731,0xbe953e48bdc928a3,0xbf623f55bf463f35
.quad 0x3f803f803f803f80,0x3f803f803f803f80,0x3f223f0e3ef13ec4,0x3f7f3f7b3f753f6d,0xbe48bec4bf0ebf35,0x3f7b3f6d3f553f35,0xbf62bf7bbf7fbf6d,0x3f753f553f223ec4,0xbf6dbf35bec4a68d,0x3f6d3f353ec4a742,0xbe953e483f223f6d,0x3f623f0e3dc9bec4,0x3f0e3f6d3f7b3f35,0x3f553ec4be48bf35,0x3f7f3f553e95bec4,0x3f463e48bef1bf6d
.quad 0x3f35a777bf35bf80,0x3f35a784bf35bf80,0xbdc9bf55bf75bec4,0x3f22be48bf62bf6d,0xbf55bf6dbe483f35,0x3f0ebec4bf7bbf35,0xbf75be483f463f6d,0x3ef1bf0ebf7fbec4,0xbec43f353f6d2754,0x3ec4bf35bf6d2889,0x3ef13f7b3dc9bf6d,0x3e95bf55bf463ec4,0x3f7b3ec4bf55bf35,0x3e48bf6dbf0e3f35,0x3f46bf0ebf623ec4,0x3dc9bf7bbe953f6d
.quad 0x270dbf8026d43f80,0x26d4bf80270d3f80,0xbf46bf0e3f623ec4,0xbdc9bf7b3e953f6d,0xbf7b3ec43f55bf35,0xbe48bf6d3f0e3f35,0xbef13f7bbdc9bf6d,0xbe95bf553f463ec4,0x3ec43f35bf6da7b1,0xbec4bf353f6da7e5,0x3f75be48bf463f6d,0xbef1bf0e3f7fbec4,0x3f55bf6d3e483f35,0xbf0ebec43f7bbf35,0x3dc9bf553f75bec4,0xbf22be483f62bf6d
.quad 0xbf3528393f35bf80,0xbf3528a33f35bf80,0xbf7f3f55be95bec4,0xbf463e483ef1bf6d,0xbf0e3f6dbf7b3f35,0xbf553ec43e48bf35,0x3e953e48bf223f6d,0xbf623f0ebdc9bec4,0x3f6dbf353ec428be,0xbf6d3f35bec428ea,0x3f62bf7b3f7fbf6d,0xbf753f55bf223ec4,0x3e48bec43f0ebf35,0xbf7b3f6dbf553f35,0xbf223f0ebef13ec4,0xbf7f3f7bbf753f6d
.quad 0x0,0x0,0xbf75bf7bbf7fbf80,0xbef1bf0ebf22bf35,0xbf0ebec4be4825d4,0xbf55bf6dbf7bbf80,0x3f223f553f753f80,0xbf7fbf7bbf62bf35,0x3f6d3f353ec4a654,0xbf6dbf35bec42677,0xbdc9bf0ebf62bf80,0xbf22be483e953f35,0xbf7bbf6dbf0e269f,0xbe483ec43f553f80,0xbef13e483f463f80,0x3e953f553f7f3f35
.quad 0x3f353f803f35a6d4,0x3f353f803f35a6f7,0x3f623e48bf22bf80,0x3f753f553dc9bf35,0xbe48bf6dbf5527c2,0x3f7b3ec4bf0ebf80,0xbf7fbf0e3ef13f80,0x3f46be48bf75bf35,0xbec43f353f6da71f,0x3ec4bf35bf6da68d,0x3f463f55be95bf80,0xbdc9bf7bbef13f35,0x3f55bec4bf7ba68d,0xbf0ebf6d3e483f80,0xbe95bf7b3dc93f80,0xbf62bf0e3f463f35
.quad 0xbf80a60e3f80a754,0xbf80a1b73f80a777,0xbe953f7b3dc9bf80,0xbf623f0e3f46bf35,0x3f553ec4bf7b27f7,0xbf0e3f6d3e48bf80,0x3f46bf55be953f80,0xbdc93f7bbef1bf35,0xbec4bf353f6da842,0x3ec43f35bf6d280d,0xbf7f3f0e3ef1bf80,0x3f463e48bf753f35,0xbe483f6dbf55260d,0x3f7bbec4bf0e3f80,0x3f62be48bf223f80,0x3f75bf553dc93f35
.quad 0x3f35bf803f35a79f,0x3f35bf803f35270d,0xbef1be483f46bf80,0x3e95bf553f7fbf35,0xbf7b3f6dbf0e2816,0xbe48bec43f55bf80,0xbdc93f0ebf623f80,0xbf223e483e95bf35,0x3f6dbf353ec4270d,0xbf6d3f35bec42896,0x3f22bf553f75bf80,0xbf7f3f7bbf623f35,0xbf0e3ec4be48270d,0xbf553f6dbf7b3f80,0xbf753f7bbf7f3f80,0xbef13f0ebf223f35
.quad 0x0,0x0,0xbf46bf55bf62bf6d,0xbdc9be48be95bec4,0xbf7bbf6dbf55bf35,0xbe48bec4bf0ebf35,0xbef1be483dc93ec4,0xbe95bf0ebf46bf6d,0x3ec43f353f6d3f80,0xbec4bf35bf6dbf80,0x3f753f7b3f463ec4,0xbef1bf55bf7fbf6d,0x3f553ec4be48bf35,0xbf0ebf6dbf7bbf35,0x3dc9bf0ebf75bf6d,0xbf22bf7bbf62bec4
.quad 0xbf35bf80bf35a70d,0xbf35bf80bf3527c2,0xbf7fbf0e3e953f6d,0xbf46bf7bbef13ec4,0xbf0e3ec43f7b3f35,0xbf55bf6dbe483f35,0x3e953f7b3f22bec4,0xbf62bf553dc93f6d,0x3f6d3f35bec4bf80,0xbf6dbf353ec43f80,0x3f62be48bf7fbec4,0xbf75bf0e3f223f6d,0x3e48bf6dbf0e3f35,0xbf7bbec43f553f35,0xbf22bf553ef13f6d,0xbf7fbe483f753ec4
.quad 0xbf8027f73f80278d,0xbf8028043f80a842,0xbf223f553ef1bf6d,0xbf7f3e483f75bec4,0x3e483f6dbf0ebf35,0xbf7b3ec43f55bf35,0x3f623e48bf7f3ec4,0xbf753f0e3f22bf6d,0x3f6dbf35bec43f80,0xbf6d3f353ec4bf80,0x3e95bf7b3f223ec4,0xbf623f553dc9bf6d,0xbf0ebec43f7bbf35,0xbf553f6dbe48bf35,0xbf7f3f0e3e95bf6d,0xbf463f7bbef1bec4
.quad 0xbf353f80bf35a7d4,0xbf353f80bf352909,0x3dc93f0ebf753f6d,0xbf223f7bbf623ec4,0x3f55bec4be483f35,0xbf0e3f6dbf7b3f35,0x3f75bf7b3f46bec4,0xbef13f55bf7f3f6d,0x3ec4bf353f6dbf80,0xbec43f35bf6d3f80,0xbef13e483dc9bec4,0xbe953f0ebf463f6d,0xbf7b3f6dbf553f35,0xbe483ec4bf0e3f35,0xbf463f55bf623f6d,0xbdc93e48be953ec4
.quad 0xbf803f80bf803f80,0xbf803f80bf803f80,0xbf753f7bbf7f3f80,0xbef13f0ebf223f35,0xbf553f6dbf7b3f80,0x3f0ebec43e48a654,0xbf223f55bf753f80,0x3f7fbf7b3f62bf35,0xbec43f35bf6d3f80,0x3ec4bf353f6dbf80,0xbdc93f0ebf623f80,0xbf223e483e95bf35,0x3e483ec4bf553f80,0xbf7b3f6dbf0ea754,0x3ef13e48bf463f80,0xbe953f55bf7f3f35
.quad 0x3f3525b0bf353f80,0x3f35a58ebf353f80,0x3f62be48bf223f80,0x3f75bf553dc93f35,0x3f7bbec4bf0e3f80,0x3e48bf6d3f55a60d,0x3f7fbf0ebef13f80,0xbf46be483f75bf35,0x3f6dbf35bec43f80,0xbf6d3f353ec4bf80,0x3f46bf55be953f80,0xbdc93f7bbef1bf35,0x3f0ebf6dbe483f80,0x3f553ec4bf7ba765,0x3e95bf7bbdc93f80,0x3f62bf0ebf463f35
.quad 0x261fbf80a5543f80,0x2804bf80a7773f80,0xbe95bf7b3dc93f80,0xbf62bf0e3f463f35,0xbf0ebf6d3e483f80,0xbf553ec43f7ba58e,0xbf46bf553e953f80,0x3dc93f7b3ef1bf35,0xbf6dbf353ec43f80,0x3f6d3f35bec4bf80,0xbf7fbf0e3ef13f80,0x3f46be48bf75bf35,0xbf7bbec43f0e3f80,0xbe48bf6dbf55a777,0xbf62be483f223f80,0xbf75bf55bdc93f35
.quad 0xbf35a5f73f353f80,0xbf35a78d3f353f80,0xbef13e483f463f80,0x3e953f553f7f3f35,0xbe483ec43f553f80,0x3f7b3f6d3f0ea137,0x3dc93f0e3f623f80,0x3f223e48be95bf35,0x3ec43f353f6d3f80,0xbec4bf35bf6dbf80,0x3f223f553f753f80,0xbf7fbf7bbf62bf35,0x3f553f6d3f7b3f80,0xbf0ebec4be48a784,0x3f753f7b3f7f3f80,0x3ef13f0e3f223f35
.quad 0xbf803f80bf803f80,0xbf803f80bf803f80,0xbf463f55bf623f6d,0xbdc93e48be953ec4,0xbe483ec4bf0e3f35,0x3f7bbf6d3f55bf35,0x3ef1be48bdc93ec4,0x3e95bf0e3f46bf6d,0x3f6dbf353ec4261f,0xbf6d3f35bec4a777,0x3f75bf7b3f46bec4,0xbef13f55bf7f3f6d,0x3f0ebf6d3f7bbf35,0x3f55bec4be483f35,0xbdc9bf0e3f75bf6d,0x3f22bf7b3f62bec4
.quad 0xbf35a7423f35bf80,0xbf35a78d3f35bf80,0xbf7f3f0e3e95bf6d,0xbf463f7bbef1bec4,0xbf553f6dbe48bf35,0x3f0e3ec4bf7b3f35,0xbe953f7bbf22bec4,0x3f62bf55bdc93f6d,0x3ec43f35bf6da731,0xbec4bf353f6d258d,0x3f623e48bf7f3ec4,0xbf753f0e3f22bf6d,0x3f7bbec4bf553f35,0x3e483f6dbf0ebf35,0x3f22bf55bef13f6d,0x3f7fbe48bf753ec4
.quad 0xa60dbf80a7423f80,0x2889bf8027543f80,0xbf22bf553ef13f6d,0xbf7fbe483f753ec4,0xbf7bbec43f553f35,0xbe483f6d3f0ebf35,0xbf623e483f7f3ec4,0x3f753f0ebf22bf6d,0xbec43f353f6da68d,0x3ec4bf35bf6da796,0x3e953f7b3f22bec4,0xbf62bf553dc93f6d,0x3f553f6d3e48bf35,0xbf0e3ec43f7b3f35,0x3f7f3f0ebe95bf6d,0x3f463f7b3ef1bec4
.quad 0x3f35a60dbf35bf80,0x3f352816bf35bf80,0x3dc9bf0ebf75bf6d,0xbf22bf7bbf62bec4,0xbf0ebf6dbf7bbf35,0xbf55bec43e483f35,0xbf75bf7bbf46bec4,0x3ef13f553f7f3f6d,0xbf6dbf35bec4a742,0x3f6d3f353ec4268d,0xbef1be483dc93ec4,0xbe95bf0ebf46bf6d,0x3e483ec43f0e3f35,0xbf7bbf6dbf55bf35,0x3f463f553f623f6d,0x3dc93e483e953ec4
.quad 0x25d4a58d250d0000,0x27b1a6b0269fa68d,0xbe953e48bdc90000,0xbf623f55bf463f35,0xbf0e3ec4be480000,0xbf553f6dbf7b3f80,0xbf463f0ebe950000,0x3dc93e48bef13f35,0xbf6d3f35bec40000,0x3f6dbf353ec4269f,0xbf7f3f55bef10000,0x3f46bf7b3f75bf35,0xbf7b3f6dbf0e0000,0xbe48bec43f55bf80,0xbf623f7bbf220000,0xbf753f0e3dc9bf35
.quad 0xbf353f80bf350000,0xbf353f80bf35a6b0,0xbef13f7bbf460000,0x3e953f0ebf7f3f35,0xbe483f6dbf550000,0x3f7bbec4bf0e3f80,0x3dc93f55bf620000,0x3f22bf7b3e953f35,0x3ec43f35bf6d0000,0xbec4bf353f6d27b1,0x3f223f0ebf750000,0xbf7f3e483f62bf35,0x3f553ec4bf7b0000,0xbf0e3f6d3e48bf80,0x3f753e48bf7f0000,0x3ef13f55bf22bf35
.quad 0x3f8025d4bf800000,0x3f8027c2bf80a6d4,0x3f75be48bf7f0000,0x3ef1bf55bf223f35,0x3f55bec4bf7b0000,0xbf0ebf6d3e483f80,0x3f22bf0ebf750000,0xbf7fbe483f623f35,0x3ec4bf35bf6d0000,0xbec43f353f6da70d,0x3dc9bf55bf620000,0x3f223f7b3e95bf35,0xbe48bf6dbf550000,0x3f7b3ec4bf0ebf80,0xbef1bf7bbf460000,0x3e95bf0ebf7fbf35
.quad 0xbf35bf80bf350000,0xbf35bf80bf35a6f7,0xbf62bf7bbf220000,0xbf75bf0e3dc93f35,0xbf7bbf6dbf0e0000,0xbe483ec43f553f80,0xbf7fbf55bef10000,0x3f463f7b3f753f35,0xbf6dbf35bec40000,0x3f6d3f353ec427c2,0xbf46bf0ebe950000,0x3dc9be48bef1bf35,0xbf0ebec4be480000,0xbf55bf6dbf7bbf80,0xbe95be48bdc90000,0xbf62bf55bf46bf35
.quad 0x2677a6542630a60d,0x27c2a6f7a70da6d4,0xbf223f0ebef13ec4,0xbf7f3f7bbf753f6d,0xbf7b3f6dbf553f35,0xbe483ec4bf0e3f35,0xbf623f7bbf7f3f6d,0x3f75bf553f22bec4,0xbec43f35bf6d3f80,0x3ec4bf353f6dbf80,0x3e953e48bf223f6d,0xbf623f0ebdc9bec4,0x3f55bec4be483f35,0xbf0e3f6dbf7b3f35,0x3f7fbf553e953ec4,0x3f46be48bef13f6d
.quad 0x3f35bf803f352630,0x3f35bf803f3527c2,0x3dc9bf553f75bec4,0xbf22be483f62bf6d,0xbf0ebec43f7bbf35,0xbf553f6dbe48bf35,0xbf753e483f46bf6d,0x3ef13f0ebf7f3ec4,0xbf6d3f353ec4bf80,0x3f6dbf35bec43f80,0xbef13f7bbdc9bf6d,0xbe95bf553f463ec4,0x3e483f6dbf0ebf35,0xbf7b3ec43f55bf35,0x3f463f0ebf62bec4,0x3dc93f7bbe95bf6d
.quad 0x3f80269fbf80a654,0x3f80a68dbf80a71f,0x3f46bf0ebf623ec4,0x3dc9bf7bbe953f6d,0x3e48bf6dbf0e3f35,0xbf7bbec43f553f35,0xbef1bf7bbdc93f6d,0xbe953f553f46bec4,0xbf6dbf353ec43f80,0x3f6d3f35bec4bf80,0xbf75be483f463f6d,0x3ef1bf0ebf7fbec4,0xbf0e3ec43f7b3f35,0xbf55bf6dbe483f35,0x3dc93f553f753ec4,0xbf223e483f623f6d
.quad 0x3f353f803f352677,0x3f353f803f35a68d,0x3f7f3f553e95bec4,0x3f463e48bef1bf6d,0x3f553ec4be48bf35,0xbf0ebf6dbf7bbf35,0x3e95be48bf22bf6d,0xbf62bf0ebdc93ec4,0xbec4bf35bf6dbf80,0x3ec43f353f6d3f80,0xbf62bf7bbf7fbf6d,0x3f753f553f223ec4,0xbf7bbf6dbf55bf35,0xbe48bec4bf0ebf35,0xbf22bf0ebef1bec4,0xbf7fbf7bbf75bf6d
.quad 0xbf803f80bf803f80,0xbf803f80bf803f80,0x3e95be483dc9258d,0x3f62bf553f46bf35,0x3f55bf6d3f7bbf80,0xbf0e3ec4be48a7b1,0xbf463f0ebe95a78d,0x3dc93e48bef13f35,0xbec43f35bf6d3f80,0x3ec4bf353f6dbf80,0x3f7fbf553ef1260d,0xbf463f7bbf753f35,0xbe48bec43f55bf80,0x3f7bbf6d3f0e281f,0xbf623f7bbf22a796,0xbf753f0e3dc9bf35
.quad 0x3f35268dbf353f80,0x3f35a7b1bf353f80,0x3ef1bf7b3f46280d,0xbe95bf0e3f7fbf35,0xbf7b3ec43f0ebf80,0xbe483f6dbf5526d4,0x3dc93f55bf62a79f,0x3f22bf7b3e953f35,0x3f6dbf35bec43f80,0xbf6d3f353ec4bf80,0xbf22bf0e3f75268d,0x3f7fbe48bf623f35,0xbf0e3f6d3e48bf80,0xbf55bec43f7b2730,0x3f753e48bf7f2731,0x3ef13f55bf22bf35
.quad 0x281fbf8028283f80,0x2839bf80a7e53f80,0xbf753e483f7f2816,0xbef13f553f22bf35,0x3f0e3f6dbe48bf80,0x3f55bec4bf7ba7e5,0x3f22bf0ebf75a7b1,0xbf7fbe483f623f35,0xbf6dbf353ec43f80,0x3f6d3f35bec4bf80,0xbdc93f553f6226d4,0xbf22bf7bbe953f35,0x3f7b3ec4bf0ebf80,0x3e483f6d3f552839,0xbef1bf7bbf46270d,0x3e95bf0ebf7fbf35
.quad 0xbf3526d43f353f80,0xbf3528be3f353f80,0x3f623f7b3f22281f,0x3f753f0ebdc9bf35,0x3e48bec4bf55bf80,0xbf7bbf6dbf0ea880,0xbf7fbf55bef1a7c2,0x3f463f7b3f753f35,0x3ec43f353f6d3f80,0xbec4bf35bf6dbf80,0x3f463f0e3e95270d,0xbdc93e483ef13f35,0xbf55bf6dbf7bbf80,0x3f0e3ec43e4828a3,0xbe95be48bdc926d4,0xbf62bf55bf46bf35
.quad 0xbf803f80bf803f80,0xbf803f80bf803f80,0x3f22bf0e3ef1bec4,0x3f7fbf7b3f75bf6d,0x3e48bec43f0ebf35,0xbf7b3f6dbf553f35,0xbf623f7bbf7f3f6d,0x3f75bf553f22bec4,0x3f6dbf353ec4268d,0xbf6d3f35bec426d4,0xbe95be483f22bf6d,0x3f62bf0e3dc93ec4,0xbf0e3f6dbf7b3f35,0xbf553ec43e48bf35,0x3f7fbf553e953ec4,0x3f46be48bef13f6d
.quad 0xbf35a85d3f35bf80,0xbf35a7e53f35bf80,0xbdc93f55bf753ec4,0x3f223e48bf623f6d,0x3f55bf6d3e483f35,0xbf0ebec43f7bbf35,0xbf753e483f46bf6d,0x3ef13f0ebf7f3ec4,0x3ec43f35bf6d270d,0xbec4bf353f6d2754,0x3ef1bf7b3dc93f6d,0x3e953f55bf46bec4,0xbf7b3ec43f55bf35,0xbe48bf6d3f0e3f35,0x3f463f0ebf62bec4,0x3dc93f7bbe95bf6d
.quad 0x2730bf8026d43f80,0x28a3bf80a8803f80,0xbf463f0e3f62bec4,0xbdc93f7b3e95bf6d,0x3f7b3ec4bf55bf35,0x3e48bf6dbf0e3f35,0xbef1bf7bbdc93f6d,0xbe953f553f46bec4,0xbec43f353f6d2828,0x3ec4bf35bf6da804,0x3f753e48bf46bf6d,0xbef13f0e3f7f3ec4,0xbf55bf6dbe483f35,0x3f0ebec4bf7bbf35,0x3dc93f553f753ec4,0xbf223e483f623f6d
.quad 0x3f35289abf35bf80,0x3f3528eabf35bf80,0xbf7fbf55be953ec4,0xbf46be483ef13f6d,0x3f0e3f6d3f7b3f35,0x3f553ec4be48bf35,0x3e95be48bf22bf6d,0xbf62bf0ebdc93ec4,0xbf6dbf35bec4a7e5,0x3f6d3f353ec4a731,0x3f623f7b3f7f3f6d,0xbf75bf55bf22bec4,0xbe48bec4bf0ebf35,0x3f7b3f6d3f553f35,0xbf22bf0ebef1bec4,0xbf7fbf7bbf75bf6d
.quad 0x27d4a71fa6d4a70d,0x27f7278da60ea754,0xbf753f7bbf7f3f80,0xbef13f0ebf223f35,0x3f0ebec43e48a6d4,0x3f55bf6d3f7bbf80,0x3f22bf553f75bf80,0xbf7f3f7bbf623f35,0xbf6d3f35bec4a71f,0x3f6dbf353ec427f7,0xbdc93f0ebf623f80,0xbf223e483e95bf35,0x3f7bbf6d3f0e27d4,0x3e483ec4bf553f80,0xbef1be483f46bf80,0x3e95bf553f7fbf35
.quad 0xbf353f80bf35a730,0xbf353f80bf35a842,0x3f62be48bf223f80,0x3f75bf553dc93f35,0x3e48bf6d3f55a68d,0xbf7b3ec43f0ebf80,0xbf7f3f0e3ef1bf80,0x3f463e48bf753f35,0x3ec43f35bf6da831,0xbec4bf353f6d260d,0x3f46bf55be953f80,0xbdc93f7bbef1bf35,0xbf55bec43f7b27e5,0x3f0ebf6dbe483f80,0xbe953f7b3dc9bf80,0xbf623f0e3f46bf35
.quad 0x3f8027f7bf80a754,0x3f80a7d4bf80a79f,0xbe95bf7b3dc93f80,0xbf62bf0e3f463f35,0xbf553ec43f7ba60e,0x3f0e3f6dbe48bf80,0x3f463f55be95bf80,0xbdc9bf7bbef13f35,0x3ec4bf35bf6d278d,0xbec43f353f6d2816,0xbf7fbf0e3ef13f80,0x3f46be48bf75bf35,0x3e483f6d3f5527f7,0xbf7bbec43f0e3f80,0x3f623e48bf22bf80,0x3f753f553dc9bf35
.quad 0xbf35bf80bf35a777,0xbf35bf80bf35270d,0xbef13e483f463f80,0x3e953f553f7f3f35,0x3f7b3f6d3f0ea1b7,0x3e48bec4bf55bf80,0xbdc9bf0ebf62bf80,0xbf22be483e953f35,0xbf6dbf35bec4a842,0x3f6d3f353ec4270d,0x3f223f553f753f80,0xbf7fbf7bbf62bf35,0x3f0e3ec43e482804,0x3f553f6d3f7b3f80,0xbf75bf7bbf7fbf80,0xbef1bf0ebf22bf35
.quad 0x27e5a831a68da730,0x2804a842a1b7a777,0xbf463f55bf623f6d,0xbdc93e48be953ec4,0x3f7bbf6d3f55bf35,0x3e48bec43f0ebf35,0xbef13e483dc9bec4,0xbe953f0ebf463f6d,0xbec43f35bf6d3f80,0x3ec4bf353f6dbf80,0x3f75bf7b3f46bec4,0xbef13f55bf7f3f6d,0xbf553ec43e48bf35,0x3f0ebf6d3f7bbf35,0x3dc93f0ebf753f6d,0xbf223f7bbf623ec4
.quad 0x3f35bf803f35a60e,0x3f35bf803f35280d,0xbf7f3f0e3e95bf6d,0xbf463f7bbef1bec4,0x3f0e3ec4bf7b3f35,0x3f55bf6d3e483f35,0x3e95bf7b3f223ec4,0xbf623f553dc9bf6d,0xbf6d3f353ec4bf80,0x3f6dbf35bec43f80,0x3f623e48bf7f3ec4,0xbf753f0e3f22bf6d,0xbe48bf6d3f0e3f35,0x3f7bbec4bf553f35,0xbf223f553ef1bf6d,0xbf7f3e483f75bec4
.quad 0x3f802884bf80a842,0x3f802909bf80270d,0xbf22bf553ef13f6d,0xbf7fbe483f753ec4,0xbe483f6d3f0ebf35,0x3f7b3ec4bf55bf35,0x3f62be48bf7fbec4,0xbf75bf0e3f223f6d,0xbf6dbf353ec43f80,0x3f6d3f35bec4bf80,0x3e953f7b3f22bec4,0xbf62bf553dc93f6d,0x3f0ebec4bf7bbf35,0x3f553f6d3e48bf35,0xbf7fbf0e3e953f6d,0xbf46bf7bbef13ec4
.quad 0x3f353f803f35280d,0x3f353f803f352896,0x3dc9bf0ebf75bf6d,0xbf22bf7bbf62bec4,0xbf55bec43e483f35,0x3f0e3f6d3f7b3f35,0x3f753f7b3f463ec4,0xbef1bf55bf7fbf6d,0xbec4bf35bf6dbf80,0x3ec43f353f6d3f80,0xbef1be483dc93ec4,0xbe95bf0ebf46bf6d,0x3f7b3f6d3f553f35,0x3e483ec43f0e3f35,0xbf46bf55bf62bf6d,0xbdc9be48be95bec4
.quad 0xbf803f80bf803f80,0xbf803f80bf803f80,0x3f75bf7b3f7fbf80,0x3ef1bf0e3f22bf35,0xbf553f6dbf7b3f80,0x3f0ebec43e482777,0x3f22bf553f75bf80,0xbf7f3f7bbf623f35,0xbec43f35bf6d3f80,0x3ec4bf353f6dbf80,0x3dc9bf0e3f62bf80,0x3f22be48be953f35,0x3e483ec4bf553f80,0xbf7b3f6dbf0ea60d,0xbef1be483f46bf80,0x3e95bf553f7fbf35
.quad 0x3f352777bf353f80,0x3f35a731bf353f80,0xbf623e483f22bf80,0xbf753f55bdc9bf35,0x3f7bbec4bf0e3f80,0x3e48bf6d3f55a731,0xbf7f3f0e3ef1bf80,0x3f463e48bf753f35,0x3f6dbf35bec43f80,0xbf6d3f353ec4bf80,0xbf463f553e95bf80,0x3dc9bf7b3ef13f35,0x3f0ebf6dbe483f80,0x3f553ec4bf7b27c2,0xbe953f7b3dc9bf80,0xbf623f0e3f46bf35
.quad 0xa731bf8027e63f80,0x286ebf80a92a3f80,0x3e953f7bbdc9bf80,0x3f623f0ebf46bf35,0xbf0ebf6d3e483f80,0xbf553ec43f7b28b5,0x3f463f55be95bf80,0xbdc9bf7bbef13f35,0xbf6dbf353ec43f80,0x3f6d3f35bec4bf80,0x3f7f3f0ebef1bf80,0xbf463e483f753f35,0xbf7bbec43f0e3f80,0xbe48bf6dbf55a89a,0x3f623e48bf22bf80,0x3f753f553dc9bf35
.quad 0xbf35285d3f353f80,0xbf3527773f353f80,0x3ef1be48bf46bf80,0xbe95bf55bf7fbf35,0xbe483ec43f553f80,0x3f7b3f6d3f0e2880,0xbdc9bf0ebf62bf80,0xbf22be483e953f35,0x3ec43f353f6d3f80,0xbec4bf35bf6dbf80,0xbf22bf55bf75bf80,0x3f7f3f7b3f623f35,0x3f553f6d3f7b3f80,0xbf0ebec4be48a84b,0xbf75bf7bbf7fbf80,0xbef1bf0ebf22bf35
.quad 0xbf803f80bf803f80,0xbf803f80bf803f80,0x3f46bf553f62bf6d,0x3dc9be483e95bec4,0xbe483ec4bf0e3f35,0x3f7bbf6d3f55bf35,0xbef13e483dc9bec4,0xbe953f0ebf463f6d,0x3f6dbf353ec42839,0xbf6d3f35bec4a8c7,0xbf753f7bbf463ec4,0x3ef1bf553f7fbf6d,0x3f0ebf6d3f7bbf35,0x3f55bec4be483f35,0x3dc93f0ebf753f6d,0xbf223f7bbf623ec4
.quad 0xbf35a60d3f35bf80,0xbf35a8cf3f35bf80,0x3f7fbf0ebe953f6d,0x3f46bf7b3ef13ec4,0xbf553f6dbe48bf35,0x3f0e3ec4bf7b3f35,0x3e95bf7b3f223ec4,0xbf623f553dc9bf6d,0x3ec43f35bf6d27e6,0xbec4bf353f6d28f3,0xbf62be483f7fbec4,0x3f75bf0ebf223f6d,0x3f7bbec4bf553f35,0x3e483f6dbf0ebf35,0xbf223f553ef1bf6d,0xbf7f3e483f75bec4
.quad 0x27c2bf80a6d43f80,0xa804bf80284b3f80,0x3f223f55bef1bf6d,0x3f7f3e48bf75bec4,0xbf7bbec43f553f35,0xbe483f6d3f0ebf35,0x3f62be48bf7fbec4,0xbf75bf0e3f223f6d,0xbec43f353f6d27c2,0x3ec4bf35bf6da90f,0xbe95bf7bbf223ec4,0x3f623f55bdc9bf6d,0x3f553f6d3e48bf35,0xbf0e3ec43f7b3f35,0xbf7fbf0e3e953f6d,0xbf46bf7bbef13ec4
.quad 0x3f35291dbf35bf80,0x3f352889bf35bf80,0xbdc93f0e3f753f6d,0x3f223f7b3f623ec4,0xbf0ebf6dbf7bbf35,0xbf55bec43e483f35,0x3f753f7b3f463ec4,0xbef1bf55bf7fbf6d,0xbf6dbf35bec4a89a,0x3f6d3f353ec42926,0x3ef13e48bdc9bec4,0x3e953f0e3f463f6d,0x3e483ec43f0e3f35,0xbf7bbf6dbf55bf35,0xbf46bf55bf62bf6d,0xbdc9be48be95bec4
.quad 0x280d2754260da78d,0x281f270d288da7b0,0x3e95be483dc9260d,0x3f62bf553f46bf35,0xbf0e3ec4be482754,0xbf553f6dbf7b3f80,0x3f46bf0e3e95280d,0xbdc9be483ef1bf35,0xbf6d3f35bec4a79f,0x3f6dbf353ec4270d,0x3f7fbf553ef1268d,0xbf463f7bbf753f35,0xbf7b3f6dbf0ea854,0xbe48bec43f55bf80,0x3f62bf7b3f222816,0x3f75bf0ebdc93f35
.quad 0xbf353f80bf35a7b0,0xbf353f80bf35268e,0x3ef1bf7b3f46288d,0xbe95bf0e3f7fbf35,0xbe483f6dbf55270d,0x3f7bbec4bf0e3f80,0xbdc9bf553f62281f,0xbf223f7bbe95bf35,0x3ec43f35bf6da8b1,0xbec4bf353f6da78d,0xbf22bf0e3f75270d,0x3f7fbe48bf623f35,0x3f553ec4bf7ba865,0xbf0e3f6d3e48bf80,0xbf75be483f7fa7b1,0xbef1bf553f223f35
.quad 0x3f80a8a8bf80a7d4,0x3f80a754bf80a8c2,0xbf753e483f7f2896,0xbef13f553f22bf35,0x3f55bec4bf7b268e,0xbf0ebf6d3e483f80,0xbf223f0e3f752831,0x3f7f3e48bf62bf35,0x3ec4bf35bf6d280d,0xbec43f353f6d28a8,0xbdc93f553f622754,0xbf22bf7bbe953f35,0xbe48bf6dbf55a877,0x3f7b3ec4bf0ebf80,0x3ef13f7b3f46a78d,0xbe953f0e3f7f3f35
.quad 0xbf35bf80bf35a7f7,0xbf35bf80bf35a88d,0x3f623f7b3f22289f,0x3f753f0ebdc9bf35,0xbf7bbf6dbf0e2237,0xbe483ec43f553f80,0x3f7f3f553ef12842,0xbf46bf7bbf75bf35,0xbf6dbf35bec4a8c2,0x3f6d3f353ec42865,0x3f463f0e3e95278d,0xbdc93e483ef13f35,0xbf0ebec4be48a884,0xbf55bf6dbf7bbf80,0x3e953e483dc9a754,0x3f623f553f463f35
.quad 0x2816a854268da79f,0xa7b1a865270da8b1,0x3f22bf0e3ef1bec4,0x3f7fbf7b3f75bf6d,0xbf7b3f6dbf553f35,0xbe483ec4bf0e3f35,0x3f62bf7b3f7fbf6d,0xbf753f55bf223ec4,0xbec43f35bf6d3f80,0x3ec4bf353f6dbf80,0xbe95be483f22bf6d,0x3f62bf0e3dc93ec4,0x3f55bec4be483f35,0xbf0e3f6dbf7b3f35,0xbf7f3f55be95bec4,0xbf463e483ef1bf6d
.quad 0x3f35bf803f35270d,0x3f35bf803f3528dd,0xbdc93f55bf753ec4,0x3f223e48bf623f6d,0xbf0ebec43f7bbf35,0xbf553f6dbe48bf35,0x3f75be48bf463f6d,0xbef1bf0e3f7fbec4,0xbf6d3f353ec4bf80,0x3f6dbf35bec43f80,0x3ef1bf7b3dc93f6d,0x3e953f55bf46bec4,0x3e483f6dbf0ebf35,0xbf7b3ec43f55bf35,0xbf46bf0e3f623ec4,0xbdc9bf7b3e953f6d
.quad 0x3f80289fbf80a877,0x3f8027b0bf80a904,0xbf463f0e3f62bec4,0xbdc93f7b3e95bf6d,0x3e48bf6dbf0e3f35,0xbf7bbec43f553f35,0x3ef13f7b3dc9bf6d,0x3e95bf55bf463ec4,0xbf6dbf353ec43f80,0x3f6d3f35bec4bf80,0x3f753e48bf46bf6d,0xbef13f0e3f7f3ec4,0xbf0e3ec43f7b3f35,0xbf55bf6dbe483f35,0xbdc9bf55bf75bec4,0x3f22be48bf62bf6d
.quad 0x3f353f803f35a754,0x3f353f803f35291a,0xbf7fbf55be953ec4,0xbf46be483ef13f6d,0x3f553ec4be48bf35,0xbf0ebf6dbf7bbf35,0xbe953e483f223f6d,0x3f623f0e3dc9bec4,0xbec4bf35bf6dbf80,0x3ec43f353f6d3f80,0x3f623f7b3f7f3f6d,0xbf75bf55bf22bec4,0xbf7bbf6dbf55bf35,0xbe48bec4bf0ebf35,0x3f223f0e3ef13ec4,0x3f7f3f7b3f753f6d
.quad 0xbf803f80bf803f80,0xbf803f80bf803f80,0xbe953e48bdc927e6,0xbf623f55bf463f35,0x3f55bf6d3f7bbf80,0xbf0e3ec4be48a892,0x3f46bf0e3e95a731,0xbdc9be483ef1bf35,0xbec43f35bf6d3f80,0x3ec4bf353f6dbf80,0xbf7f3f55bef1a6d4,0x3f46bf7b3f75bf35,0xbe48bec43f55bf80,0x3f7bbf6d3f0e27e5,0x3f62bf7b3f2227c2,0x3f75bf0ebdc93f35
.quad 0x3f35a816bf353f80,0x3f35a880bf353f80,0xbef13f7bbf46a828,0x3e953f0ebf7f3f35,0xbf7b3ec43f0ebf80,0xbe483f6dbf552777,0xbdc9bf553f62286e,0xbf223f7bbe95bf35,0x3f6dbf35bec43f80,0xbf6d3f353ec4bf80,0x3f223f0ebf75a89a,0xbf7f3e483f62bf35,0xbf0e3f6d3e48bf80,0xbf55bec43f7b2889,0xbf75be483f7f28be,0xbef1bf553f223f35
.quad 0x2902bf80a8e13f80,0xa85dbf80a85d3f80,0x3f75be48bf7f2777,0x3ef1bf55bf223f35,0x3f0e3f6dbe48bf80,0x3f55bec4bf7ba918,0xbf223f0e3f75260c,0x3f7f3e48bf62bf35,0xbf6dbf353ec43f80,0x3f6d3f35bec4bf80,0x3dc9bf55bf62a79f,0x3f223f7b3e95bf35,0x3f7b3ec4bf0ebf80,0x3e483f6d3f55a79f,0x3ef13f7b3f462926,0xbe953f0e3f7f3f35
.quad 0xbf3528cf3f353f80,0xbf35a8803f353f80,0xbf62bf7bbf22a85d,0xbf75bf0e3dc93f35,0x3e48bec4bf55bf80,0xbf7bbf6dbf0ea880,0x3f7f3f553ef1a85d,0xbf46bf7bbf75bf35,0x3ec43f353f6d3f80,0xbec4bf35bf6dbf80,0xbf46bf0ebe95a8b5,0x3dc9be48bef1bf35,0xbf55bf6dbf7bbf80,0x3f0e3ec43e482914,0x3e953e483dc9a79f,0x3f623f553f463f35
.quad 0xbf803f80bf803f80,0xbf803f80bf803f80,0xbf223f0ebef13ec4,0xbf7f3f7bbf753f6d,0x3e48bec43f0ebf35,0xbf7b3f6dbf553f35,0x3f62bf7b3f7fbf6d,0xbf753f55bf223ec4,0x3f6dbf353ec427c2,0xbf6d3f35bec4a89a,0x3e953e48bf223f6d,0xbf623f0ebdc9bec4,0xbf0e3f6dbf7b3f35,0xbf553ec43e48bf35,0xbf7f3f55be95bec4,0xbf463e483ef1bf6d
.quad 0xbf35a89a3f35bf80,0xbf35a84b3f35bf80,0x3dc9bf553f75bec4,0xbf22be483f62bf6d,0x3f55bf6d3e483f35,0xbf0ebec43f7bbf35,0x3f75be48bf463f6d,0xbef1bf0e3f7fbec4,0x3ec43f35bf6d28e1,0xbec4bf353f6d2926,0xbef13f7bbdc9bf6d,0xbe95bf553f463ec4,0xbf7b3ec43f55bf35,0xbe48bf6d3f0e3f35,0xbf46bf0e3f623ec4,0xbdc9bf7b3e953f6d
.quad 0xa8b5bf80a79f3f80,0xa79fbf80a8b53f80,0x3f46bf0ebf623ec4,0x3dc9bf7bbe953f6d,0x3f7b3ec4bf55bf35,0x3e48bf6dbf0e3f35,0x3ef13f7b3dc9bf6d,0x3e95bf55bf463ec4,0xbec43f353f6d26d3,0x3ec4bf35bf6da8fc,0xbf75be483f463f6d,0x3ef1bf0ebf7fbec4,0xbf55bf6dbe483f35,0x3f0ebec4bf7bbf35,0xbdc9bf55bf75bec4,0x3f22be48bf62bf6d
.quad 0x3f35296cbf35bf80,0x3f352914bf35bf80,0x3f7f3f553e95bec4,0x3f463e48bef1bf6d,0x3f0e3f6d3f7b3f35,0x3f553ec4be48bf35,0xbe953e483f223f6d,0x3f623f0e3dc9bec4,0xbf6dbf35bec42902,0x3f6d3f353ec428ac,0xbf62bf7bbf7fbf6d,0x3f753f553f223ec4,0xbe48bec4bf0ebf35,0x3f7b3f6d3f553f35,0x3f223f0e3ef13ec4,0x3f7f3f7b3f753f6d
.quad 0x2831268e2896a7d4,0x28422237289fa7f7,0x3f75bf7b3f7fbf80,0x3ef1bf0e3f22bf35,0x3f0ebec43e482831,0x3f55bf6d3f7bbf80,0xbf223f55bf753f80,0x3f7fbf7b3f62bf35,0xbf6d3f35bec4a877,0x3f6dbf353ec4a754,0x3dc9bf0e3f62bf80,0x3f22be48be953f35,0x3f7bbf6d3f0e289f,0x3e483ec4bf553f80,0x3ef13e48bf463f80,0xbe953f55bf7f3f35
.quad 0xbf353f80bf35a8c2,0xbf353f80bf35a88d,0xbf623e483f22bf80,0xbf753f55bdc9bf35,0x3e48bf6d3f55a754,0xbf7b3ec43f0ebf80,0x3f7fbf0ebef13f80,0xbf46be483f75bf35,0x3ec43f35bf6da68d,0xbec4bf353f6d27d4,0xbf463f553e95bf80,0x3dc9bf7b3ef13f35,0xbf55bec43f7b27b0,0x3f0ebf6dbe483f80,0x3e95bf7bbdc93f80,0x3f62bf0ebf463f35
.quad 0x3f802865bf80a81f,0x3f802900bf80278d,0x3e953f7bbdc9bf80,0x3f623f0ebf46bf35,0xbf553ec43f7b2865,0x3f0e3f6dbe48bf80,0xbf46bf553e953f80,0x3dc93f7b3ef1bf35,0x3ec4bf35bf6da896,0xbec43f353f6d2884,0x3f7f3f0ebef1bf80,0xbf463e483f753f35,0x3e483f6d3f5528b9,0xbf7bbec43f0e3f80,0xbf62be483f223f80,0xbf75bf55bdc93f35
.quad 0xbf35bf80bf35278d,0xbf35bf80bf35a916,0x3ef1be48bf46bf80,0xbe95bf55bf7fbf35,0x3f7b3f6d3f0e2900,0x3e48bec4bf55bf80,0x3dc93f0e3f623f80,0x3f223e48be95bf35,0xbf6dbf35bec4a78d,0x3f6d3f353ec4a7b1,0xbf22bf55bf75bf80,0x3f7f3f7b3f623f35,0x3f0e3ec43e482923,0x3f553f6d3f7b3f80,0x3f753f7b3f7f3f80,0x3ef13f0e3f223f35
.quad 0xa78da8772754280d,0xa754a884278da8c2,0x3f46bf553f62bf6d,0x3dc9be483e95bec4,0x3f7bbf6d3f55bf35,0x3e48bec43f0ebf35,0x3ef1be48bdc93ec4,0x3e95bf0e3f46bf6d,0xbec43f35bf6d3f80,0x3ec4bf353f6dbf80,0xbf753f7bbf463ec4,0x3ef1bf553f7fbf6d,0xbf553ec43e48bf35,0x3f0ebf6d3f7bbf35,0xbdc9bf0e3f75bf6d,0x3f22bf7b3f62bec4
.quad 0x3f35bf803f35a831,0x3f35bf803f352865,0x3f7fbf0ebe953f6d,0x3f46bf7b3ef13ec4,0x3f0e3ec4bf7b3f35,0x3f55bf6d3e483f35,0xbe953f7bbf22bec4,0x3f62bf55bdc93f6d,0xbf6d3f353ec4bf80,0x3f6dbf35bec43f80,0xbf62be483f7fbec4,0x3f75bf0ebf223f6d,0xbe48bf6d3f0e3f35,0x3f7bbec4bf553f35,0x3f22bf55bef13f6d,0x3f7fbe48bf753ec4
.quad 0x3f8028b9bf802854,0x3f802923bf80a989,0x3f223f55bef1bf6d,0x3f7f3e48bf75bec4,0xbe483f6d3f0ebf35,0x3f7b3ec4bf55bf35,0xbf623e483f7f3ec4,0x3f753f0ebf22bf6d,0xbf6dbf353ec43f80,0x3f6d3f35bec4bf80,0xbe95bf7bbf223ec4,0x3f623f55bdc9bf6d,0x3f0ebec4bf7bbf35,0x3f553f6d3e48bf35,0x3f7f3f0ebe95bf6d,0x3f463f7b3ef1bec4
.quad 0x3f353f803f35a93e,0x3f353f803f35296a,0xbdc93f0e3f753f6d,0x3f223f7b3f623ec4,0xbf55bec43e483f35,0x3f0e3f6d3f7b3f35,0xbf75bf7bbf46bec4,0x3ef13f553f7f3f6d,0xbec4bf35bf6dbf80,0x3ec43f353f6d3f80,0x3ef13e48bdc9bec4,0x3e953f0e3f463f6d,0x3f7b3f6d3f553f35,0x3e483ec43f0e3f35,0x3f463f553f623f6d,0x3dc93e483e953ec4
.quad 0x3f800000,0x3f800000,0x800000003f800000,0x800000003f800000,0x3f800000,0x3b490fc63f7fffb1,0x800000003f800000,0xbb490fc63f7fffb1,0x3f800000,0x3bc90f883f7ffec4,0x800000003f800000,0xbbc90f883f7ffec4,0x3f800000,0x3c16cb583f7ffd39,0x800000003f800000,0xbc16cb583f7ffd39
.quad 0x3f800000,0x3c490e903f7ffb11,0x800000003f800000,0xbc490e903f7ffb11,0x3f800000,0x3c7b514b3f7ff84a,0x800000003f800000,0xbc7b514b3f7ff84a,0x3f800000,0x3c96c9b63f7ff4e6,0x800000003f800000,0xbc96c9b63f7ff4e6,0x3f800000,0x3cafea693f7ff0e3,0x800000003f800000,0xbcafea693f7ff0e3
.quad 0x3f800000,0x3cc90ab03f7fec43,0x800000003f800000,0xbcc90ab03f7fec43,0x3f800000,0x3ce22a7a3f7fe705,0x800000003f800000,0xbce22a7a3f7fe705,0x3f800000,0x3cfb49ba3f7fe129,0x800000003f800000,0xbcfb49ba3f7fe129,0x3f800000,0x3d0a342f3f7fdaaf,0x800000003f800000,0xbd0a342f3f7fdaaf
.quad 0x3f800000,0x3d16c32c3f7fd397,0x800000003f800000,0xbd16c32c3f7fd397,0x3f800000,0x3d2351cb3f7fcbe2,0x800000003f800000,0xbd2351cb3f7fcbe2,0x3f800000,0x3d2fe0073f7fc38f,0x800000003f800000,0xbd2fe0073f7fc38f,0x3f800000,0x3d3c6dd53f7fba9e,0x800000003f800000,0xbd3c6dd53f7fba9e
.quad 0x3f800000,0x3f800000,0x800000003f800000,0x800000003f800000,0x3c490e903f7ffb11,0x3c7b514b3f7ff84a,0xbc490e903f7ffb11,0xbc7b514b3f7ff84a,0x3cc90ab03f7fec43,0x3cfb49ba3f7fe129,0xbcc90ab03f7fec43,0xbcfb49ba3f7fe129,0x3d16c32c3f7fd397,0x3d3c6dd53f7fba9e,0xbd16c32c3f7fd397,0xbd3c6dd53f7fba9e
.quad 0x3d48fb303f7fb10f,0x3d7b2b743f7f84ab,0xbd48fb303f7fb10f,0xbd7b2b743f7f84ab,0x3d7b2b743f7f84ab,0x3d9cecf93f7f3f54,0xbd7b2b743f7f84ab,0xbd9cecf93f7f3f54,0x3d96a9053f7f4e6d,0x3dbc3ac33f7eea9d,0xbd96a9053f7f4e6d,0xbdbc3ac33f7eea9d,0x3dafb6803f7f0e58,0x3ddb7d373f7e868b,0xbdafb6803f7f0e58,0xbddb7d373f7e868b
.quad 0x3dc8bd363f7ec46d,0x3dfab2733f7e1324,0xbdc8bd363f7ec46d,0xbdfab2733f7e1324,0x3de1bc2e3f7e70b0,0x3e0cec4a3f7d906e,0xbde1bc2e3f7e70b0,0xbe0cec4a3f7d906e,0x3dfab2733f7e1324,0x3e1c76de3f7cfe73,0xbdfab2733f7e1324,0xbe1c76de3f7cfe73,0x3e09cf863f7dabcc,0x3e2bf8043f7c5d3a,0xbe09cf863f7dabcc,0xbe2bf8043f7c5d3a
.quad 0x3e1640833f7d3aac,0x3e3b6ecf3f7baccd,0xbe1640833f7d3aac,0xbe3b6ecf3f7baccd,0x3e22abb63f7cbfc9,0x3e4ada4f3f7aed37,0xbe22abb63f7cbfc9,0xbe4ada4f3f7aed37,0x3e2f10a23f7c3b28,0x3e5a39973f7a1e84,0xbe2f10a23f7c3b28,0xbe5a39973f7a1e84,0x3e3b6ecf3f7baccd,0x3e698bba3f7940c0,0xbe3b6ecf3f7baccd,0xbe698bba3f7940c0
.quad 0x3f800000,0x3f800000,0x800000003f800000,0x800000003f800000,0x3bc90f883f7ffec4,0x3c16cb583f7ffd39,0xbbc90f883f7ffec4,0xbc16cb583f7ffd39,0x3c490e903f7ffb11,0x3c96c9b63f7ff4e6,0xbc490e903f7ffb11,0xbc96c9b63f7ff4e6,0x3c96c9b63f7ff4e6,0x3ce22a7a3f7fe705,0xbc96c9b63f7ff4e6,0xbce22a7a3f7fe705
.quad 0x3cc90ab03f7fec43,0x3d16c32c3f7fd397,0xbcc90ab03f7fec43,0xbd16c32c3f7fd397,0x3cfb49ba3f7fe129,0x3d3c6dd53f7fba9e,0xbcfb49ba3f7fe129,0xbd3c6dd53f7fba9e,0x3d16c32c3f7fd397,0x3d6214693f7f9c18,0xbd16c32c3f7fd397,0xbd6214693f7f9c18,0x3d2fe0073f7fc38f,0x3d83db0a3f7f7808,0xbd2fe0073f7fc38f,0xbd83db0a3f7f7808
.quad 0x3d48fb303f7fb10f,0x3d96a9053f7f4e6d,0xbd48fb303f7fb10f,0xbd96a9053f7f4e6d,0x3d6214693f7f9c18,0x3da973ba3f7f1f49,0xbd6214693f7f9c18,0xbda973ba3f7f1f49,0x3d7b2b743f7f84ab,0x3dbc3ac33f7eea9d,0xbd7b2b743f7f84ab,0xbdbc3ac33f7eea9d,0x3d8a200a3f7f6ac7,0x3dcefdb73f7eb069,0xbd8a200a3f7f6ac7,0xbdcefdb73f7eb069
.quad 0x3d96a9053f7f4e6d,0x3de1bc2e3f7e70b0,0xbd96a9053f7f4e6d,0xbde1bc2e3f7e70b0,0x3da3308c3f7f2f9d,0x3df475c03f7e2b72,0xbda3308c3f7f2f9d,0xbdf475c03f7e2b72,0x3dafb6803f7f0e58,0x3e0395023f7de0b1,0xbdafb6803f7f0e58,0xbe0395023f7de0b1,0x3dbc3ac33f7eea9d,0x3e0cec4a3f7d906e,0xbdbc3ac33f7eea9d,0xbe0cec4a3f7d906e
.quad 0x3f800000,0x3f800000,0x800000003f800000,0x800000003f800000,0x3c96c9b63f7ff4e6,0x3cafea693f7ff0e3,0xbc96c9b63f7ff4e6,0xbcafea693f7ff0e3,0x3d16c32c3f7fd397,0x3d2fe0073f7fc38f,0xbd16c32c3f7fd397,0xbd2fe0073f7fc38f,0x3d6214693f7f9c18,0x3d83db0a3f7f7808,0xbd6214693f7f9c18,0xbd83db0a3f7f7808
.quad 0x3d96a9053f7f4e6d,0x3dafb6803f7f0e58,0xbd96a9053f7f4e6d,0xbdafb6803f7f0e58,0x3dbc3ac33f7eea9d,0x3ddb7d373f7e868b,0xbdbc3ac33f7eea9d,0xbddb7d373f7e868b,0x3de1bc2e3f7e70b0,0x3e0395023f7de0b1,0xbde1bc2e3f7e70b0,0xbe0395023f7de0b1,0x3e0395023f7de0b1,0x3e195be03f7d1cdd,0xbe0395023f7de0b1,0xbe195be03f7d1cdd
.quad 0x3e1640833f7d3aac,0x3e2f10a23f7c3b28,0xbe1640833f7d3aac,0xbe2f10a23f7c3b28,0x3e28defc3f7c7eb0,0x3e44b0b93f7b3bab,0xbe28defc3f7c7eb0,0xbe44b0b93f7b3bab,0x3e3b6ecf3f7baccd,0x3e5a39973f7a1e84,0xbe3b6ecf3f7baccd,0xbe5a39973f7a1e84,0x3e4dee603f7ac516,0x3e6fa8b23f78e3d6,0xbe4dee603f7ac516,0xbe6fa8b23f78e3d6
.quad 0x3e605c133f79c79d,0x3e827dc03f778bc5,0xbe605c133f79c79d,0xbe827dc03f778bc5,0x3e72b6513f78b47b,0x3e8d17c03f76167a,0xbe72b6513f78b47b,0xbe8d17c03f76167a,0x3e827dc03f778bc5,0x3e97a1173f748422,0xbe827dc03f778bc5,0xbe97a1173f748422,0x3e8b95073f764d97,0x3ea218873f72d4eb,0xbe8b95073f764d97,0xbea218873f72d4eb
.quad 0x3f800000,0x3f800000,0x800000003f800000,0x800000003f800000,0x3cc90ab03f7fec43,0x3ce22a7a3f7fe705,0xbcc90ab03f7fec43,0xbce22a7a3f7fe705,0x3d48fb303f7fb10f,0x3d6214693f7f9c18,0xbd48fb303f7fb10f,0xbd6214693f7f9c18,0x3d96a9053f7f4e6d,0x3da973ba3f7f1f49,0xbd96a9053f7f4e6d,0xbda973ba3f7f1f49
.quad 0x3dc8bd363f7ec46d,0x3de1bc2e3f7e70b0,0xbdc8bd363f7ec46d,0xbde1bc2e3f7e70b0,0x3dfab2733f7e1324,0x3e0cec4a3f7d906e,0xbdfab2733f7e1324,0xbe0cec4a3f7d906e,0x3e1640833f7d3aac,0x3e28defc3f7c7eb0,0xbe1640833f7d3aac,0xbe28defc3f7c7eb0,0x3e2f10a23f7c3b28,0x3e44b0b93f7b3bab,0xbe2f10a23f7c3b28,0xbe44b0b93f7b3bab
.quad 0x3e47c5c23f7b14be,0x3e605c133f79c79d,0xbe47c5c23f7b14be,0xbe605c133f79c79d,0x3e605c133f79c79d,0x3e7bdba43f7822d1,0xbe605c133f79c79d,0xbe7bdba43f7822d1,0x3e78cfcc3f7853f8,0x3e8b95073f764d97,0xbe78cfcc3f7853f8,0xbe8b95073f764d97,0x3e888e933f76ba07,0x3e9920fe3f74484b,0xbe888e933f76ba07,0xbe9920fe3f74484b
.quad 0x3e94a0313f74fa0b,0x3ea68f123f721352,0xbe94a0313f74fa0b,0xbea68f123f721352,0x3ea09ae53f731447,0x3eb3dca53f6faf1b,0xbea09ae53f731447,0xbeb3dca53f6faf1b,0x3eac7cd43f710908,0x3ec1071e3f6d1c1d,0xbeac7cd43f710908,0xbec1071e3f6d1c1d,0x3eb8442a3f6ed89e,0x3ece0bea3f6a5ad9,0xbeb8442a3f6ed89e,0xbece0bea3f6a5ad9
.quad 0x3f800000,0x3f800000,0x800000003f800000,0x800000003f800000,0x3d16c32c3f7fd397,0x3d2351cb3f7fcbe2,0xbd16c32c3f7fd397,0xbd2351cb3f7fcbe2,0x3d96a9053f7f4e6d,0x3da3308c3f7f2f9d,0xbd96a9053f7f4e6d,0xbda3308c3f7f2f9d,0x3de1bc2e3f7e70b0,0x3df475c03f7e2b72,0xbde1bc2e3f7e70b0,0xbdf475c03f7e2b72
.quad 0x3e1640833f7d3aac,0x3e22abb63f7cbfc9,0xbe1640833f7d3aac,0xbe22abb63f7cbfc9,0x3e3b6ecf3f7baccd,0x3e4ada4f3f7aed37,0xbe3b6ecf3f7baccd,0xbe4ada4f3f7aed37,0x3e605c133f79c79d,0x3e72b6513f78b47b,0xbe605c133f79c79d,0xbe72b6513f78b47b,0x3e827dc03f778bc5,0x3e8d17c03f76167a,0xbe827dc03f778bc5,0xbe8d17c03f76167a
.quad 0x3e94a0313f74fa0b,0x3ea09ae53f731447,0xbe94a0313f74fa0b,0xbea09ae53f731447,0x3ea68f123f721352,0x3eb3dca53f6faf1b,0xbea68f123f721352,0xbeb3dca53f6faf1b,0x3eb8442a3f6ed89e,0x3ec6d5293f6be858,0xbeb8442a3f6ed89e,0xbec6d5293f6be858,0x3ec9b9533f6b4b0c,0x3ed97cb93f67c187,0xbec9b9533f6b4b0c,0xbed97cb93f67c187
.quad 0x3edae8803f676bd8,0x3eebcbbb3f633c5a,0xbedae8803f676bd8,0xbeebcbbb3f633c5a,0x3eebcbbb3f633c5a,0x3efdbabb3f5e5aa6,0xbeebcbbb3f633c5a,0xbefdbabb3f5e5aa6,0x3efc5d273f5ebe05,0x3f07a1363f591e6a,0xbefc5d273f5ebe05,0xbf07a1363f591e6a,0x3f064b823f59f26a,0x3f102dd53f5389c7,0xbf064b823f59f26a,0xbf102dd53f5389c7
.quad 0x3f800000,0x3f800000,0x800000003f800000,0x800000003f800000,0x3cfb49ba3f7fe129,0x3d0a342f3f7fdaaf,0xbcfb49ba3f7fe129,0xbd0a342f3f7fdaaf,0x3d7b2b743f7f84ab,0x3d8a200a3f7f6ac7,0xbd7b2b743f7f84ab,0xbd8a200a3f7f6ac7,0x3dbc3ac33f7eea9d,0x3dcefdb73f7eb069,0xbdbc3ac33f7eea9d,0xbdcefdb73f7eb069
.quad 0x3dfab2733f7e1324,0x3e09cf863f7dabcc,0xbdfab2733f7e1324,0xbe09cf863f7dabcc,0x3e1c76de3f7cfe73,0x3e2bf8043f7c5d3a,0xbe1c76de3f7cfe73,0xbe2bf8043f7c5d3a,0x3e3b6ecf3f7baccd,0x3e4dee603f7ac516,0xbe3b6ecf3f7baccd,0xbe4dee603f7ac516,0x3e5a39973f7a1e84,0x3e6fa8b23f78e3d6,0xbe5a39973f7a1e84,0xbe6fa8b23f78e3d6
.quad 0x3e78cfcc3f7853f8,0x3e888e933f76ba07,0xbe78cfcc3f7853f8,0xbe888e933f76ba07,0x3e8b95073f764d97,0x3e9920fe3f74484b,0xbe8b95073f764d97,0xbe9920fe3f74484b,0x3e9aa0863f740bdd,0x3ea986c43f718f57,0xbe9aa0863f740bdd,0xbea986c43f718f57,0x3ea986c43f718f57,0x3eb9bb1e3f6e8ff8,0xbea986c43f718f57,0xbeb9bb1e3f6e8ff8
.quad 0x3eb8442a3f6ed89e,0x3ec9b9533f6b4b0c,0xbeb8442a3f6ed89e,0xbec9b9533f6b4b0c,0x3ec6d5293f6be858,0x3ed97cb93f67c187,0xbec6d5293f6be858,0xbed97cb93f67c187,0x3ed536413f68bf3c,0x3ee900b73f63f473,0xbed536413f68bf3c,0xbee900b73f63f473,0x3ee363fa3f655e0b,0x3ef840c83f5fe4e9,0xbee363fa3f655e0b,0xbef840c83f5fe4e9
.quad 0x3f800000,0x3f800000,0x800000003f800000,0x800000003f800000,0x3d2fe0073f7fc38f,0x3d3c6dd53f7fba9e,0xbd2fe0073f7fc38f,0xbd3c6dd53f7fba9e,0x3dafb6803f7f0e58,0x3dbc3ac33f7eea9d,0xbdafb6803f7f0e58,0xbdbc3ac33f7eea9d,0x3e0395023f7de0b1,0x3e0cec4a3f7d906e,0xbe0395023f7de0b1,0xbe0cec4a3f7d906e
.quad 0x3e2f10a23f7c3b28,0x3e3b6ecf3f7baccd,0xbe2f10a23f7c3b28,0xbe3b6ecf3f7baccd,0x3e5a39973f7a1e84,0x3e698bba3f7940c0,0xbe5a39973f7a1e84,0xbe698bba3f7940c0,0x3e827dc03f778bc5,0x3e8b95073f764d97,0xbe827dc03f778bc5,0xbe8b95073f764d97,0x3e97a1173f748422,0x3ea218873f72d4eb,0xbe97a1173f748422,0xbea218873f72d4eb
.quad 0x3eac7cd43f710908,0x3eb8442a3f6ed89e,0xbeac7cd43f710908,0xbeb8442a3f6ed89e,0x3ec1071e3f6d1c1d,0x3ece0bea3f6a5ad9,0xbec1071e3f6d1c1d,0xbece0bea3f6a5ad9,0x3ed536413f68bf3c,0x3ee363fa3f655e0b,0xbed536413f68bf3c,0xbee363fa3f655e0b,0x3ee900b73f63f473,0x3ef840c83f5fe4e9,0xbee900b73f63f473,0xbef840c83f5fe4e9
.quad 0x3efc5d273f5ebe05,0x3f064b823f59f26a,0xbefc5d273f5ebe05,0xbf064b823f59f26a,0x3f07a1363f591e6a,0x3f102dd53f5389c7,0xbf07a1363f591e6a,0xbf102dd53f5389c7,0x3f10d3cd3f531849,0x3f19c2003f4cae79,0xbf10d3cd3f531849,0xbf19c2003f4cae79,0x3f19c2003f4cae79,0x3f2302d33f456439,0xbf19c2003f4cae79,0xbf2302d33f456439
.quad 0x3f800000,0x3f800000,0x800000003f800000,0x800000003f800000,0x3d48fb303f7fb10f,0x3d55880e3f7fa6e3,0xbd48fb303f7fb10f,0xbd55880e3f7fa6e3,0x3dc8bd363f7ec46d,0x3dd53db93f7e9bc9,0xbdc8bd363f7ec46d,0xbdd53db93f7e9bc9,0x3e1640833f7d3aac,0x3e1f917b3f7cdf6c,0xbe1640833f7d3aac,0xbe1f917b3f7cdf6c
.quad 0x3e47c5c23f7b14be,0x3e5415013f7a7302,0xbe47c5c23f7b14be,0xbe5415013f7a7302,0x3e78cfcc3f7853f8,0x3e8402703f77583a,0xbe78cfcc3f7853f8,0xbe8402703f77583a,0x3e94a0313f74fa0b,0x3e9d9e783f73913f,0xbe94a0313f74fa0b,0xbe9d9e783f73913f,0x3eac7cd43f710908,0x3eb6ccc33f6f20b0,0xbeac7cd43f710908,0xbeb6ccc33f6f20b0
.quad 0x3ec3ef153f6c835e,0x3ecf7bca3f6a09a7,0xbec3ef153f6c835e,0xbecf7bca3f6a09a7,0x3edae8803f676bd8,0x3ee79a5d3f644fac,0xbedae8803f676bd8,0xbee79a5d3f644fac,0x3ef15aea3f61c598,0x3eff17b23f5df6be,0xbef15aea3f61c598,0xbeff17b23f5df6be,0x3f039c3d3f5b941a,0x3f0af1b73f570348,0xbf039c3d3f5b941a,0xbf0af1b73f570348
.quad 0x3f0e39da3f54db31,0x3f15f6d93f4f7a1f,0xbf0e39da3f54db31,0xbf15f6d93f4f7a1f,0x3f187fc03f4d9f02,0x3f2093933f476085,0xbf187fc03f4d9f02,0xbf2093933f476085,0x3f2267993f45e403,0x3f2ac0823f3ebc1b,0xbf2267993f45e403,0xbf2ac0823f3ebc1b,0x3f2beb4a3f3daef9,0x3f34768f3f3592e7,0xbf2beb4a3f3daef9,0xbf34768f3f3592e7
.quad 0x3f800000,0x3f800000,0x800000003f800000,0x800000003f800000,0x3d7b2b743f7f84ab,0x3d83db0a3f7f7808,0xbd7b2b743f7f84ab,0xbd83db0a3f7f7808,0x3dfab2733f7e1324,0x3e0395023f7de0b1,0xbdfab2733f7e1324,0xbe0395023f7de0b1,0x3e3b6ecf3f7baccd,0x3e44b0b93f7b3bab,0xbe3b6ecf3f7baccd,0xbe44b0b93f7b3bab
.quad 0x3e78cfcc3f7853f8,0x3e827dc03f778bc5,0xbe78cfcc3f7853f8,0xbe827dc03f778bc5,0x3e9aa0863f740bdd,0x3ea218873f72d4eb,0xbe9aa0863f740bdd,0xbea218873f72d4eb,0x3eb8442a3f6ed89e,0x3ec1071e3f6d1c1d,0xbeb8442a3f6ed89e,0xbec1071e3f6d1c1d,0x3ed536413f68bf3c,0x3edf28a93f666771,0xbed536413f68bf3c,0xbedf28a93f666771
.quad 0x3ef15aea3f61c598,0x3efc5d273f5ebe05,0xbef15aea3f61c598,0xbefc5d273f5ebe05,0x3f064b823f59f26a,0x3f0c42c93f5627fe,0xbf064b823f59f26a,0xbf0c42c93f5627fe,0x3f13682a3f514d3d,0x3f19c2003f4cae79,0xbf13682a3f514d3d,0xbf19c2003f4cae79,0x3f1ff6cb3f47de65,0x3f269de33f425b89,0xbf1ff6cb3f47de65,0xbf269de33f425b89
.quad 0x3f2beb4a3f3daef9,0x3f32c8c93f373a23,0xbf2beb4a3f3daef9,0xbf32c8c93f373a23,0x3f373a233f32c8c9,0x3f3e35c53f2b561b,0xbf373a233f32c8c9,0xbf3e35c53f2b561b,0x3f41d8703f273656,0x3f48d8b33f1ebc12,0xbf41d8703f273656,0xbf48d8b33f1ebc12,0x3f4bbbf83f1b02c6,0x3f52a6493f11796b,0xbf4bbbf83f1b02c6,0xbf52a6493f11796b
.quad 0x3f800000,0x3f800000,0x800000003f800000,0x800000003f800000,0x3d6214693f7f9c18,0x3d6ea0383f7f90b1,0xbd6214693f7f9c18,0xbd6ea0383f7f90b1,0x3de1bc2e3f7e70b0,0x3dee38763f7e4323,0xbde1bc2e3f7e70b0,0xbdee38763f7e4323,0x3e28defc3f7c7eb0,0x3e3228d43f7c187a,0xbe28defc3f7c7eb0,0xbe3228d43f7c187a
.quad 0x3e605c133f79c79d,0x3e6c9a7f3f791298,0xbe605c133f79c79d,0xbe6c9a7f3f791298,0x3e8b95073f764d97,0x3e931f353f75341d,0xbe8b95073f764d97,0xbe931f353f75341d,0x3ea68f123f721352,0x3eaf713a3f708066,0xbea68f123f721352,0xbeaf713a3f708066,0x3ec1071e3f6d1c1d,0x3ecb2aae3f6afb8c,0xbec1071e3f6d1c1d,0xbecb2aae3f6afb8c
.quad 0x3edae8803f676bd8,0x3ee633753f64aa59,0xbedae8803f676bd8,0xbee633753f64aa59,0x3ef41f073f6106f2,0x3f003a063f5d924d,0xbef41f073f6106f2,0xbf003a063f5d924d,0x3f064b823f59f26a,0x3f0cead03f55b993,0xbf064b823f59f26a,0xbf0cead03f55b993,0x3f121eb03f5233c6,0x3f19210f3f4d26fd,0xbf121eb03f5233c6,0xbf19210f3f4d26fd
.quad 0x3f1d7fd13f49d112,0x3f24d2253f43e200,0xbf1d7fd13f49d112,0xbf24d2253f43e200,0x3f2866053f40d0da,0x3f2ff3e63f39f2ac,0xbf2866053f40d0da,0xbf2ff3e63f39f2ac,0x3f32c8c93f373a23,0x3f3a7ca43f2f61a5,0xbf32c8c93f373a23,0xbf3a7ca43f2f61a5,0x3f3ca0033f2d1469,0x3f4463373f24381a,0xbf3ca0033f2d1469,0xbf4463373f24381a
.quad 0x3f800000,0x3f800000,0x800000003f800000,0x800000003f800000,0x3d8a200a3f7f6ac7,0x3d9064b43f7f5ce9,0xbd8a200a3f7f6ac7,0xbd9064b43f7f5ce9,0x3e09cf863f7dabcc,0x3e1008b73f7d7474,0xbe09cf863f7dabcc,0xbe1008b73f7d7474,0x3e4dee603f7ac516,0x3e57278f3f7a4910,0xbe4dee603f7ac516,0xbe57278f3f7a4910
.quad 0x3e888e933f76ba07,0x3e8e9a223f75dec6,0xbe888e933f76ba07,0xbe8e9a223f75dec6,0x3ea986c43f718f57,0x3eb0eacb3f703b37,0xbea986c43f718f57,0xbeb0eacb3f703b37,0x3ec9b9533f6b4b0c,0x3ed25a093f696591,0xbec9b9533f6b4b0c,0xbed25a093f696591,0x3ee900b73f63f473,0x3ef2bd433f61668a,0xbee900b73f63f473,0xbef2bd433f61668a
.quad 0x3f039c3d3f5b941a,0x3f08f59b3f584853,0xbf039c3d3f5b941a,0xbf08f59b3f584853,0x3f121eb03f5233c6,0x3f17de123f4e1689,0xbf121eb03f5233c6,0xbf17de123f4e1689,0x3f1ff6cb3f47de65,0x3f26050a3f42de29,0xbf1ff6cb3f47de65,0xbf26050a3f42de29,0x3f2d14693f3ca003,0x3f33587a3f36ad7f,0xbf2d14693f3ca003,0xbf33587a3f36ad7f
.quad 0x3f3968423f3085bb,0x3f3fc7673f299415,0xbf3968423f3085bb,0xbf3fc7673f299415,0x3f44e3f53f239da9,0x3f4b41fa3f1ba299,0xbf44e3f53f239da9,0xbf4b41fa3f1ba299,0x3f4f7a1f3f15f6d9,0x3f55b9933f0cead0,0xbf4f7a1f3f15f6d9,0xbf55b9933f0cead0,0x3f591e6a3f07a136,0x3f5f20db3efafef7,0xbf591e6a3f07a136,0xbf5f20db3efafef7
.quad 0x3f800000,0x3f800000,0x800000003f800000,0x800000003f800000,0x3d96a9053f7f4e6d,0x3d9cecf93f7f3f54,0xbd96a9053f7f4e6d,0xbd9cecf93f7f3f54,0x3e1640833f7d3aac,0x3e1c76de3f7cfe73,0xbe1640833f7d3aac,0xbe1c76de3f7cfe73,0x3e605c133f79c79d,0x3e698bba3f7940c0,0xbe605c133f79c79d,0xbe698bba3f7940c0
.quad 0x3e94a0313f74fa0b,0x3e9aa0863f740bdd,0xbe94a0313f74fa0b,0xbe9aa0863f740bdd,0x3eb8442a3f6ed89e,0x3ebf926f3f6d67a1,0xbeb8442a3f6ed89e,0xbebf926f3f6d67a1,0x3edae8803f676bd8,0x3ee363fa3f655e0b,0xbedae8803f676bd8,0xbee363fa3f655e0b,0x3efc5d273f5ebe05,0x3f02ef9f3f5bfb34,0xbefc5d273f5ebe05,0xbf02ef9f3f5bfb34
.quad 0x3f0e39da3f54db31,0x3f13682a3f514d3d,0xbf0e39da3f54db31,0xbf13682a3f514d3d,0x3f1d7fd13f49d112,0x3f2302d33f456439,0xbf1d7fd13f49d112,0xbf2302d33f456439,0x3f2beb4a3f3daef9,0x3f31a81d3f385216,0xbf2beb4a3f3daef9,0xbf31a81d3f385216,0x3f3968423f3085bb,0x3f3f41fc3f2a2a80,0xbf3968423f3085bb,0xbf3f41fc3f2a2a80
.quad 0x3f45e4033f226799,0x3f4bbbf83f1b02c6,0xbf45e4033f226799,0xbf4bbbf83f1b02c6,0x3f514d3d3f13682a,0x3f5703483f0af1b7,0xbf514d3d3f13682a,0xbf5703483f0af1b7,0x3f5b941a3f039c3d,0x3f6106f23ef41f07,0xbf5b941a3f039c3d,0xbf6106f23ef41f07,0x3f64aa593ee63375,0x3f69b7e43ed0eb2a,0xbf64aa593ee63375,0xbf69b7e43ed0eb2a
.quad 0x3f800000,0x3f800000,0x800000003f800000,0x800000003f800000,0x3dafb6803f7f0e58,0x3db5f8da3f7efcc9,0xbdafb6803f7f0e58,0xbdb5f8da3f7efcc9,0x3e2f10a23f7c3b28,0x3e3540983f7bf531,0xbe2f10a23f7c3b28,0xbe3540983f7bf531,0x3e827dc03f778bc5,0x3e870ada3f76ef5b,0xbe827dc03f778bc5,0xbe870ada3f76ef5b
.quad 0x3eac7cd43f710908,0x3eb263ef3f6ff573,0xbeac7cd43f710908,0xbeb263ef3f6ff573,0x3ed536413f68bf3c,0x3edc53c13f671599,0xbed536413f68bf3c,0xbedc53c13f671599,0x3efc5d273f5ebe05,0x3f0242b13f5c61c7,0xbefc5d273f5ebe05,0xbf0242b13f5c61c7,0x3f10d3cd3f531849,0x3f1553b73f4fefa8,0xbf10d3cd3f531849,0xbf1553b73f4fefa8
.quad 0x3f2267993f45e403,0x3f2736563f41d870,0xbf2267993f45e403,0xbf2736563f41d870,0x3f32c8c93f373a23,0x3f37c6553f3238aa,0xbf32c8c93f373a23,0xbf37c6553f3238aa,0x3f41d8703f273656,0x3f46e22a3f212ff9,0xbf41d8703f273656,0xbf46e22a3f212ff9,0x3f4f7a1f3f15f6d9,0x3f546b3b3f0ee0db,0xbf4f7a1f3f15f6d9,0xbf546b3b3f0ee0db
.quad 0x3f5b941a3f039c3d,0x3f6046213ef6e0cb,0xbf5b941a3f039c3d,0xbf6046213ef6e0cb,0x3f660f883ee0924f,0x3f6a5ad93ece0bea,0xbf660f883ee0924f,0xbf6a5ad93ece0bea,0x3f6ed89e3eb8442a,0x3f7294f83ea395c5,0xbf6ed89e3eb8442a,0xbf7294f83ea395c5,0x3f75dec63e8e9a22,0x3f78e3d63e6fa8b2,0xbf75dec63e8e9a22,0xbf78e3d63e6fa8b2
.quad 0x3f800000,0x3f800000,0x800000003f800000,0x800000003f800000,0x3da3308c3f7f2f9d,0x3da973ba3f7f1f49,0xbda3308c3f7f2f9d,0xbda973ba3f7f1f49,0x3e22abb63f7cbfc9,0x3e28defc3f7c7eb0,0xbe22abb63f7cbfc9,0xbe28defc3f7c7eb0,0x3e72b6513f78b47b,0x3e7bdba43f7822d1,0xbe72b6513f78b47b,0xbe7bdba43f7822d1
.quad 0x3ea09ae53f731447,0x3ea68f123f721352,0xbea09ae53f731447,0xbea68f123f721352,0x3ec6d5293f6be858,0x3ece0bea3f6a5ad9,0xbec6d5293f6be858,0xbece0bea3f6a5ad9,0x3eebcbbb3f633c5a,0x3ef41f073f6106f2,0xbeebcbbb3f633c5a,0xbef41f073f6106f2,0x3f07a1363f591e6a,0x3f0c42c93f5627fe,0xbf07a1363f591e6a,0xbf0c42c93f5627fe
.quad 0x3f187fc03f4d9f02,0x3f1d7fd13f49d112,0xbf187fc03f4d9f02,0xbf1d7fd13f49d112,0x3f2866053f40d0da,0x3f2da8593f3c17d9,0xbf2866053f40d0da,0xbf2da8593f3c17d9,0x3f373a233f32c8c9,0x3f3ca0033f2d1469,0xbf373a233f32c8c9,0xbf3ca0033f2d1469,0x3f44e3f53f239da9,0x3f4a4c873f1ce11f,0xbf44e3f53f239da9,0xbf4a4c873f1ce11f
.quad 0x3f514d3d3f13682a,0x3f5695e53f0b9a6b,0xbf514d3d3f13682a,0xbf5695e53f0b9a6b,0x3f5c61c73f0242b1,0x3f61668a3ef2bd43,0xbf5c61c73f0242b1,0xbf61668a3ef2bd43,0x3f660f883ee0924f,0x3f6aab7b3ecc9b8b,0xbf660f883ee0924f,0xbf6aab7b3ecc9b8b,0x3f6e46be3ebb31a0,0x3f7254703ea5129f,0xbf6e46be3ebb31a0,0xbf7254703ea5129f
.quad 0x3f800000,0x3f800000,0x800000003f800000,0x800000003f800000,0x3dbc3ac33f7eea9d,0x3dc27c393f7ed7d4,0xbdbc3ac33f7eea9d,0xbdc27c393f7ed7d4,0x3e3b6ecf3f7baccd,0x3e419b373f7b61fc,0xbe3b6ecf3f7baccd,0xbe419b373f7b61fc,0x3e8b95073f764d97,0x3e901c2c3f75a67b,0xbe8b95073f764d97,0xbe901c2c3f75a67b
.quad 0x3eb8442a3f6ed89e,0x3ebe1d4a3f6db293,0xbeb8442a3f6ed89e,0xbebe1d4a3f6db293,0x3ee363fa3f655e0b,0x3eea66813f6398ac,0xbee363fa3f655e0b,0xbeea66813f6398ac,0x3f064b823f59f26a,0x3f0a48ad3f577026,0xbf064b823f59f26a,0xbf0a48ad3f577026,0x3f19c2003f4cae79,0x3f1e1e223f495521,0xbf19c2003f4cae79,0xbf1e1e223f495521
.quad 0x3f2beb4a3f3daef9,0x3f3085bb3f396842,0xbf2beb4a3f3daef9,0xbf3085bb3f396842,0x3f3ca0033f2d1469,0x3f4154e13f27ce61,0xbf3ca0033f2d1469,0xbf4154e13f27ce61,0x3f4bbbf83f1b02c6,0x3f5064af3f14b039,0xbf4bbbf83f1b02c6,0xbf5064af3f14b039,0x3f591e6a3f07a136,0x3f5d924d3f003a06,0xbf591e6a3f07a136,0xbf5d924d3f003a06
.quad 0x3f64aa593ee63375,0x3f68bf3c3ed53641,0xbf64aa593ee63375,0xbf68bf3c3ed53641,0x3f6e46be3ebb31a0,0x3f71d19f3ea80b1f,0xbf6e46be3ebb31a0,0xbf71d19f3ea80b1f,0x3f75dec63e8e9a22,0x3f78b47b3e72b651,0xbf75dec63e8e9a22,0xbf78b47b3e72b651,0x3f7b61fc3e419b37,0x3f7d57de3e1324ca,0xbf7b61fc3e419b37,0xbf7d57de3e1324ca
.quad 0x3f800000,0x3f800000,0x800000003f800000,0x800000003f800000,0x3dc8bd363f7ec46d,0x3dcefdb73f7eb069,0xbdc8bd363f7ec46d,0xbdcefdb73f7eb069,0x3e47c5c23f7b14be,0x3e4dee603f7ac516,0xbe47c5c23f7b14be,0xbe4dee603f7ac516,0x3e94a0313f74fa0b,0x3e9920fe3f74484b,0xbe94a0313f74fa0b,0xbe9920fe3f74484b
.quad 0x3ec3ef153f6c835e,0x3ec9b9533f6b4b0c,0xbec3ef153f6c835e,0xbec9b9533f6b4b0c,0x3ef15aea3f61c598,0x3ef840c83f5fe4e9,0xbef15aea3f61c598,0xbef840c83f5fe4e9,0x3f0e39da3f54db31,0x3f121eb03f5233c6,0xbf0e39da3f54db31,0xbf121eb03f5233c6,0x3f2267993f45e403,0x3f269de33f425b89,0xbf2267993f45e403,0xbf269de33f425b89
.quad 0x3f3504f33f3504f3,0x3f3968423f3085bb,0xbf3504f33f3504f3,0xbf3968423f3085bb,0x3f45e4033f226799,0x3f4a4c873f1ce11f,0xbf45e4033f226799,0xbf4a4c873f1ce11f,0x3f54db313f0e39da,0x3f591e6a3f07a136,0xbf54db313f0e39da,0xbf591e6a3f07a136,0x3f61c5983ef15aea,0x3f65b7103ee1fb6a,0xbf61c5983ef15aea,0xbf65b7103ee1fb6a
.quad 0x3f6c835e3ec3ef15,0x3f6ff5733eb263ef,0xbf6c835e3ec3ef15,0xbf6ff5733eb263ef,0x3f74fa0b3e94a031,0x3f77beb73e80f8c0,0xbf74fa0b3e94a031,0xbf77beb73e80f8c0,0x3f7b14be3e47c5c2,0x3f7cfe733e1c76de,0xbf7b14be3e47c5c2,0xbf7cfe733e1c76de,0x3f7ec46d3dc8bd36,0x3f7fa6e33d55880e,0xbf7ec46d3dc8bd36,0xbf7fa6e33d55880e
.quad 0x3f800000,0x3f800000,0x800000003f800000,0x800000003f800000,0x3de1bc2e3f7e70b0,0x3de7fa9a3f7e5a38,0xbde1bc2e3f7e70b0,0xbde7fa9a3f7e5a38,0x3e605c133f79c79d,0x3e667c663f796e4e,0xbe605c133f79c79d,0xbe667c663f796e4e,0x3ea68f123f721352,0x3eab02013f714c7a,0xbea68f123f721352,0xbeab02013f714c7a
.quad 0x3edae8803f676bd8,0x3ee0924f3f660f88,0xbedae8803f676bd8,0xbee0924f3f660f88,0x3f064b823f59f26a,0x3f099f4e3f57dc7f,0xbf064b823f59f26a,0xbf099f4e3f57dc7f,0x3f1d7fd13f49d112,0x3f212ff93f46e22a,0xbf1d7fd13f49d112,0xbf212ff93f46e22a,0x3f32c8c93f373a23,0x3f36ad7f3f33587a,0xbf32c8c93f373a23,0xbf36ad7f3f33587a
.quad 0x3f45e4033f226799,0x3f49d1123f1d7fd1,0xbf45e4033f226799,0xbf49d1123f1d7fd1,0x3f5695e53f0b9a6b,0x3f5a5ba03f05a02c,0xbf5695e53f0b9a6b,0xbf5a5ba03f05a02c,0x3f64aa593ee63375,0x3f6816a83ed8106b,0xbf64aa593ee63375,0xbf6816a83ed8106b,0x3f6ff5733eb263ef,0x3f72d4eb3ea21887,0xbf6ff5733eb263ef,0xbf72d4eb3ea21887
.quad 0x3f7853f83e78cfcc,0x3f7a73023e541501,0xbf7853f83e78cfcc,0xbf7a73023e541501,0x3f7dabcc3e09cf86,0x3f7ed7d43dc27c39,0xbf7dabcc3e09cf86,0xbf7ed7d43dc27c39,0x3f7fec433cc90ab0,0x3f7ff4e6bc96c9b6,0xbf7fec433cc90ab0,0xbf7ff4e6bc96c9b6,0x3f7f0e58bdafb680,0x3f7dc68cbe06b26e,0xbf7f0e58bdafb680,0xbf7dc68cbe06b26e
.quad 0x3f800000,0x3f800000,0x800000003f800000,0x800000003f800000,0x3dd53db93f7e9bc9,0x3ddb7d373f7e868b,0xbdd53db93f7e9bc9,0xbddb7d373f7e868b,0x3e5415013f7a7302,0x3e5a39973f7a1e84,0xbe5415013f7a7302,0xbe5a39973f7a1e84,0x3e9d9e783f73913f,0x3ea218873f72d4eb,0xbe9d9e783f73913f,0xbea218873f72d4eb
.quad 0x3ecf7bca3f6a09a7,0x3ed536413f68bf3c,0xbecf7bca3f6a09a7,0xbed536413f68bf3c,0x3eff17b23f5df6be,0x3f02ef9f3f5bfb34,0xbeff17b23f5df6be,0xbf02ef9f3f5bfb34,0x3f15f6d93f4f7a1f,0x3f19c2003f4cae79,0xbf15f6d93f4f7a1f,0xbf19c2003f4cae79,0x3f2ac0823f3ebc1b,0x3f2ecef73f3b0629,0xbf2ac0823f3ebc1b,0xbf2ecef73f3b0629
.quad 0x3f3daef93f2beb4a,0x3f41d8703f273656,0xbf3daef93f2beb4a,0xbf41d8703f273656,0x3f4e8d903f173c07,0x3f52a6493f11796b,0xbf4e8d903f173c07,0xbf52a6493f11796b,0x3f5d2d533f00e7e4,0x3f6106f23ef41f07,0xbf5d2d533f00e7e4,0xbf6106f23ef41f07,0x3f6965913ed25a09,0x3f6cd0073ec27b55,0xbf6965913ed25a09,0xbf6cd0073ec27b55
.quad 0x3f7314473ea09ae5,0x3f75dec63e8e9a22,0xbf7314473ea09ae5,0xbf75dec63e8e9a22,0x3f7a1e843e5a3997,0x3f7c187a3e3228d4,0xbf7a1e843e5a3997,0xbf7c187a3e3228d4,0x3f7e70b03de1bc2e,0x3f7f6ac73d8a200a,0xbf7e70b03de1bc2e,0xbf7f6ac73d8a200a,0x3f7ffec43bc90f88,0x3f7fcbe2bd2351cb,0xbf7ffec43bc90f88,0xbf7fcbe2bd2351cb
.quad 0x3f800000,0x3f800000,0x800000003f800000,0x800000003f800000,0x3dee38763f7e4323,0x3df475c03f7e2b72,0xbdee38763f7e4323,0xbdf475c03f7e2b72,0x3e6c9a7f3f791298,0x3e72b6513f78b47b,0xbe6c9a7f3f791298,0xbe72b6513f78b47b,0x3eaf713a3f708066,0x3eb3dca53f6faf1b,0xbeaf713a3f708066,0xbeb3dca53f6faf1b
.quad 0x3ee633753f64aa59,0x3eebcbbb3f633c5a,0xbee633753f64aa59,0xbeebcbbb3f633c5a,0x3f0cead03f55b993,0x3f102dd53f5389c7,0xbf0cead03f55b993,0xbf102dd53f5389c7,0x3f24d2253f43e200,0x3f2866053f40d0da,0xbf24d2253f43e200,0xbf2866053f40d0da,0x3f3a7ca43f2f61a5,0x3f3e35c53f2b561b,0xbf3a7ca43f2f61a5,0xbf3e35c53f2b561b
.quad 0x3f4d9f023f187fc0,0x3f514d3d3f13682a,0xbf4d9f023f187fc0,0xbf514d3d3f13682a,0x3f5df6be3eff17b2,0x3f61668a3ef2bd43,0xbf5df6be3eff17b2,0xbf61668a3ef2bd43,0x3f6b4b0c3ec9b953,0x3f6e46be3ebb31a0,0xbf6b4b0c3ec9b953,0xbf6e46be3ebb31a0,0x3f756d973e919ddd,0x3f77beb73e80f8c0,0xbf756d973e919ddd,0xbf77beb73e80f8c0
.quad 0x3f7c3b283e2f10a2,0x3f7dabcc3e09cf86,0xbf7c3b283e2f10a2,0xbf7dabcc3e09cf86,0x3f7f9c183d621469,0x3f7ff84a3c7b514b,0xbf7f9c183d621469,0xbf7ff84a3c7b514b,0x3f7f84abbd7b2b74,0x3f7e9bc9bdd53db9,0xbf7f84abbd7b2b74,0xbf7e9bc9bdd53db9,0x3f7bf531be354098,0x3f799b43be636c83,0xbf7bf531be354098,0xbf799b43be636c83
.quad 0x3f800000,0x3f800000,0x800000003f800000,0x800000003f800000,0x3dfab2733f7e1324,0x3e0077453f7dfa38,0xbdfab2733f7e1324,0xbe0077453f7dfa38,0x3e78cfcc3f7853f8,0x3e7ee6e13f77f110,0xbe78cfcc3f7853f8,0xbe7ee6e13f77f110,0x3eb8442a3f6ed89e,0x3ebca7af3f6dfcf2,0xbeb8442a3f6ed89e,0xbebca7af3f6dfcf2
.quad 0x3ef15aea3f61c598,0x3ef6e0cb3f604621,0xbef15aea3f61c598,0xbef6e0cb3f604621,0x3f13682a3f514d3d,0x3f16999f3f4f0417,0xbf13682a3f514d3d,0xbf16999f3f4f0417,0x3f2beb4a3f3daef9,0x3f2f61a53f3a7ca4,0xbf2beb4a3f3daef9,0xbf2f61a53f3a7ca4,0x3f41d8703f273656,0x3f4564393f2302d3,0xbf41d8703f273656,0xbf4564393f2302d3
.quad 0x3f54db313f0e39da,0x3f5848533f08f59b,0xbf54db313f0e39da,0xbf5848533f08f59b,0x3f64aa593ee63375,0x3f67c1873ed97cb9,0xbf64aa593ee63375,0xbf67c1873ed97cb9,0x3f7109083eac7cd4,0x3f73913f3e9d9e78,0xbf7109083eac7cd4,0xbf73913f3e9d9e78,0x3f79c79d3e605c13,0x3f7b87b23e3e853e,0xbf79c79d3e605c13,0xbf7b87b23e3e853e
.quad 0x3f7ec46d3dc8bd36,0x3f7f84ab3d7b2b74,0xbf7ec46d3dc8bd36,0xbf7f84ab3d7b2b74,0x3f7fec43bcc90ab0,0x3f7f7808bd83db0a,0xbf7fec43bcc90ab0,0xbf7f7808bd83db0a,0x3f7d3aacbe164083,0x3f7b61fcbe419b37,0xbf7d3aacbe164083,0xbf7b61fcbe419b37,0x3f76ba07be888e93,0x3f73530ebe9f1cdf,0xbf76ba07be888e93,0xbf73530ebe9f1cdf
.quad 0x3f800000,0x3f800000,0x800000003f800000,0x800000003f800000,0x3e09cf863f7dabcc,0x3e0cec4a3f7d906e,0xbe09cf863f7dabcc,0xbe0cec4a3f7d906e,0x3e888e933f76ba07,0x3e8b95073f764d97,0xbe888e933f76ba07,0xbe8b95073f764d97,0x3ec9b9533f6b4b0c,0x3ece0bea3f6a5ad9,0xbec9b9533f6b4b0c,0xbece0bea3f6a5ad9
.quad 0x3f039c3d3f5b941a,0x3f064b823f59f26a,0xbf039c3d3f5b941a,0xbf064b823f59f26a,0x3f1ff6cb3f47de65,0x3f2302d33f456439,0xbf1ff6cb3f47de65,0xbf2302d33f456439,0x3f3968423f3085bb,0x3f3ca0033f2d1469,0xbf3968423f3085bb,0xbf3ca0033f2d1469,0x3f4f7a1f3f15f6d9,0x3f52a6493f11796b,0xbf4f7a1f3f15f6d9,0xbf52a6493f11796b
.quad 0x3f61c5983ef15aea,0x3f64aa593ee63375,0xbf61c5983ef15aea,0xbf64aa593ee63375,0x3f6ff5733eb263ef,0x3f7254703ea5129f,0xbf6ff5733eb263ef,0xbf7254703ea5129f,0x3f79c79d3e605c13,0x3f7b61fc3e419b37,0xbf79c79d3e605c13,0xbf7b61fc3e419b37,0x3f7f0e583dafb680,0x3f7fa6e33d55880e,0xbf7f0e583dafb680,0xbf7fa6e33d55880e
.quad 0x3f7fb10fbd48fb30,0x3f7f0e58bdafb680,0xbf7fb10fbd48fb30,0xbf7f0e58bdafb680,0x3f7baccdbe3b6ecf,0x3f799b43be636c83,0xbf7baccdbe3b6ecf,0xbf799b43be636c83,0x3f731447bea09ae5,0x3f6f6830beb554ec,0xbf731447bea09ae5,0xbf6f6830beb554ec,0x3f660f88bee0924f,0x3f60a6cfbef58035,0xbf660f88bee0924f,0xbf60a6cfbef58035
.quad 0x3f800000,0x3f800000,0x800000003f800000,0x800000003f800000,0x3e0395023f7de0b1,0x3e06b26e3f7dc68c,0xbe0395023f7de0b1,0xbe06b26e3f7dc68c,0x3e827dc03f778bc5,0x3e8586ce3f772417,0xbe827dc03f778bc5,0xbe8586ce3f772417,0x3ec1071e3f6d1c1d,0x3ec5625c3f6c3624,0xbec1071e3f6d1c1d,0xbec5625c3f6c3624
.quad 0x3efc5d273f5ebe05,0x3f00e7e43f5d2d53,0xbefc5d273f5ebe05,0xbf00e7e43f5d2d53,0x3f19c2003f4cae79,0x3f1ce11f3f4a4c87,0xbf19c2003f4cae79,0xbf1ce11f3f4a4c87,0x3f32c8c93f373a23,0x3f36206c3f33e7bc,0xbf32c8c93f373a23,0xbf36206c3f33e7bc,0x3f48d8b33f1ebc12,0x3f4c35783f1a6293,0xbf48d8b33f1ebc12,0xbf4c35783f1a6293
.quad 0x3f5b941a3f039c3d,0x3f5ebe053efc5d27,0xbf5b941a3f039c3d,0xbf5ebe053efc5d27,0x3f6aab7b3ecc9b8b,0x3f6d67a13ebf926f,0xbf6aab7b3ecc9b8b,0xbf6d67a13ebf926f,0x3f75dec63e8e9a22,0x3f77f1103e7ee6e1,0xbf75dec63e8e9a22,0xbf77f1103e7ee6e1,0x3f7cfe733e1c76de,0x3f7e2b723df475c0,0xbf7cfe733e1c76de,0xbf7e2b723df475c0
.quad 0x3f7fec433cc90ab0,0x3f7ffb11bc490e90,0xbf7fec433cc90ab0,0xbf7ffb11bc490e90,0x3f7e9bc9bdd53db9,0x3f7d57debe1324ca,0xbf7e9bc9bdd53db9,0xbf7d57debe1324ca,0x3f791298be6c9a7f,0x3f764d97be8b9507,0xbf791298be6c9a7f,0xbf764d97be8b9507,0x3f6f6830beb554ec,0x3f6afb8cbecb2aae,0xbf6f6830beb554ec,0xbf6afb8cbecb2aae
.quad 0x3f800000,0x3f800000,0x800000003f800000,0x800000003f800000,0x3e1008b73f7d7474,0x3e1324ca3f7d57de,0xbe1008b73f7d7474,0xbe1324ca3f7d57de,0x3e8e9a223f75dec6,0x3e919ddd3f756d97,0xbe8e9a223f75dec6,0xbe919ddd3f756d97,0x3ed25a093f696591,0x3ed6a3993f686b39,0xbed25a093f696591,0xbed6a3993f686b39
.quad 0x3f08f59b3f584853,0x3f0b9a6b3f5695e5,0xbf08f59b3f584853,0xbf0b9a6b3f5695e5,0x3f26050a3f42de29,0x3f28fd413f404c5c,0xbf26050a3f42de29,0xbf28fd413f404c5c,0x3f3fc7673f299415,0x3f42de293f26050a,0xbf3fc7673f299415,0xbf42de293f26050a,0x3f55b9933f0cead0,0x3f58b3a13f084b92,0xbf55b9933f0cead0,0xbf58b3a13f084b92
.quad 0x3f676bd83edae880,0x3f6a09a73ecf7bca,0xbf676bd83edae880,0xbf6a09a73ecf7bca,0x3f7484223e97a117,0x3f76841b3e8a11f7,0xbf7484223e97a117,0xbf76841b3e8a11f7,0x3f7cbfc93e22abb6,0x3f7de0b13e039502,0xbf7cbfc93e22abb6,0xbf7de0b13e039502,0x3f7ff4e63c96c9b6,0x3f7ff84abc7b514b,0xbf7ff4e63c96c9b6,0xbf7ff84abc7b514b
.quad 0x3f7e1324bdfab273,0x3f7cbfc9be22abb6,0xbf7e1324bdfab273,0xbf7cbfc9be22abb6,0x3f772417be8586ce,0x3f74484bbe9920fe,0xbf772417be8586ce,0xbf74484bbe9920fe,0x3f6b4b0cbec9b953,0x3f66beccbeddbe79,0xbf6b4b0cbec9b953,0xbf66beccbeddbe79,0x3f5ac450bf04f484,0x3f546b3bbf0ee0db,0xbf5ac450bf04f484,0xbf546b3bbf0ee0db
.quad 0x3f800000,0x3f800000,0x800000003f800000,0x800000003f800000,0x3e1640833f7d3aac,0x3e195be03f7d1cdd,0xbe1640833f7d3aac,0xbe195be03f7d1cdd,0x3e94a0313f74fa0b,0x3e97a1173f748422,0xbe94a0313f74fa0b,0xbe97a1173f748422,0x3edae8803f676bd8,0x3edf28a93f666771,0xbedae8803f676bd8,0xbedf28a93f666771
.quad 0x3f0e39da3f54db31,0x3f10d3cd3f531849,0xbf0e39da3f54db31,0xbf10d3cd3f531849,0x3f2beb4a3f3daef9,0x3f2ecef73f3b0629,0xbf2beb4a3f3daef9,0xbf2ecef73f3b0629,0x3f45e4033f226799,0x3f48d8b33f1ebc12,0xbf45e4033f226799,0xbf48d8b33f1ebc12,0x3f5b941a3f039c3d,0x3f5e5aa63efdbabb,0xbf5b941a3f039c3d,0xbf5e5aa63efdbabb
.quad 0x3f6c835e3ec3ef15,0x3f6ed89e3eb8442a,0xbf6c835e3ec3ef15,0xbf6ed89e3eb8442a,0x3f7853f83e78cfcc,0x3f79f35e3e5d4b1a,0xbf7853f83e78cfcc,0xbf79f35e3e5d4b1a,0x3f7ec46d3dc8bd36,0x3f7f6ac73d8a200a,0xbf7ec46d3dc8bd36,0xbf7f6ac73d8a200a,0x3f7fb10fbd48fb30,0x3f7f1f49bda973ba,0xbf7fb10fbd48fb30,0xbf7f1f49bda973ba
.quad 0x3f7b14bebe47c5c2,0x3f791298be6c9a7f,0xbf7b14bebe47c5c2,0xbf791298be6c9a7f,0x3f710908beac7cd4,0x3f6d67a1bebf926f,0xbf710908beac7cd4,0xbf6d67a1bebf926f,0x3f61c598bef15aea,0x3f5c61c7bf0242b1,0xbf61c598bef15aea,0xbf5c61c7bf0242b1,0x3f4d9f02bf187fc0,0x3f466354bf21cbfb,0xbf4d9f02bf187fc0,0xbf466354bf21cbfb
.quad 0x3f800000,0x3f800000,0x800000003f800000,0x800000003f800000,0x3e22abb63f7cbfc9,0x3e25c58c3f7c9f8a,0xbe22abb63f7cbfc9,0xbe25c58c3f7c9f8a,0x3ea09ae53f731447,0x3ea395c53f7294f8,0xbea09ae53f731447,0xbea395c53f7294f8,0x3eebcbbb3f633c5a,0x3eeff7fb3f62241a,0xbeebcbbb3f633c5a,0xbeeff7fb3f62241a
.quad 0x3f187fc03f4d9f02,0x3f1b02c63f4bbbf8,0xbf187fc03f4d9f02,0xbf1b02c63f4bbbf8,0x3f373a233f32c8c9,0x3f39f2ac3f2ff3e6,0xbf373a233f32c8c9,0xbf39f2ac3f2ff3e6,0x3f514d3d3f13682a,0x3f53fac33f0f8784,0xbf514d3d3f13682a,0xbf53fac33f0f8784,0x3f660f883ee0924f,0x3f686b393ed6a399,0xbf660f883ee0924f,0xbf686b393ed6a399
.quad 0x3f74fa0b3e94a031,0x3f76ba073e888e93,0xbf74fa0b3e94a031,0xbf76ba073e888e93,0x3f7dabcc3e09cf86,0x3f7e868b3ddb7d37,0xbf7dabcc3e09cf86,0xbf7e868b3ddb7d37,0x3f7fec43bcc90ab0,0x3f7f9c18bd621469,0xbf7fec43bcc90ab0,0xbf7f9c18bd621469,0x3f7baccdbe3b6ecf,0x3f79f35ebe5d4b1a,0xbf7baccdbe3b6ecf,0xbf79f35ebe5d4b1a
.quad 0x3f710908beac7cd4,0x3f6db293bebe1d4a,0xbf710908beac7cd4,0xbf6db293bebe1d4a,0x3f604621bef6e0cb,0x3f5b2c79bf044889,0xbf604621bef6e0cb,0xbf5b2c79bf044889,0x3f49d112bf1d7fd1,0x3f42de29bf26050a,0xbf49d112bf1d7fd1,0xbf42de29bf26050a,0x3f2e3bdebf3b8f3b,0x3f256bcbbf436051,0xbf2e3bdebf3b8f3b,0xbf256bcbbf436051
.quad 0x3f800000,0x3f800000,0x800000003f800000,0x800000003f800000,0x3e1c76de3f7cfe73,0x3e1f917b3f7cdf6c,0xbe1c76de3f7cfe73,0xbe1f917b3f7cdf6c,0x3e9aa0863f740bdd,0x3e9d9e783f73913f,0xbe9aa0863f740bdd,0xbe9d9e783f73913f,0x3ee363fa3f655e0b,0x3ee79a5d3f644fac,0xbee363fa3f655e0b,0xbee79a5d3f644fac
.quad 0x3f13682a3f514d3d,0x3f15f6d93f4f7a1f,0xbf13682a3f514d3d,0xbf15f6d93f4f7a1f,0x3f31a81d3f385216,0x3f34768f3f3592e7,0xbf31a81d3f385216,0xbf34768f3f3592e7,0x3f4bbbf83f1b02c6,0x3f4e8d903f173c07,0xbf4bbbf83f1b02c6,0xbf4e8d903f173c07,0x3f6106f23ef41f07,0x3f6398ac3eea6681,0xbf6106f23ef41f07,0xbf6398ac3eea6681
.quad 0x3f7109083eac7cd4,0x3f7314473ea09ae5,0xbf7109083eac7cd4,0xbf7314473ea09ae5,0x3f7b61fc3e419b37,0x3f7c9f8a3e25c58c,0xbf7b61fc3e419b37,0xbf7c9f8a3e25c58c,0x3f7fd3973d16c32c,0x3f7ffec43bc90f88,0xbf7fd3973d16c32c,0xbf7ffec43bc90f88,0x3f7e4323bdee3876,0x3f7d1cddbe195be0,0xbf7e4323bdee3876,0xbf7d1cddbe195be0
.quad 0x3f76ba07be888e93,0x3f740bddbe9aa086,0xbf76ba07be888e93,0xbf740bddbe9aa086,0x3f696591bed25a09,0x3f650479bee4cbfe,0xbf696591bed25a09,0xbf650479bee4cbfe,0x3f5695e5bf0b9a6b,0x3f5064afbf14b039,0xbf5695e5bf0b9a6b,0xbf5064afbf14b039,0x3f3ebc1bbf2ac082,0x3f36ad7fbf33587a,0xbf3ebc1bbf2ac082,0xbf36ad7fbf33587a
.quad 0x3f800000,0x3f800000,0x800000003f800000,0x800000003f800000,0x3e28defc3f7c7eb0,0x3e2bf8043f7c5d3a,0xbe28defc3f7c7eb0,0xbe2bf8043f7c5d3a,0x3ea68f123f721352,0x3ea986c43f718f57,0xbea68f123f721352,0xbea986c43f718f57,0x3ef41f073f6106f2,0x3ef840c83f5fe4e9,0xbef41f073f6106f2,0xbef840c83f5fe4e9
.quad 0x3f1d7fd13f49d112,0x3f1ff6cb3f47de65,0xbf1d7fd13f49d112,0xbf1ff6cb3f47de65,0x3f3ca0033f2d1469,0x3f3f41fc3f2a2a80,0xbf3ca0033f2d1469,0xbf3f41fc3f2a2a80,0x3f5695e53f0b9a6b,0x3f591e6a3f07a136,0xbf5695e53f0b9a6b,0xbf591e6a3f07a136,0x3f6aab7b3ecc9b8b,0x3f6cd0073ec27b55,0xbf6aab7b3ecc9b8b,0xbf6cd0073ec27b55
.quad 0x3f7853f83e78cfcc,0x3f79c79d3e605c13,0xbf7853f83e78cfcc,0xbf79c79d3e605c13,0x3f7f2f9d3da3308c,0x3f7fa6e33d55880e,0xbf7f2f9d3da3308c,0xbf7fa6e33d55880e,0x3f7f0e58bdafb680,0x3f7e4323bdee3876,0xbf7f0e58bdafb680,0xbf7e4323bdee3876,0x3f77f110be7ee6e1,0x3f75a67bbe901c2c,0xbf77f110be7ee6e1,0xbf75a67bbe901c2c
.quad 0x3f6a09a7becf7bca,0x3f660f88bee0924f,0xbf6a09a7becf7bca,0xbf660f88bee0924f,0x3f55b993bf0cead0,0x3f4fefa8bf1553b7,0xbf55b993bf0cead0,0xbf4fefa8bf1553b7,0x3f3b8f3bbf2e3bde,0x3f33e7bcbf36206c,0xbf3b8f3bbf2e3bde,0xbf33e7bcbf36206c,0x3f1c420cbf4ac77f,0x3f12c39abf51c0c2,0xbf1c420cbf4ac77f,0xbf12c39abf51c0c2
.quad 0x3f800000,0x3f800000,0x800000003f800000,0x800000003f800000,0x3e2f10a23f7c3b28,0x3e3228d43f7c187a,0xbe2f10a23f7c3b28,0xbe3228d43f7c187a,0x3eac7cd43f710908,0x3eaf713a3f708066,0xbeac7cd43f710908,0xbeaf713a3f708066,0x3efc5d273f5ebe05,0x3f003a063f5d924d,0xbefc5d273f5ebe05,0xbf003a063f5d924d
.quad 0x3f2267993f45e403,0x3f24d2253f43e200,0xbf2267993f45e403,0xbf24d2253f43e200,0x3f41d8703f273656,0x3f4463373f24381a,0xbf41d8703f273656,0xbf4463373f24381a,0x3f5b941a3f039c3d,0x3f5df6be3eff17b2,0xbf5b941a3f039c3d,0xbf5df6be3eff17b2,0x3f6ed89e3eb8442a,0x3f70c5013eadf73c,0xbf6ed89e3eb8442a,0xbf70c5013eadf73c
.quad 0x3f7b14be3e47c5c2,0x3f7c3b283e2f10a2,0xbf7b14be3e47c5c2,0xbf7c3b283e2f10a2,0x3f7fec433cc90ab0,0x3f7fffb1bb490fc6,0xbf7fec433cc90ab0,0xbf7fffb1bb490fc6,0x3f7d3aacbe164083,0x3f7bf531be354098,0xbf7d3aacbe164083,0xbf7bf531be354098,0x3f731447bea09ae5,0x3f703b37beb0eacb,0xbf731447bea09ae5,0xbf703b37beb0eacb
.quad 0x3f61c598bef15aea,0x3f5d2d53bf00e7e4,0xbf61c598bef15aea,0xbf5d2d53bf00e7e4,0x3f49d112bf1d7fd1,0x3f436051bf256bcb,0xbf49d112bf1d7fd1,0xbf436051bf256bcb,0x3f2beb4abf3daef9,0x3f239da9bf44e3f5,0xbf2beb4abf3daef9,0xbf239da9bf44e3f5,0x3f08f59bbf584853,0x3efdbabbbf5e5aa6,0xbf08f59bbf584853,0xbefdbabbbf5e5aa6
.quad 0x3f800000,0x3f800000,0x800000003f800000,0x800000003f800000,0x3e3b6ecf3f7baccd,0x3e3e853e3f7b87b2,0xbe3b6ecf3f7baccd,0xbe3e853e3f7b87b2,0x3eb8442a3f6ed89e,0x3ebb31a03f6e46be,0xbeb8442a3f6ed89e,0xbebb31a03f6e46be,0x3f064b823f59f26a,0x3f084b923f58b3a1,0xbf064b823f59f26a,0xbf084b923f58b3a1
.quad 0x3f2beb4a3f3daef9,0x3f2e3bde3f3b8f3b,0xbf2beb4a3f3daef9,0xbf2e3bde3f3b8f3b,0x3f4bbbf83f1b02c6,0x3f4e16893f17de12,0xbf4bbbf83f1b02c6,0xbf4e16893f17de12,0x3f64aa593ee63375,0x3f66becc3eddbe79,0xbf64aa593ee63375,0xbf66becc3eddbe79,0x3f75dec63e8e9a22,0x3f77583a3e840270,0xbf75dec63e8e9a22,0xbf77583a3e840270
.quad 0x3f7ec46d3dc8bd36,0x3f7f4e6d3d96a905,0xbf7ec46d3dc8bd36,0xbf7f4e6d3d96a905,0x3f7f0e58bdafb680,0x3f7e5a38bde7fa9a,0xbf7f0e58bdafb680,0xbf7e5a38bde7fa9a,0x3f76ba07be888e93,0x3f748422be97a117,0xbf76ba07be888e93,0xbf748422be97a117,0x3f660f88bee0924f,0x3f62241abeeff7fb,0xbf660f88bee0924f,0xbf62241abeeff7fb
.quad 0x3f4d9f02bf187fc0,0x3f47de65bf1ff6cb,0xbf4d9f02bf187fc0,0xbf47de65bf1ff6cb,0x3f2e3bdebf3b8f3b,0x3f269de3bf425b89,0xbf2e3bdebf3b8f3b,0xbf269de3bf425b89,0x3f08f59bbf584853,0x3eff17b2bf5df6be,0xbf08f59bbf584853,0xbeff17b2bf5df6be,0x3ebe1d4abf6db293,0x3ea80b1fbf71d19f,0xbebe1d4abf6db293,0xbea80b1fbf71d19f
.quad 0x3f800000,0x3f800000,0x800000003f800000,0x800000003f800000,0x3e3540983f7bf531,0x3e3857ec3f7bd14d,0xbe3540983f7bf531,0xbe3857ec3f7bd14d,0x3eb263ef3f6ff573,0x3eb554ec3f6f6830,0xbeb263ef3f6ff573,0xbeb554ec3f6f6830,0x3f0242b13f5c61c7,0x3f0448893f5b2c79,0xbf0242b13f5c61c7,0xbf0448893f5b2c79
.quad 0x3f2736563f41d870,0x3f2994153f3fc767,0xbf2736563f41d870,0xbf2994153f3fc767,0x3f46e22a3f212ff9,0x3f4955213f1e1e22,0xbf46e22a3f212ff9,0xbf4955213f1e1e22,0x3f6046213ef6e0cb,0x3f6282103eee9479,0xbf6046213ef6e0cb,0xbf6282103eee9479,0x3f7294f83ea395c5,0x3f74484b3e9920fe,0xbf7294f83ea395c5,0xbf74484b3e9920fe
.quad 0x3f7d3aac3e164083,0x3f7e13243dfab273,0xbf7d3aac3e164083,0xbf7e13243dfab273,0x3f7fe129bcfb49ba,0x3f7f90b1bd6ea038,0xbf7fe129bcfb49ba,0xbf7f90b1bd6ea038,0x3f7a7302be541501,0x3f78b47bbe72b651,0xbf7a7302be541501,0xbf78b47bbe72b651,0x3f6d1c1dbec1071e,0x3f69b7e4bed0eb2a,0xbf6d1c1dbec1071e,0xbf69b7e4bed0eb2a
.quad 0x3f584853bf08f59b,0x3f531849bf10d3cd,0xbf584853bf08f59b,0xbf531849bf10d3cd,0x3f3ca003bf2d1469,0x3f3592e7bf34768f,0xbf3ca003bf2d1469,0xbf3592e7bf34768f,0x3f1b02c6bf4bbbf8,0x3f121eb0bf5233c6,0xbf1b02c6bf4bbbf8,0xbf121eb0bf5233c6,0x3ee900b7bf63f473,0x3ed3c867bf6912ae,0xbee900b7bf63f473,0xbed3c867bf6912ae
.quad 0x3f800000,0x3f800000,0x800000003f800000,0x800000003f800000,0x3e419b373f7b61fc,0x3e44b0b93f7b3bab,0xbe419b373f7b61fc,0xbe44b0b93f7b3bab,0x3ebe1d4a3f6db293,0x3ec1071e3f6d1c1d,0xbebe1d4a3f6db293,0xbec1071e3f6d1c1d,0x3f0a48ad3f577026,0x3f0c42c93f5627fe,0xbf0a48ad3f577026,0xbf0c42c93f5627fe
.quad 0x3f3085bb3f396842,0x3f32c8c93f373a23,0xbf3085bb3f396842,0xbf32c8c93f373a23,0x3f5064af3f14b039,0x3f52a6493f11796b,0xbf5064af3f14b039,0xbf52a6493f11796b,0x3f68bf3c3ed53641,0x3f6aab7b3ecc9b8b,0xbf68bf3c3ed53641,0xbf6aab7b3ecc9b8b,0x3f78b47b3e72b651,0x3f79f35e3e5d4b1a,0xbf78b47b3e72b651,0xbf79f35e3e5d4b1a
.quad 0x3f7fb10f3d48fb30,0x3f7fec433cc90ab0,0xbf7fb10f3d48fb30,0xbf7fec433cc90ab0,0x3f7d7474be1008b7,0x3f7c5d3abe2bf804,0xbf7d7474be1008b7,0xbf7c5d3abe2bf804,0x3f721352bea68f12,0x3f6f6830beb554ec,0xbf721352bea68f12,0xbf6f6830beb554ec,0x3f5df6bebeff17b2,0x3f5988adbf06f686,0xbf5df6bebeff17b2,0xbf5988adbf06f686
.quad 0x3f41d870bf273656,0x3f3b8f3bbf2e3bde,0xbf41d870bf273656,0xbf3b8f3bbf2e3bde,0x3f1ebc12bf48d8b3,0x3f16999fbf4f0417,0xbf1ebc12bf48d8b3,0xbf16999fbf4f0417,0x3eebcbbbbf633c5a,0x3ed8106bbf6816a8,0xbeebcbbbbf633c5a,0xbed8106bbf6816a8,0x3e919dddbf756d97,0x3e75c35abf788486,0xbe919dddbf756d97,0xbe75c35abf788486
.quad 0x3f800000,0x3d48fb303f7fb10f,0x800000003f800000,0xbd48fb303f7fb10f,0x3f800000,0x3d55880e3f7fa6e3,0x800000003f800000,0xbd55880e3f7fa6e3,0x3f800000,0x3d6214693f7f9c18,0x800000003f800000,0xbd6214693f7f9c18,0x3f800000,0x3d6ea0383f7f90b1,0x800000003f800000,0xbd6ea0383f7f90b1
.quad 0x3f800000,0x3d7b2b743f7f84ab,0x800000003f800000,0xbd7b2b743f7f84ab,0x3f800000,0x3d83db0a3f7f7808,0x800000003f800000,0xbd83db0a3f7f7808,0x3f800000,0x3d8a200a3f7f6ac7,0x800000003f800000,0xbd8a200a3f7f6ac7,0x3f800000,0x3d9064b43f7f5ce9,0x800000003f800000,0xbd9064b43f7f5ce9
.quad 0x3f800000,0x3d96a9053f7f4e6d,0x800000003f800000,0xbd96a9053f7f4e6d,0x3f800000,0x3d9cecf93f7f3f54,0x800000003f800000,0xbd9cecf93f7f3f54,0x3f800000,0x3da3308c3f7f2f9d,0x800000003f800000,0xbda3308c3f7f2f9d,0x3f800000,0x3da973ba3f7f1f49,0x800000003f800000,0xbda973ba3f7f1f49
.quad 0x3f800000,0x3dafb6803f7f0e58,0x800000003f800000,0xbdafb6803f7f0e58,0x3f800000,0x3db5f8da3f7efcc9,0x800000003f800000,0xbdb5f8da3f7efcc9,0x3f800000,0x3dbc3ac33f7eea9d,0x800000003f800000,0xbdbc3ac33f7eea9d,0x3f800000,0x3dc27c393f7ed7d4,0x800000003f800000,0xbdc27c393f7ed7d4
.quad 0x3e47c5c23f7b14be,0x3e78cfcc3f7853f8,0xbe47c5c23f7b14be,0xbe78cfcc3f7853f8,0x3e5415013f7a7302,0x3e8402703f77583a,0xbe5415013f7a7302,0xbe8402703f77583a,0x3e605c133f79c79d,0x3e8b95073f764d97,0xbe605c133f79c79d,0xbe8b95073f764d97,0x3e6c9a7f3f791298,0x3e931f353f75341d,0xbe6c9a7f3f791298,0xbe931f353f75341d
.quad 0x3e78cfcc3f7853f8,0x3e9aa0863f740bdd,0xbe78cfcc3f7853f8,0xbe9aa0863f740bdd,0x3e827dc03f778bc5,0x3ea218873f72d4eb,0xbe827dc03f778bc5,0xbea218873f72d4eb,0x3e888e933f76ba07,0x3ea986c43f718f57,0xbe888e933f76ba07,0xbea986c43f718f57,0x3e8e9a223f75dec6,0x3eb0eacb3f703b37,0xbe8e9a223f75dec6,0xbeb0eacb3f703b37
.quad 0x3e94a0313f74fa0b,0x3eb8442a3f6ed89e,0xbe94a0313f74fa0b,0xbeb8442a3f6ed89e,0x3e9aa0863f740bdd,0x3ebf926f3f6d67a1,0xbe9aa0863f740bdd,0xbebf926f3f6d67a1,0x3ea09ae53f731447,0x3ec6d5293f6be858,0xbea09ae53f731447,0xbec6d5293f6be858,0x3ea68f123f721352,0x3ece0bea3f6a5ad9,0xbea68f123f721352,0xbece0bea3f6a5ad9
.quad 0x3eac7cd43f710908,0x3ed536413f68bf3c,0xbeac7cd43f710908,0xbed536413f68bf3c,0x3eb263ef3f6ff573,0x3edc53c13f671599,0xbeb263ef3f6ff573,0xbedc53c13f671599,0x3eb8442a3f6ed89e,0x3ee363fa3f655e0b,0xbeb8442a3f6ed89e,0xbee363fa3f655e0b,0x3ebe1d4a3f6db293,0x3eea66813f6398ac,0xbebe1d4a3f6db293,0xbeea66813f6398ac
.quad 0x3dc8bd363f7ec46d,0x3e1640833f7d3aac,0xbdc8bd363f7ec46d,0xbe1640833f7d3aac,0x3dd53db93f7e9bc9,0x3e1f917b3f7cdf6c,0xbdd53db93f7e9bc9,0xbe1f917b3f7cdf6c,0x3de1bc2e3f7e70b0,0x3e28defc3f7c7eb0,0xbde1bc2e3f7e70b0,0xbe28defc3f7c7eb0,0x3dee38763f7e4323,0x3e3228d43f7c187a,0xbdee38763f7e4323,0xbe3228d43f7c187a
.quad 0x3dfab2733f7e1324,0x3e3b6ecf3f7baccd,0xbdfab2733f7e1324,0xbe3b6ecf3f7baccd,0x3e0395023f7de0b1,0x3e44b0b93f7b3bab,0xbe0395023f7de0b1,0xbe44b0b93f7b3bab,0x3e09cf863f7dabcc,0x3e4dee603f7ac516,0xbe09cf863f7dabcc,0xbe4dee603f7ac516,0x3e1008b73f7d7474,0x3e57278f3f7a4910,0xbe1008b73f7d7474,0xbe57278f3f7a4910
.quad 0x3e1640833f7d3aac,0x3e605c133f79c79d,0xbe1640833f7d3aac,0xbe605c133f79c79d,0x3e1c76de3f7cfe73,0x3e698bba3f7940c0,0xbe1c76de3f7cfe73,0xbe698bba3f7940c0,0x3e22abb63f7cbfc9,0x3e72b6513f78b47b,0xbe22abb63f7cbfc9,0xbe72b6513f78b47b,0x3e28defc3f7c7eb0,0x3e7bdba43f7822d1,0xbe28defc3f7c7eb0,0xbe7bdba43f7822d1
.quad 0x3e2f10a23f7c3b28,0x3e827dc03f778bc5,0xbe2f10a23f7c3b28,0xbe827dc03f778bc5,0x3e3540983f7bf531,0x3e870ada3f76ef5b,0xbe3540983f7bf531,0xbe870ada3f76ef5b,0x3e3b6ecf3f7baccd,0x3e8b95073f764d97,0xbe3b6ecf3f7baccd,0xbe8b95073f764d97,0x3e419b373f7b61fc,0x3e901c2c3f75a67b,0xbe419b373f7b61fc,0xbe901c2c3f75a67b
.quad 0x3e94a0313f74fa0b,0x3eac7cd43f710908,0xbe94a0313f74fa0b,0xbeac7cd43f710908,0x3e9d9e783f73913f,0x3eb6ccc33f6f20b0,0xbe9d9e783f73913f,0xbeb6ccc33f6f20b0,0x3ea68f123f721352,0x3ec1071e3f6d1c1d,0xbea68f123f721352,0xbec1071e3f6d1c1d,0x3eaf713a3f708066,0x3ecb2aae3f6afb8c,0xbeaf713a3f708066,0xbecb2aae3f6afb8c
.quad 0x3eb8442a3f6ed89e,0x3ed536413f68bf3c,0xbeb8442a3f6ed89e,0xbed536413f68bf3c,0x3ec1071e3f6d1c1d,0x3edf28a93f666771,0xbec1071e3f6d1c1d,0xbedf28a93f666771,0x3ec9b9533f6b4b0c,0x3ee900b73f63f473,0xbec9b9533f6b4b0c,0xbee900b73f63f473,0x3ed25a093f696591,0x3ef2bd433f61668a,0xbed25a093f696591,0xbef2bd433f61668a
.quad 0x3edae8803f676bd8,0x3efc5d273f5ebe05,0xbedae8803f676bd8,0xbefc5d273f5ebe05,0x3ee363fa3f655e0b,0x3f02ef9f3f5bfb34,0xbee363fa3f655e0b,0xbf02ef9f3f5bfb34,0x3eebcbbb3f633c5a,0x3f07a1363f591e6a,0xbeebcbbb3f633c5a,0xbf07a1363f591e6a,0x3ef41f073f6106f2,0x3f0c42c93f5627fe,0xbef41f073f6106f2,0xbf0c42c93f5627fe
.quad 0x3efc5d273f5ebe05,0x3f10d3cd3f531849,0xbefc5d273f5ebe05,0xbf10d3cd3f531849,0x3f0242b13f5c61c7,0x3f1553b73f4fefa8,0xbf0242b13f5c61c7,0xbf1553b73f4fefa8,0x3f064b823f59f26a,0x3f19c2003f4cae79,0xbf064b823f59f26a,0xbf19c2003f4cae79,0x3f0a48ad3f577026,0x3f1e1e223f495521,0xbf0a48ad3f577026,0xbf1e1e223f495521
.quad 0x3ec3ef153f6c835e,0x3edae8803f676bd8,0xbec3ef153f6c835e,0xbedae8803f676bd8,0x3ecf7bca3f6a09a7,0x3ee79a5d3f644fac,0xbecf7bca3f6a09a7,0xbee79a5d3f644fac,0x3edae8803f676bd8,0x3ef41f073f6106f2,0xbedae8803f676bd8,0xbef41f073f6106f2,0x3ee633753f64aa59,0x3f003a063f5d924d,0xbee633753f64aa59,0xbf003a063f5d924d
.quad 0x3ef15aea3f61c598,0x3f064b823f59f26a,0xbef15aea3f61c598,0xbf064b823f59f26a,0x3efc5d273f5ebe05,0x3f0c42c93f5627fe,0xbefc5d273f5ebe05,0xbf0c42c93f5627fe,0x3f039c3d3f5b941a,0x3f121eb03f5233c6,0xbf039c3d3f5b941a,0xbf121eb03f5233c6,0x3f08f59b3f584853,0x3f17de123f4e1689,0xbf08f59b3f584853,0xbf17de123f4e1689
.quad 0x3f0e39da3f54db31,0x3f1d7fd13f49d112,0xbf0e39da3f54db31,0xbf1d7fd13f49d112,0x3f13682a3f514d3d,0x3f2302d33f456439,0xbf13682a3f514d3d,0xbf2302d33f456439,0x3f187fc03f4d9f02,0x3f2866053f40d0da,0xbf187fc03f4d9f02,0xbf2866053f40d0da,0x3f1d7fd13f49d112,0x3f2da8593f3c17d9,0xbf1d7fd13f49d112,0xbf2da8593f3c17d9
.quad 0x3f2267993f45e403,0x3f32c8c93f373a23,0xbf2267993f45e403,0xbf32c8c93f373a23,0x3f2736563f41d870,0x3f37c6553f3238aa,0xbf2736563f41d870,0xbf37c6553f3238aa,0x3f2beb4a3f3daef9,0x3f3ca0033f2d1469,0xbf2beb4a3f3daef9,0xbf3ca0033f2d1469,0x3f3085bb3f396842,0x3f4154e13f27ce61,0xbf3085bb3f396842,0xbf4154e13f27ce61
.quad 0x3f0e39da3f54db31,0x3f187fc03f4d9f02,0xbf0e39da3f54db31,0xbf187fc03f4d9f02,0x3f15f6d93f4f7a1f,0x3f2093933f476085,0xbf15f6d93f4f7a1f,0xbf2093933f476085,0x3f1d7fd13f49d112,0x3f2866053f40d0da,0xbf1d7fd13f49d112,0xbf2866053f40d0da,0x3f24d2253f43e200,0x3f2ff3e63f39f2ac,0xbf24d2253f43e200,0xbf2ff3e63f39f2ac
.quad 0x3f2beb4a3f3daef9,0x3f373a233f32c8c9,0xbf2beb4a3f3daef9,0xbf373a233f32c8c9,0x3f32c8c93f373a23,0x3f3e35c53f2b561b,0xbf32c8c93f373a23,0xbf3e35c53f2b561b,0x3f3968423f3085bb,0x3f44e3f53f239da9,0xbf3968423f3085bb,0xbf44e3f53f239da9,0x3f3fc7673f299415,0x3f4b41fa3f1ba299,0xbf3fc7673f299415,0xbf4b41fa3f1ba299
.quad 0x3f45e4033f226799,0x3f514d3d3f13682a,0xbf45e4033f226799,0xbf514d3d3f13682a,0x3f4bbbf83f1b02c6,0x3f5703483f0af1b7,0xbf4bbbf83f1b02c6,0xbf5703483f0af1b7,0x3f514d3d3f13682a,0x3f5c61c73f0242b1,0xbf514d3d3f13682a,0xbf5c61c73f0242b1,0x3f5695e53f0b9a6b,0x3f61668a3ef2bd43,0xbf5695e53f0b9a6b,0xbf61668a3ef2bd43
.quad 0x3f5b941a3f039c3d,0x3f660f883ee0924f,0xbf5b941a3f039c3d,0xbf660f883ee0924f,0x3f6046213ef6e0cb,0x3f6a5ad93ece0bea,0xbf6046213ef6e0cb,0xbf6a5ad93ece0bea,0x3f64aa593ee63375,0x3f6e46be3ebb31a0,0xbf64aa593ee63375,0xbf6e46be3ebb31a0,0x3f68bf3c3ed53641,0x3f71d19f3ea80b1f,0xbf68bf3c3ed53641,0xbf71d19f3ea80b1f
.quad 0x3ef15aea3f61c598,0x3f039c3d3f5b941a,0xbef15aea3f61c598,0xbf039c3d3f5b941a,0x3eff17b23f5df6be,0x3f0af1b73f570348,0xbeff17b23f5df6be,0xbf0af1b73f570348,0x3f064b823f59f26a,0x3f121eb03f5233c6,0xbf064b823f59f26a,0xbf121eb03f5233c6,0x3f0cead03f55b993,0x3f19210f3f4d26fd,0xbf0cead03f55b993,0xbf19210f3f4d26fd
.quad 0x3f13682a3f514d3d,0x3f1ff6cb3f47de65,0xbf13682a3f514d3d,0xbf1ff6cb3f47de65,0x3f19c2003f4cae79,0x3f269de33f425b89,0xbf19c2003f4cae79,0xbf269de33f425b89,0x3f1ff6cb3f47de65,0x3f2d14693f3ca003,0xbf1ff6cb3f47de65,0xbf2d14693f3ca003,0x3f26050a3f42de29,0x3f33587a3f36ad7f,0xbf26050a3f42de29,0xbf33587a3f36ad7f
.quad 0x3f2beb4a3f3daef9,0x3f3968423f3085bb,0xbf2beb4a3f3daef9,0xbf3968423f3085bb,0x3f31a81d3f385216,0x3f3f41fc3f2a2a80,0xbf31a81d3f385216,0xbf3f41fc3f2a2a80,0x3f373a233f32c8c9,0x3f44e3f53f239da9,0xbf373a233f32c8c9,0xbf44e3f53f239da9,0x3f3ca0033f2d1469,0x3f4a4c873f1ce11f,0xbf3ca0033f2d1469,0xbf4a4c873f1ce11f
.quad 0x3f41d8703f273656,0x3f4f7a1f3f15f6d9,0xbf41d8703f273656,0xbf4f7a1f3f15f6d9,0x3f46e22a3f212ff9,0x3f546b3b3f0ee0db,0xbf46e22a3f212ff9,0xbf546b3b3f0ee0db,0x3f4bbbf83f1b02c6,0x3f591e6a3f07a136,0xbf4bbbf83f1b02c6,0xbf591e6a3f07a136,0x3f5064af3f14b039,0x3f5d924d3f003a06,0xbf5064af3f14b039,0xbf5d924d3f003a06
.quad 0x3f2267993f45e403,0x3f2beb4a3f3daef9,0xbf2267993f45e403,0xbf2beb4a3f3daef9,0x3f2ac0823f3ebc1b,0x3f34768f3f3592e7,0xbf2ac0823f3ebc1b,0xbf34768f3f3592e7,0x3f32c8c93f373a23,0x3f3ca0033f2d1469,0xbf32c8c93f373a23,0xbf3ca0033f2d1469,0x3f3a7ca43f2f61a5,0x3f4463373f24381a,0xbf3a7ca43f2f61a5,0xbf4463373f24381a
.quad 0x3f41d8703f273656,0x3f4bbbf83f1b02c6,0xbf41d8703f273656,0xbf4bbbf83f1b02c6,0x3f48d8b33f1ebc12,0x3f52a6493f11796b,0xbf48d8b33f1ebc12,0xbf52a6493f11796b,0x3f4f7a1f3f15f6d9,0x3f591e6a3f07a136,0xbf4f7a1f3f15f6d9,0xbf591e6a3f07a136,0x3f55b9933f0cead0,0x3f5f20db3efafef7,0xbf55b9933f0cead0,0xbf5f20db3efafef7
.quad 0x3f5b941a3f039c3d,0x3f64aa593ee63375,0xbf5b941a3f039c3d,0xbf64aa593ee63375,0x3f6106f23ef41f07,0x3f69b7e43ed0eb2a,0xbf6106f23ef41f07,0xbf69b7e43ed0eb2a,0x3f660f883ee0924f,0x3f6e46be3ebb31a0,0xbf660f883ee0924f,0xbf6e46be3ebb31a0,0x3f6aab7b3ecc9b8b,0x3f7254703ea5129f,0xbf6aab7b3ecc9b8b,0xbf7254703ea5129f
.quad 0x3f6ed89e3eb8442a,0x3f75dec63e8e9a22,0xbf6ed89e3eb8442a,0xbf75dec63e8e9a22,0x3f7294f83ea395c5,0x3f78e3d63e6fa8b2,0xbf7294f83ea395c5,0xbf78e3d63e6fa8b2,0x3f75dec63e8e9a22,0x3f7b61fc3e419b37,0xbf75dec63e8e9a22,0xbf7b61fc3e419b37,0x3f78b47b3e72b651,0x3f7d57de3e1324ca,0xbf78b47b3e72b651,0xbf7d57de3e1324ca
.quad 0x3f3504f33f3504f3,0x3f3daef93f2beb4a,0xbf3504f33f3504f3,0xbf3daef93f2beb4a,0x3f3daef93f2beb4a,0x3f4663543f21cbfb,0xbf3daef93f2beb4a,0xbf4663543f21cbfb,0x3f45e4033f226799,0x3f4e8d903f173c07,0xbf45e4033f226799,0xbf4e8d903f173c07,0x3f4d9f023f187fc0,0x3f5627fe3f0c42c9,0xbf4d9f023f187fc0,0xbf5627fe3f0c42c9
.quad 0x3f54db313f0e39da,0x3f5d2d533f00e7e4,0xbf54db313f0e39da,0xbf5d2d533f00e7e4,0x3f5b941a3f039c3d,0x3f6398ac3eea6681,0xbf5b941a3f039c3d,0xbf6398ac3eea6681,0x3f61c5983ef15aea,0x3f6965913ed25a09,0xbf61c5983ef15aea,0xbf6965913ed25a09,0x3f676bd83edae880,0x3f6e8ff83eb9bb1e,0xbf676bd83edae880,0xbf6e8ff83eb9bb1e
.quad 0x3f6c835e3ec3ef15,0x3f7314473ea09ae5,0xbf6c835e3ec3ef15,0xbf7314473ea09ae5,0x3f7109083eac7cd4,0x3f76ef5b3e870ada,0xbf7109083eac7cd4,0xbf76ef5b3e870ada,0x3f74fa0b3e94a031,0x3f7a1e843e5a3997,0xbf74fa0b3e94a031,0xbf7a1e843e5a3997,0x3f7853f83e78cfcc,0x3f7c9f8a3e25c58c,0xbf7853f83e78cfcc,0xbf7c9f8a3e25c58c
.quad 0x3f7b14be3e47c5c2,0x3f7e70b03de1bc2e,0xbf7b14be3e47c5c2,0xbf7e70b03de1bc2e,0x3f7d3aac3e164083,0x3f7f90b13d6ea038,0xbf7d3aac3e164083,0xbf7f90b13d6ea038,0x3f7ec46d3dc8bd36,0x3f7ffec43bc90f88,0xbf7ec46d3dc8bd36,0xbf7ffec43bc90f88,0x3f7fb10f3d48fb30,0x3f7fba9ebd3c6dd5,0xbf7fb10f3d48fb30,0xbf7fba9ebd3c6dd5
.quad 0x3f54db313f0e39da,0x3f5b941a3f039c3d,0xbf54db313f0e39da,0xbf5b941a3f039c3d,0x3f5d2d533f00e7e4,0x3f6398ac3eea6681,0xbf5d2d533f00e7e4,0xbf6398ac3eea6681,0x3f64aa593ee63375,0x3f6aab7b3ecc9b8b,0xbf64aa593ee63375,0xbf6aab7b3ecc9b8b,0x3f6b4b0c3ec9b953,0x3f70c5013eadf73c,0xbf6b4b0c3ec9b953,0xbf70c5013eadf73c
.quad 0x3f7109083eac7cd4,0x3f75dec63e8e9a22,0xbf7109083eac7cd4,0xbf75dec63e8e9a22,0x3f75dec63e8e9a22,0x3f79f35e3e5d4b1a,0xbf75dec63e8e9a22,0xbf79f35e3e5d4b1a,0x3f79c79d3e605c13,0x3f7cfe733e1c76de,0xbf79c79d3e605c13,0xbf7cfe733e1c76de,0x3f7cbfc93e22abb6,0x3f7efcc93db5f8da,0xbf7cbfc93e22abb6,0xbf7efcc93db5f8da
.quad 0x3f7ec46d3dc8bd36,0x3f7fec433cc90ab0,0xbf7ec46d3dc8bd36,0xbf7fec433cc90ab0,0x3f7fd3973d16c32c,0x3f7fcbe2bd2351cb,0xbf7fd3973d16c32c,0xbf7fcbe2bd2351cb,0x3f7fec43bcc90ab0,0x3f7e9bc9bdd53db9,0xbf7fec43bcc90ab0,0xbf7e9bc9bdd53db9,0x3f7f0e58bdafb680,0x3f7c5d3abe2bf804,0xbf7f0e58bdafb680,0xbf7c5d3abe2bf804
.quad 0x3f7d3aacbe164083,0x3f791298be6c9a7f,0xbf7d3aacbe164083,0xbf791298be6c9a7f,0x3f7a7302be541501,0x3f74bf62be9620d2,0xbf7a7302be541501,0xbf74bf62be9620d2,0x3f76ba07be888e93,0x3f6f6830beb554ec,0xbf76ba07be888e93,0xbf6f6830beb554ec,0x3f721352bea68f12,0x3f6912aebed3c867,0xbf721352bea68f12,0xbf6912aebed3c867
.quad 0x3f45e4033f226799,0x3f4d9f023f187fc0,0xbf45e4033f226799,0xbf4d9f023f187fc0,0x3f4e8d903f173c07,0x3f5627fe3f0c42c9,0xbf4e8d903f173c07,0xbf5627fe3f0c42c9,0x3f5695e53f0b9a6b,0x3f5df6be3eff17b2,0xbf5695e53f0b9a6b,0xbf5df6be3eff17b2,0x3f5df6be3eff17b2,0x3f6504793ee4cbfe,0xbf5df6be3eff17b2,0xbf6504793ee4cbfe
.quad 0x3f64aa593ee63375,0x3f6b4b0c3ec9b953,0xbf64aa593ee63375,0xbf6b4b0c3ec9b953,0x3f6aab7b3ecc9b8b,0x3f70c5013eadf73c,0xbf6aab7b3ecc9b8b,0xbf70c5013eadf73c,0x3f6ff5733eb263ef,0x3f756d973e919ddd,0xbf6ff5733eb263ef,0xbf756d973e919ddd,0x3f7484223e97a117,0x3f7940c03e698bba,0xbf7484223e97a117,0xbf7940c03e698bba
.quad 0x3f7853f83e78cfcc,0x3f7c3b283e2f10a2,0xbf7853f83e78cfcc,0xbf7c3b283e2f10a2,0x3f7b61fc3e419b37,0x3f7e5a383de7fa9a,0xbf7b61fc3e419b37,0xbf7e5a383de7fa9a,0x3f7dabcc3e09cf86,0x3f7f9c183d621469,0xbf7dabcc3e09cf86,0xbf7f9c183d621469,0x3f7f2f9d3da3308c,0x3f7fffb1bb490fc6,0xbf7f2f9d3da3308c,0xbf7fffb1bb490fc6
.quad 0x3f7fec433cc90ab0,0x3f7f84abbd7b2b74,0xbf7fec433cc90ab0,0xbf7f84abbd7b2b74,0x3f7fe129bcfb49ba,0x3f7e2b72bdf475c0,0xbf7fe129bcfb49ba,0xbf7e2b72bdf475c0,0x3f7f0e58bdafb680,0x3f7bf531be354098,0xbf7f0e58bdafb680,0xbf7bf531be354098,0x3f7d7474be1008b7,0x3f78e3d6be6fa8b2,0xbf7d7474be1008b7,0xbf78e3d6be6fa8b2
.quad 0x3f61c5983ef15aea,0x3f676bd83edae880,0xbf61c5983ef15aea,0xbf676bd83edae880,0x3f6965913ed25a09,0x3f6e8ff83eb9bb1e,0xbf6965913ed25a09,0xbf6e8ff83eb9bb1e,0x3f6ff5733eb263ef,0x3f7484223e97a117,0xbf6ff5733eb263ef,0xbf7484223e97a117,0x3f756d973e919ddd,0x3f7940c03e698bba,0xbf756d973e919ddd,0xbf7940c03e698bba
.quad 0x3f79c79d3e605c13,0x3f7cbfc93e22abb6,0xbf79c79d3e605c13,0xbf7cbfc93e22abb6,0x3f7cfe733e1c76de,0x3f7efcc93db5f8da,0xbf7cfe733e1c76de,0xbf7efcc93db5f8da,0x3f7f0e583dafb680,0x3f7ff4e63c96c9b6,0xbf7f0e583dafb680,0xbf7ff4e63c96c9b6,0x3f7ff4e63c96c9b6,0x3f7fa6e3bd55880e,0xbf7ff4e63c96c9b6,0xbf7fa6e3bd55880e
.quad 0x3f7fb10fbd48fb30,0x3f7e1324bdfab273,0xbf7fb10fbd48fb30,0xbf7e1324bdfab273,0x3f7e4323bdee3876,0x3f7b3babbe44b0b9,0xbf7e4323bdee3876,0xbf7b3babbe44b0b9,0x3f7baccdbe3b6ecf,0x3f772417be8586ce,0xbf7baccdbe3b6ecf,0xbf772417be8586ce,0x3f77f110be7ee6e1,0x3f71d19fbea80b1f,0xbf77f110be7ee6e1,0xbf71d19fbea80b1f
.quad 0x3f731447bea09ae5,0x3f6b4b0cbec9b953,0xbf731447bea09ae5,0xbf6b4b0cbec9b953,0x3f6d1c1dbec1071e,0x3f6398acbeea6681,0xbf6d1c1dbec1071e,0xbf6398acbeea6681,0x3f660f88bee0924f,0x3f5ac450bf04f484,0xbf660f88bee0924f,0xbf5ac450bf04f484,0x3f5df6bebeff17b2,0x3f50d937bf140c5f,0xbf5df6bebeff17b2,0xbf50d937bf140c5f
.quad 0x3f6c835e3ec3ef15,0x3f7109083eac7cd4,0xbf6c835e3ec3ef15,0xbf7109083eac7cd4,0x3f7314473ea09ae5,0x3f76ef5b3e870ada,0xbf7314473ea09ae5,0xbf76ef5b3e870ada,0x3f7853f83e78cfcc,0x3f7b61fc3e419b37,0xbf7853f83e78cfcc,0xbf7b61fc3e419b37,0x3f7c3b283e2f10a2,0x3f7e5a383de7fa9a,0xbf7c3b283e2f10a2,0xbf7e5a383de7fa9a
.quad 0x3f7ec46d3dc8bd36,0x3f7fd3973d16c32c,0xbf7ec46d3dc8bd36,0xbf7fd3973d16c32c,0x3f7fec433cc90ab0,0x3f7fcbe2bd2351cb,0xbf7fec433cc90ab0,0xbf7fcbe2bd2351cb,0x3f7fb10fbd48fb30,0x3f7e4323bdee3876,0xbf7fb10fbd48fb30,0xbf7e4323bdee3876,0x3f7e1324bdfab273,0x3f7b3babbe44b0b9,0xbf7e1324bdfab273,0xbf7b3babbe44b0b9
.quad 0x3f7b14bebe47c5c2,0x3f76ba07be888e93,0xbf7b14bebe47c5c2,0xbf76ba07be888e93,0x3f76ba07be888e93,0x3f70c501beadf73c,0xbf76ba07be888e93,0xbf70c501beadf73c,0x3f710908beac7cd4,0x3f696591bed25a09,0xbf710908beac7cd4,0xbf696591bed25a09,0x3f6a09a7becf7bca,0x3f60a6cfbef58035,0xbf6a09a7becf7bca,0xbf60a6cfbef58035
.quad 0x3f61c598bef15aea,0x3f5695e5bf0b9a6b,0xbf61c598bef15aea,0xbf5695e5bf0b9a6b,0x3f584853bf08f59b,0x3f4b41fabf1ba299,0xbf584853bf08f59b,0xbf4b41fabf1ba299,0x3f4d9f02bf187fc0,0x3f3ebc1bbf2ac082,0xbf4d9f02bf187fc0,0xbf3ebc1bbf2ac082,0x3f41d870bf273656,0x3f311722bf38dd65,0xbf41d870bf273656,0xbf311722bf38dd65
.quad 0x3f7b14be3e47c5c2,0x3f7d3aac3e164083,0xbf7b14be3e47c5c2,0xbf7d3aac3e164083,0x3f7e70b03de1bc2e,0x3f7f90b13d6ea038,0xbf7e70b03de1bc2e,0xbf7f90b13d6ea038,0x3f7fec433cc90ab0,0x3f7fe129bcfb49ba,0xbf7fec433cc90ab0,0xbf7fe129bcfb49ba,0x3f7f84abbd7b2b74,0x3f7e2b72bdf475c0,0xbf7f84abbd7b2b74,0xbf7e2b72bdf475c0
.quad 0x3f7d3aacbe164083,0x3f7a7302be541501,0xbf7d3aacbe164083,0xbf7a7302be541501,0x3f791298be6c9a7f,0x3f74bf62be9620d2,0xbf791298be6c9a7f,0xbf74bf62be9620d2,0x3f731447bea09ae5,0x3f6d1c1dbec1071e,0xbf731447bea09ae5,0xbf6d1c1dbec1071e,0x3f6b4b0cbec9b953,0x3f6398acbeea6681,0xbf6b4b0cbec9b953,0xbf6398acbeea6681
.quad 0x3f61c598bef15aea,0x3f584853bf08f59b,0xbf61c598bef15aea,0xbf584853bf08f59b,0x3f5695e5bf0b9a6b,0x3f4b41fabf1ba299,0xbf5695e5bf0b9a6b,0xbf4b41fabf1ba299,0x3f49d112bf1d7fd1,0x3f3ca003bf2d1469,0xbf49d112bf1d7fd1,0xbf3ca003bf2d1469,0x3f3b8f3bbf2e3bde,0x3f2c800fbf3d27b8,0xbf3b8f3bbf2e3bde,0xbf2c800fbf3d27b8
.quad 0x3f2beb4abf3daef9,0x3f1b02c6bf4bbbf8,0xbf2beb4abf3daef9,0xbf1b02c6bf4bbbf8,0x3f1b02c6bf4bbbf8,0x3f084b92bf58b3a1,0xbf1b02c6bf4bbbf8,0xbf084b92bf58b3a1,0x3f08f59bbf584853,0x3ee900b7bf63f473,0xbf08f59bbf584853,0xbee900b7bf63f473,0x3eebcbbbbf633c5a,0x3ebf926fbf6d67a1,0xbeebcbbbbf633c5a,0xbebf926fbf6d67a1
.quad 0x3f74fa0b3e94a031,0x3f7853f83e78cfcc,0xbf74fa0b3e94a031,0xbf7853f83e78cfcc,0x3f7a1e843e5a3997,0x3f7c9f8a3e25c58c,0xbf7a1e843e5a3997,0xbf7c9f8a3e25c58c,0x3f7dabcc3e09cf86,0x3f7f2f9d3da3308c,0xbf7dabcc3e09cf86,0xbf7f2f9d3da3308c,0x3f7f9c183d621469,0x3f7fffb1bb490fc6,0xbf7f9c183d621469,0xbf7fffb1bb490fc6
.quad 0x3f7fec43bcc90ab0,0x3f7f0e58bdafb680,0xbf7fec43bcc90ab0,0xbf7f0e58bdafb680,0x3f7e9bc9bdd53db9,0x3f7c5d3abe2bf804,0xbf7e9bc9bdd53db9,0xbf7c5d3abe2bf804,0x3f7baccdbe3b6ecf,0x3f77f110be7ee6e1,0xbf7baccdbe3b6ecf,0xbf77f110be7ee6e1,0x3f772417be8586ce,0x3f71d19fbea80b1f,0xbf772417be8586ce,0xbf71d19fbea80b1f
.quad 0x3f710908beac7cd4,0x3f6a09a7becf7bca,0xbf710908beac7cd4,0xbf6a09a7becf7bca,0x3f696591bed25a09,0x3f60a6cfbef58035,0xbf696591bed25a09,0xbf60a6cfbef58035,0x3f604621bef6e0cb,0x3f55b993bf0cead0,0xbf604621bef6e0cb,0xbf55b993bf0cead0,0x3f55b993bf0cead0,0x3f495521bf1e1e22,0xbf55b993bf0cead0,0xbf495521bf1e1e22
.quad 0x3f49d112bf1d7fd1,0x3f3b8f3bbf2e3bde,0xbf49d112bf1d7fd1,0xbf3b8f3bbf2e3bde,0x3f3ca003bf2d1469,0x3f2c800fbf3d27b8,0xbf3ca003bf2d1469,0xbf2c800fbf3d27b8,0x3f2e3bdebf3b8f3b,0x3f1c420cbf4ac77f,0xbf2e3bdebf3b8f3b,0xbf1c420cbf4ac77f,0x3f1ebc12bf48d8b3,0x3f0af1b7bf570348,0xbf1ebc12bf48d8b3,0xbf0af1b7bf570348
.quad 0x3f7ec46d3dc8bd36,0x3f7fb10f3d48fb30,0xbf7ec46d3dc8bd36,0xbf7fb10f3d48fb30,0x3f7ffec43bc90f88,0x3f7fba9ebd3c6dd5,0xbf7ffec43bc90f88,0xbf7fba9ebd3c6dd5,0x3f7f0e58bdafb680,0x3f7d7474be1008b7,0xbf7f0e58bdafb680,0xbf7d7474be1008b7,0x3f7bf531be354098,0x3f78e3d6be6fa8b2,0xbf7bf531be354098,0xbf78e3d6be6fa8b2
.quad 0x3f76ba07be888e93,0x3f721352bea68f12,0xbf76ba07be888e93,0xbf721352bea68f12,0x3f6f6830beb554ec,0x3f6912aebed3c867,0xbf6f6830beb554ec,0xbf6912aebed3c867,0x3f660f88bee0924f,0x3f5df6bebeff17b2,0xbf660f88bee0924f,0xbf5df6bebeff17b2,0x3f5ac450bf04f484,0x3f50d937bf140c5f,0xbf5ac450bf04f484,0xbf50d937bf140c5f
.quad 0x3f4d9f02bf187fc0,0x3f41d870bf273656,0xbf4d9f02bf187fc0,0xbf41d870bf273656,0x3f3ebc1bbf2ac082,0x3f311722bf38dd65,0xbf3ebc1bbf2ac082,0xbf311722bf38dd65,0x3f2e3bdebf3b8f3b,0x3f1ebc12bf48d8b3,0xbf2e3bdebf3b8f3b,0xbf1ebc12bf48d8b3,0x3f1c420cbf4ac77f,0x3f0af1b7bf570348,0xbf1c420cbf4ac77f,0xbf0af1b7bf570348
.quad 0x3f08f59bbf584853,0x3eebcbbbbf633c5a,0xbf08f59bbf584853,0xbeebcbbbbf633c5a,0x3ee900b7bf63f473,0x3ebf926fbf6d67a1,0xbee900b7bf63f473,0xbebf926fbf6d67a1,0x3ebe1d4abf6db293,0x3e919dddbf756d97,0xbebe1d4abf6db293,0xbe919dddbf756d97,0x3e919dddbf756d97,0x3e44b0b9bf7b3bab,0xbe919dddbf756d97,0xbe44b0b9bf7b3bab
.quad 0x3f800000248d3132,0x3f7fb10fbd48fb30,0xbf800000248d3132,0xbf7fb10fbd48fb30,0x3f7ec46dbdc8bd36,0x3f7d1cddbe195be0,0xbf7ec46dbdc8bd36,0xbf7d1cddbe195be0,0x3f7b14bebe47c5c2,0x3f77f110be7ee6e1,0xbf7b14bebe47c5c2,0xbf77f110be7ee6e1,0x3f74fa0bbe94a031,0x3f703b37beb0eacb,0xbf74fa0bbe94a031,0xbf703b37beb0eacb
.quad 0x3f6c835ebec3ef15,0x3f660f88bee0924f,0xbf6c835ebec3ef15,0xbf660f88bee0924f,0x3f61c598bef15aea,0x3f5988adbf06f686,0xbf61c598bef15aea,0xbf5988adbf06f686,0x3f54db31bf0e39da,0x3f4ac77fbf1c420c,0xbf54db31bf0e39da,0xbf4ac77fbf1c420c,0x3f45e403bf226799,0x3f39f2acbf2ff3e6,0xbf45e403bf226799,0xbf39f2acbf2ff3e6
.quad 0x3f3504f3bf3504f3,0x3f273656bf41d870,0xbf3504f3bf3504f3,0xbf273656bf41d870,0x3f226799bf45e403,0x3f12c39abf51c0c2,0xbf226799bf45e403,0xbf12c39abf51c0c2,0x3f0e39dabf54db31,0x3ef9a02dbf5f8327,0xbf0e39dabf54db31,0xbef9a02dbf5f8327,0x3ef15aeabf61c598,0x3ecb2aaebf6afb8c,0xbef15aeabf61c598,0xbecb2aaebf6afb8c
.quad 0x3ec3ef15bf6c835e,0x3e9aa086bf740bdd,0xbec3ef15bf6c835e,0xbe9aa086bf740bdd,0x3e94a031bf74fa0b,0x3e5101f1bf7a9c59,0xbe94a031bf74fa0b,0xbe5101f1bf7a9c59,0x3e47c5c2bf7b14be,0x3dd53db9bf7e9bc9,0xbe47c5c2bf7b14be,0xbdd53db9bf7e9bc9,0x3dc8bd36bf7ec46d,0x3b490fc6bf7fffb1,0xbdc8bd36bf7ec46d,0xbb490fc6bf7fffb1
.quad 0x3f7b14bebe47c5c2,0x3f7853f8be78cfcc,0xbf7b14bebe47c5c2,0xbf7853f8be78cfcc,0x3f740bddbe9aa086,0x3f6faf1bbeb3dca5,0xbf740bddbe9aa086,0xbf6faf1bbeb3dca5,0x3f6a09a7becf7bca,0x3f63f473bee900b7,0xbf6a09a7becf7bca,0xbf63f473bee900b7,0x3f5d2d53bf00e7e4,0x3f554aa4bf0d9281,0xbf5d2d53bf00e7e4,0xbf554aa4bf0d9281
.quad 0x3f4d9f02bf187fc0,0x3f43e200bf24d225,0xbf4d9f02bf187fc0,0xbf43e200bf24d225,0x3f3b8f3bbf2e3bde,0x3f2ff3e6bf39f2ac,0xbf3b8f3bbf2e3bde,0xbf2ff3e6bf39f2ac,0x3f273656bf41d870,0x3f19c200bf4cae79,0xbf273656bf41d870,0xbf19c200bf4cae79,0x3f10d3cdbf531849,0x3f019573bf5cc7d1,0xbf10d3cdbf531849,0xbf019573bf5cc7d1
.quad 0x3ef15aeabf61c598,0x3ecf7bcabf6a09a7,0xbef15aeabf61c598,0xbecf7bcabf6a09a7,0x3ebe1d4abf6db293,0x3e9920febf74484b,0xbebe1d4abf6db293,0xbe9920febf74484b,0x3e888e93bf76ba07,0x3e419b37bf7b61fc,0xbe888e93bf76ba07,0xbe419b37bf7b61fc,0x3e22abb6bf7cbfc9,0x3d9cecf9bf7f3f54,0xbe22abb6bf7cbfc9,0xbd9cecf9bf7f3f54
.quad 0x3d48fb30bf7fb10f,0xbd16c32cbf7fd397,0xbd48fb30bf7fb10f,0x3d16c32cbf7fd397,0xbd7b2b74bf7f84ab,0xbe195be0bf7d1cdd,0x3d7b2b74bf7f84ab,0x3e195be0bf7d1cdd,0xbe2f10a2bf7c3b28,0xbe8586cebf772417,0x3e2f10a2bf7c3b28,0x3e8586cebf772417,0xbe8e9a22bf75dec6,0xbebca7afbf6dfcf2,0x3e8e9a22bf75dec6,0x3ebca7afbf6dfcf2
.quad 0x3f7ec46dbdc8bd36,0x3f7d3aacbe164083,0xbf7ec46dbdc8bd36,0xbf7d3aacbe164083,0x3f7ac516be4dee60,0x3f77beb7be80f8c0,0xbf7ac516be4dee60,0xbf77beb7be80f8c0,0x3f740bddbe9aa086,0x3f6f6830beb554ec,0xbf740bddbe9aa086,0xbf6f6830beb554ec,0x3f6aab7bbecc9b8b,0x3f644facbee79a5d,0xbf6aab7bbecc9b8b,0xbf644facbee79a5d
.quad 0x3f5ebe05befc5d27,0x3f5695e5bf0b9a6b,0xbf5ebe05befc5d27,0xbf5695e5bf0b9a6b,0x3f5064afbf14b039,0x3f466354bf21cbfb,0xbf5064afbf14b039,0xbf466354bf21cbfb,0x3f3fc767bf299415,0x3f33e7bcbf36206c,0xbf3fc767bf299415,0xbf33e7bcbf36206c,0x3f2d1469bf3ca003,0x3f1f599fbf485bca,0xbf2d1469bf3ca003,0xbf1f599fbf485bca
.quad 0x3f187fc0bf4d9f02,0x3f08f59bbf584853,0xbf187fc0bf4d9f02,0xbf08f59bbf584853,0x3f0242b1bf5c61c7,0x3ee1fb6abf65b710,0xbf0242b1bf5c61c7,0xbee1fb6abf65b710,0x3ed53641bf68bf3c,0x3eaf713abf708066,0xbed53641bf68bf3c,0xbeaf713abf708066,0x3ea395c5bf7294f8,0x3e75c35abf788486,0xbea395c5bf7294f8,0xbe75c35abf788486
.quad 0x3e605c13bf79c79d,0x3e09cf86bf7dabcc,0xbe605c13bf79c79d,0xbe09cf86bf7dabcc,0x3dee3876bf7e4323,0x3ce22a7abf7fe705,0xbdee3876bf7e4323,0xbce22a7abf7fe705,0x3c490e90bf7ffb11,0xbda3308cbf7f2f9d,0xbc490e90bf7ffb11,0x3da3308cbf7f2f9d,0xbdbc3ac3bf7eea9d,0xbe3e853ebf7b87b2,0x3dbc3ac3bf7eea9d,0x3e3e853ebf7b87b2
.quad 0x3f74fa0bbe94a031,0x3f710908beac7cd4,0xbf74fa0bbe94a031,0xbf710908beac7cd4,0x3f6aab7bbecc9b8b,0x3f650479bee4cbfe,0xbf6aab7bbecc9b8b,0xbf650479bee4cbfe,0x3f5d2d53bf00e7e4,0x3f55b993bf0cead0,0xbf5d2d53bf00e7e4,0xbf55b993bf0cead0,0x3f4cae79bf19c200,0x3f436051bf256bcb,0xbf4cae79bf19c200,0xbf436051bf256bcb
.quad 0x3f396842bf3085bb,0x3f2e3bdebf3b8f3b,0xbf396842bf3085bb,0xbf2e3bdebf3b8f3b,0x3f239da9bf44e3f5,0x3f16999fbf4f0417,0xbf239da9bf44e3f5,0xbf16999fbf4f0417,0x3f0b9a6bbf5695e5,0x3ef9a02dbf5f8327,0xbf0b9a6bbf5695e5,0xbef9a02dbf5f8327,0x3ee363fabf655e0b,0x3ec27b55bf6cd007,0xbee363fabf655e0b,0xbec27b55bf6cd007
.quad 0x3eac7cd4bf710908,0x3e888e93bf76ba07,0xbeac7cd4bf710908,0xbe888e93bf76ba07,0x3e667c66bf796e4e,0x3e195be0bf7d1cdd,0xbe667c66bf796e4e,0xbe195be0bf7d1cdd,0x3de1bc2ebf7e70b0,0x3cfb49babf7fe129,0xbde1bc2ebf7e70b0,0xbcfb49babf7fe129,0xbbc90f88bf7ffec4,0xbdb5f8dabf7efcc9,0x3bc90f88bf7ffec4,0x3db5f8dabf7efcc9
.quad 0xbdfab273bf7e1324,0xbe541501bf7a7302,0x3dfab273bf7e1324,0x3e541501bf7a7302,0xbe72b651bf78b47b,0xbea5129fbf725470,0x3e72b651bf78b47b,0x3ea5129fbf725470,0xbeb263efbf6ff573,0xbeddbe79bf66becc,0x3eb263efbf6ff573,0x3eddbe79bf66becc,0xbee900b7bf63f473,0xbf099f4ebf57dc7f,0x3ee900b7bf63f473,0x3f099f4ebf57dc7f
.quad 0x3f6c835ebec3ef15,0x3f676bd8bedae880,0xbf6c835ebec3ef15,0xbf676bd8bedae880,0x3f5ebe05befc5d27,0x3f57dc7fbf099f4e,0xbf5ebe05befc5d27,0xbf57dc7fbf099f4e,0x3f4d9f02bf187fc0,0x3f44e3f5bf239da9,0xbf4d9f02bf187fc0,0xbf44e3f5bf239da9,0x3f396842bf3085bb,0x3f2ecef7bf3b0629,0xbf396842bf3085bb,0xbf2ecef7bf3b0629
.quad 0x3f226799bf45e403,0x3f15f6d9bf4f7a1f,0xbf226799bf45e403,0xbf15f6d9bf4f7a1f,0x3f08f59bbf584853,0x3ef58035bf60a6cf,0xbf08f59bbf584853,0xbef58035bf60a6cf,0x3edae880bf676bd8,0x3ebb31a0bf6e46be,0xbedae880bf676bd8,0xbebb31a0bf6e46be,0x3ea09ae5bf731447,0x3e7bdba4bf7822d1,0xbea09ae5bf731447,0xbe7bdba4bf7822d1
.quad 0x3e47c5c2bf7b14be,0x3dfab273bf7e1324,0xbe47c5c2bf7b14be,0xbdfab273bf7e1324,0x3d96a905bf7f4e6d,0xbb490fc6bf7fffb1,0xbd96a905bf7f4e6d,0x3b490fc6bf7fffb1,0xbd48fb30bf7fb10f,0xbe039502bf7de0b1,0x3d48fb30bf7fb10f,0x3e039502bf7de0b1,0xbe2f10a2bf7c3b28,0xbe80f8c0bf77beb7,0x3e2f10a2bf7c3b28,0x3e80f8c0bf77beb7
.quad 0xbe94a031bf74fa0b,0xbebe1d4abf6db293,0x3e94a031bf74fa0b,0x3ebe1d4abf6db293,0xbecf7bcabf6a09a7,0xbef840c8bf5fe4e9,0x3ecf7bcabf6a09a7,0x3ef840c8bf5fe4e9,0xbf039c3dbf5b941a,0xbf173c07bf4e8d90,0x3f039c3dbf5b941a,0x3f173c07bf4e8d90,0xbf1d7fd1bf49d112,0xbf2ff3e6bf39f2ac,0x3f1d7fd1bf49d112,0x3f2ff3e6bf39f2ac
.quad 0x3f54db31bf0e39da,0x3f4d9f02bf187fc0,0xbf54db31bf0e39da,0xbf4d9f02bf187fc0,0x3f3fc767bf299415,0x3f36ad7fbf33587a,0xbf3fc767bf299415,0xbf36ad7fbf33587a,0x3f273656bf41d870,0x3f1c420cbf4ac77f,0xbf273656bf41d870,0xbf1c420cbf4ac77f,0x3f0b9a6bbf5695e5,0x3efdbabbbf5e5aa6,0xbf0b9a6bbf5695e5,0xbefdbabbbf5e5aa6
.quad 0x3edae880bf676bd8,0x3ebe1d4abf6db293,0xbedae880bf676bd8,0xbebe1d4abf6db293,0x3e9aa086bf740bdd,0x3e75c35abf788486,0xbe9aa086bf740bdd,0xbe75c35abf788486,0x3e2f10a2bf7c3b28,0x3dd53db9bf7e9bc9,0xbe2f10a2bf7c3b28,0xbdd53db9bf7e9bc9,0x3d16c32cbf7fd397,0xbd0a342fbf7fdaaf,0xbd16c32cbf7fd397,0x3d0a342fbf7fdaaf
.quad 0xbdc8bd36bf7ec46d,0xbe2f10a2bf7c3b28,0x3dc8bd36bf7ec46d,0x3e2f10a2bf7c3b28,0xbe6c9a7fbf791298,0xbe9c1fafbf73ced9,0x3e6c9a7fbf791298,0x3e9c1fafbf73ced9,0xbeb8442abf6ed89e,0xbeddbe79bf66becc,0x3eb8442abf6ed89e,0x3eddbe79bf66becc,0xbef6e0cbbf604621,0xbf0d9281bf554aa4,0x3ef6e0cbbf604621,0x3f0d9281bf554aa4
.quad 0xbf187fc0bf4d9f02,0xbf299415bf3fc767,0x3f187fc0bf4d9f02,0x3f299415bf3fc767,0xbf32c8c9bf373a23,0xbf425b89bf269de3,0x3f32c8c9bf373a23,0x3f425b89bf269de3,0xbf49d112bf1d7fd1,0xbf577026bf0a48ad,0x3f49d112bf1d7fd1,0x3f577026bf0a48ad,0xbf5d2d53bf00e7e4,0xbf686b39bed6a399,0x3f5d2d53bf00e7e4,0x3f686b39bed6a399
.quad 0x3f61c598bef15aea,0x3f5b941abf039c3d,0xbf61c598bef15aea,0xbf5b941abf039c3d,0x3f5064afbf14b039,0x3f485bcabf1f599f,0xbf5064afbf14b039,0xbf485bcabf1f599f,0x3f3b8f3bbf2e3bde,0x3f31a81dbf385216,0xbf3b8f3bbf2e3bde,0xbf31a81dbf385216,0x3f239da9bf44e3f5,0x3f17de12bf4e1689,0xbf239da9bf44e3f5,0xbf17de12bf4e1689
.quad 0x3f08f59bbf584853,0x3ef6e0cbbf604621,0xbf08f59bbf584853,0xbef6e0cbbf604621,0x3ed8106bbf6816a8,0x3eb9bb1ebf6e8ff8,0xbed8106bbf6816a8,0xbeb9bb1ebf6e8ff8,0x3e9aa086bf740bdd,0x3e72b651bf78b47b,0xbe9aa086bf740bdd,0xbe72b651bf78b47b,0x3e354098bf7bf531,0x3ddb7d37bf7e868b,0xbe354098bf7bf531,0xbddb7d37bf7e868b
.quad 0x3d48fb30bf7fb10f,0xbcc90ab0bf7fec43,0xbd48fb30bf7fb10f,0x3cc90ab0bf7fec43,0xbda3308cbf7f2f9d,0xbe1f917bbf7cdf6c,0x3da3308cbf7f2f9d,0x3e1f917bbf7cdf6c,0xbe541501bf7a7302,0xbe919dddbf756d97,0x3e541501bf7a7302,0x3e919dddbf756d97,0xbea986c4bf718f57,0xbed0eb2abf69b7e4,0x3ea986c4bf718f57,0x3ed0eb2abf69b7e4
.quad 0xbee63375bf64aa59,0xbf064b82bf59f26a,0x3ee63375bf64aa59,0x3f064b82bf59f26a,0xbf0f8784bf53fac3,0xbf21cbfbbf466354,0x3f0f8784bf53fac3,0x3f21cbfbbf466354,0xbf299415bf3fc767,0xbf3a7ca4bf2f61a5,0x3f299415bf3fc767,0x3f3a7ca4bf2f61a5,0xbf40d0dabf286605,0xbf4fefa8bf1553b7,0x3f40d0dabf286605,0x3f4fefa8bf1553b7
.quad 0x3f45e403bf226799,0x3f3daef9bf2beb4a,0xbf45e403bf226799,0xbf3daef9bf2beb4a,0x3f2d1469bf3ca003,0x3f2302d3bf456439,0xbf2d1469bf3ca003,0xbf2302d3bf456439,0x3f10d3cdbf531849,0x3f04f484bf5ac450,0xbf10d3cdbf531849,0xbf04f484bf5ac450,0x3ee363fabf655e0b,0x3ec8477cbf6b99fb,0xbee363fabf655e0b,0xbec8477cbf6b99fb
.quad 0x3ea09ae5bf731447,0x3e827dc0bf778bc5,0xbea09ae5bf731447,0xbe827dc0bf778bc5,0x3e354098bf7bf531,0x3de7fa9abf7e5a38,0xbe354098bf7bf531,0xbde7fa9abf7e5a38,0x3d16c32cbf7fd397,0xbcfb49babf7fe129,0xbd16c32cbf7fd397,0x3cfb49babf7fe129,0xbdd53db9bf7e9bc9,0xbe3228d4bf7c187a,0x3dd53db9bf7e9bc9,0x3e3228d4bf7c187a
.quad 0xbe78cfccbf7853f8,0xbea09ae5bf731447,0x3e78cfccbf7853f8,0x3ea09ae5bf731447,0xbec1071ebf6d1c1d,0xbee4cbfebf650479,0x3ec1071ebf6d1c1d,0x3ee4cbfebf650479,0xbf00e7e4bf5d2d53,0xbf121eb0bf5233c6,0x3f00e7e4bf5d2d53,0x3f121eb0bf5233c6,0xbf1ebc12bf48d8b3,0xbf2ecef7bf3b0629,0x3f1ebc12bf48d8b3,0x3f2ecef7bf3b0629
.quad 0xbf396842bf3085bb,0xbf47de65bf1ff6cb,0x3f396842bf3085bb,0x3f47de65bf1ff6cb,0xbf5064afbf14b039,0xbf5cc7d1bf019573,0x3f5064afbf14b039,0x3f5cc7d1bf019573,0xbf633c5abeebcbbb,0xbf6d1c1dbec1071e,0x3f633c5abeebcbbb,0x3f6d1c1dbec1071e,0xbf718f57bea986c4,0xbf788486be75c35a,0x3f718f57bea986c4,0x3f788486be75c35a
.quad 0x3f3504f3bf3504f3,0x3f2beb4abf3daef9,0xbf3504f3bf3504f3,0xbf2beb4abf3daef9,0x3f187fc0bf4d9f02,0x3f0d9281bf554aa4,0xbf187fc0bf4d9f02,0xbf0d9281bf554aa4,0x3ef15aeabf61c598,0x3ed8106bbf6816a8,0xbef15aeabf61c598,0xbed8106bbf6816a8,0x3eac7cd4bf710908,0x3e901c2cbf75a67b,0xbeac7cd4bf710908,0xbe901c2cbf75a67b
.quad 0x3e47c5c2bf7b14be,0x3e09cf86bf7dabcc,0xbe47c5c2bf7b14be,0xbe09cf86bf7dabcc,0x3d48fb30bf7fb10f,0xbc7b514bbf7ff84a,0xbd48fb30bf7fb10f,0x3c7b514bbf7ff84a,0xbdc8bd36bf7ec46d,0xbe28defcbf7c7eb0,0x3dc8bd36bf7ec46d,0x3e28defcbf7c7eb0,0xbe78cfccbf7853f8,0xbe9f1cdfbf73530e,0x3e78cfccbf7853f8,0x3e9f1cdfbf73530e
.quad 0xbec3ef15bf6c835e,0xbee63375bf64aa59,0x3ec3ef15bf6c835e,0x3ee63375bf64aa59,0xbf039c3dbf5b941a,0xbf140c5fbf50d937,0x3f039c3dbf5b941a,0x3f140c5fbf50d937,0xbf226799bf45e403,0xbf31a81dbf385216,0x3f226799bf45e403,0x3f31a81dbf385216,0xbf3daef9bf2beb4a,0xbf4b41fabf1ba299,0x3f3daef9bf2beb4a,0x3f4b41fabf1ba299
.quad 0xbf54db31bf0e39da,0xbf604621bef6e0cb,0x3f54db31bf0e39da,0x3f604621bef6e0cb,0xbf676bd8bedae880,0xbf703b37beb0eacb,0x3f676bd8bedae880,0x3f703b37beb0eacb,0xbf74fa0bbe94a031,0xbf7ac516be4dee60,0x3f74fa0bbe94a031,0x3f7ac516be4dee60,0xbf7d3aacbe164083,0xbf7fa6e3bd55880e,0x3f7d3aacbe164083,0x3f7fa6e3bd55880e
.quad 0x3f0e39dabf54db31,0x3f039c3dbf5b941a,0xbf0e39dabf54db31,0xbf039c3dbf5b941a,0x3ed53641bf68bf3c,0x3ebca7afbf6dfcf2,0xbed53641bf68bf3c,0xbebca7afbf6dfcf2,0x3e888e93bf76ba07,0x3e5a3997bf7a1e84,0xbe888e93bf76ba07,0xbe5a3997bf7a1e84,0x3de1bc2ebf7e70b0,0x3d55880ebf7fa6e3,0xbde1bc2ebf7e70b0,0xbd55880ebf7fa6e3
.quad 0xbd48fb30bf7fb10f,0xbde1bc2ebf7e70b0,0x3d48fb30bf7fb10f,0x3de1bc2ebf7e70b0,0xbe541501bf7a7302,0xbe8a11f7bf76841b,0x3e541501bf7a7302,0x3e8a11f7bf76841b,0xbeb8442abf6ed89e,0xbed8106bbf6816a8,0x3eb8442abf6ed89e,0x3ed8106bbf6816a8,0xbf00e7e4bf5d2d53,0xbf102dd5bf5389c7,0x3f00e7e4bf5d2d53,0x3f102dd5bf5389c7
.quad 0xbf226799bf45e403,0xbf3085bbbf396842,0x3f226799bf45e403,0x3f3085bbbf396842,0xbf3fc767bf299415,0xbf4c3578bf1a6293,0x3f3fc767bf299415,0x3f4c3578bf1a6293,0xbf584853bf08f59b,0xbf628210beee9479,0x3f584853bf08f59b,0x3f628210beee9479,0xbf6b4b0cbec9b953,0xbf72d4ebbea21887,0x3f6b4b0cbec9b953,0x3f72d4ebbea21887
.quad 0xbf7853f8be78cfcc,0xbf7cbfc9be22abb6,0x3f7853f8be78cfcc,0x3f7cbfc9be22abb6,0xbf7f0e58bdafb680,0xbf7fffb13b490fc6,0x3f7f0e58bdafb680,0x3f7fffb13b490fc6,0xbf7f4e6d3d96a905,0xbf7c7eb03e28defc,0x3f7f4e6d3d96a905,0x3f7c7eb03e28defc,0xbf7912983e6c9a7f,0xbf7254703ea5129f,0x3f7912983e6c9a7f,0x3f7254703ea5129f
.quad 0x3f226799bf45e403,0x3f187fc0bf4d9f02,0xbf226799bf45e403,0xbf187fc0bf4d9f02,0x3f0242b1bf5c61c7,0x3eed3063bf62df7b,0xbf0242b1bf5c61c7,0xbeed3063bf62df7b,0x3ebe1d4abf6db293,0x3ea395c5bf7294f8,0xbebe1d4abf6db293,0xbea395c5bf7294f8,0x3e667c66bf796e4e,0x3e2bf804bf7c5d3a,0xbe667c66bf796e4e,0xbe2bf804bf7c5d3a
.quad 0x3d96a905bf7f4e6d,0x3c490e90bf7ffb11,0xbd96a905bf7f4e6d,0xbc490e90bf7ffb11,0xbda3308cbf7f2f9d,0xbe1324cabf7d57de,0x3da3308cbf7f2f9d,0x3e1324cabf7d57de,0xbe6c9a7fbf791298,0xbe97a117bf748422,0x3e6c9a7fbf791298,0x3e97a117bf748422,0xbec1071ebf6d1c1d,0xbee1fb6abf65b710,0x3ec1071ebf6d1c1d,0x3ee1fb6abf65b710
.quad 0xbf039c3dbf5b941a,0xbf13682abf514d3d,0x3f039c3dbf5b941a,0x3f13682abf514d3d,0xbf239da9bf44e3f5,0xbf3238aabf37c655,0x3f239da9bf44e3f5,0x3f3238aabf37c655,0xbf3fc767bf299415,0xbf4cae79bf19c200,0x3f3fc767bf299415,0x3f4cae79bf19c200,0xbf577026bf0a48ad,0xbf62241abeeff7fb,0x3f577026bf0a48ad,0x3f62241abeeff7fb
.quad 0xbf6a09a7becf7bca,0xbf721352bea68f12,0x3f6a09a7becf7bca,0x3f721352bea68f12,0xbf772417be8586ce,0xbf7c187abe3228d4,0x3f772417be8586ce,0x3f7c187abe3228d4,0xbf7e70b0bde1bc2e,0xbf7ff4e6bc96c9b6,0x3f7e70b0bde1bc2e,0x3f7ff4e6bc96c9b6,0xbf7fc38f3d2fe007,0xbf7d906e3e0cec4a,0x3f7fc38f3d2fe007,0x3f7d906e3e0cec4a
.quad 0x3ef15aeabf61c598,0x3edae880bf676bd8,0xbef15aeabf61c598,0xbedae880bf676bd8,0x3ea395c5bf7294f8,0x3e8a11f7bf76841b,0xbea395c5bf7294f8,0xbe8a11f7bf76841b,0x3e22abb6bf7cbfc9,0x3dd53db9bf7e9bc9,0xbe22abb6bf7cbfc9,0xbdd53db9bf7e9bc9,0xbbc90f88bf7ffec4,0xbd83db0abf7f7808,0x3bc90f88bf7ffec4,0x3d83db0abf7f7808
.quad 0xbe2f10a2bf7c3b28,0xbe6c9a7fbf791298,0x3e2f10a2bf7c3b28,0x3e6c9a7fbf791298,0xbea986c4bf718f57,0xbec8477cbf6b99fb,0x3ea986c4bf718f57,0x3ec8477cbf6b99fb,0xbef6e0cbbf604621,0xbf0a48adbf577026,0x3ef6e0cbbf604621,0x3f0a48adbf577026,0xbf1ebc12bf48d8b3,0xbf2c800fbf3d27b8,0x3f1ebc12bf48d8b3,0x3f2c800fbf3d27b8
.quad 0xbf3daef9bf2beb4a,0xbf49d112bf1d7fd1,0x3f3daef9bf2beb4a,0x3f49d112bf1d7fd1,0xbf577026bf0a48ad,0xbf61668abef2bd43,0x3f577026bf0a48ad,0x3f61668abef2bd43,0xbf6b4b0cbec9b953,0xbf7294f8bea395c5,0x3f6b4b0cbec9b953,0x3f7294f8bea395c5,0xbf78b47bbe72b651,0xbf7cdf6cbe1f917b,0x3f78b47bbe72b651,0x3f7cdf6cbe1f917b
.quad 0xbf7f4e6dbd96a905,0xbf7ffb113c490e90,0x3f7f4e6dbd96a905,0x3f7ffb113c490e90,0xbf7eea9d3dbc3ac3,0xbf7bd14d3e3857ec,0x3f7eea9d3dbc3ac3,0x3f7bd14d3e3857ec,0xbf778bc53e827dc0,0xbf7080663eaf713a,0x3f778bc53e827dc0,0x3f7080663eaf713a,0xbf6965913ed25a09,0xbf5e5aa63efdbabb,0x3f6965913ed25a09,0x3f5e5aa63efdbabb
.quad 0x3ec3ef15bf6c835e,0x3eac7cd4bf710908,0xbec3ef15bf6c835e,0xbeac7cd4bf710908,0x3e605c13bf79c79d,0x3e2bf804bf7c5d3a,0xbe605c13bf79c79d,0xbe2bf804bf7c5d3a,0x3d48fb30bf7fb10f,0xbbc90f88bf7ffec4,0xbd48fb30bf7fb10f,0x3bc90f88bf7ffec4,0xbdfab273bf7e1324,0xbe3857ecbf7bd14d,0x3dfab273bf7e1324,0x3e3857ecbf7bd14d
.quad 0xbe94a031bf74fa0b,0xbeb263efbf6ff573,0x3e94a031bf74fa0b,0x3eb263efbf6ff573,0xbee63375bf64aa59,0xbf019573bf5cc7d1,0x3ee63375bf64aa59,0x3f019573bf5cc7d1,0xbf187fc0bf4d9f02,0xbf26050abf42de29,0x3f187fc0bf4d9f02,0x3f26050abf42de29,0xbf396842bf3085bb,0xbf456439bf2302d3,0x3f396842bf3085bb,0x3f456439bf2302d3
.quad 0xbf54db31bf0e39da,0xbf5ebe05befc5d27,0x3f54db31bf0e39da,0x3f5ebe05befc5d27,0xbf6a09a7becf7bca,0xbf714c7abeab0201,0x3f6a09a7becf7bca,0x3f714c7abeab0201,0xbf7853f8be78cfcc,0xbf7c7eb0be28defc,0x3f7853f8be78cfcc,0x3f7c7eb0be28defc,0xbf7f4e6dbd96a905,0xbf7ffd393c16cb58,0x3f7f4e6dbd96a905,0x3f7ffd393c16cb58
.quad 0xbf7ec46d3dc8bd36,0xbf7baccd3e3b6ecf,0x3f7ec46d3dc8bd36,0x3f7baccd3e3b6ecf,0xbf76ba073e888e93,0xbf6faf1b3eb3dca5,0x3f76ba073e888e93,0x3f6faf1b3eb3dca5,0xbf676bd83edae880,0xbf5c61c73f0242b1,0x3f676bd83edae880,0x3f5c61c73f0242b1,0xbf514d3d3f13682a,0xbf425b893f269de3,0x3f514d3d3f13682a,0x3f425b893f269de3
.quad 0x3e47c5c2bf7b14be,0x3e164083bf7d3aac,0xbe47c5c2bf7b14be,0xbe164083bf7d3aac,0x3c490e90bf7ffb11,0xbd2351cbbf7fcbe2,0xbc490e90bf7ffb11,0x3d2351cbbf7fcbe2,0xbe2f10a2bf7c3b28,0xbe667c66bf796e4e,0x3e2f10a2bf7c3b28,0x3e667c66bf796e4e,0xbeb263efbf6ff573,0xbece0beabf6a5ad9,0x3eb263efbf6ff573,0x3ece0beabf6a5ad9
.quad 0xbf039c3dbf5b941a,0xbf10d3cdbf531849,0x3f039c3dbf5b941a,0x3f10d3cdbf531849,0xbf299415bf3fc767,0xbf3592e7bf34768f,0x3f299415bf3fc767,0x3f3592e7bf34768f,0xbf49d112bf1d7fd1,0xbf53fac3bf0f8784,0x3f49d112bf1d7fd1,0x3f53fac3bf0f8784,0xbf633c5abeebcbbb,0xbf6afb8cbecb2aae,0x3f633c5abeebcbbb,0x3f6afb8cbecb2aae
.quad 0xbf74fa0bbe94a031,0xbf79c79dbe605c13,0x3f74fa0bbe94a031,0x3f79c79dbe605c13,0xbf7e70b0bde1bc2e,0xbf7fdaafbd0a342f,0x3f7e70b0bde1bc2e,0x3f7fdaafbd0a342f,0xbf7f4e6d3d96a905,0xbf7cfe733e1c76de,0x3f7f4e6d3d96a905,0x3f7cfe733e1c76de,0xbf778bc53e827dc0,0xbf714c7a3eab0201,0x3f778bc53e827dc0,0x3f714c7a3eab0201
.quad 0xbf676bd83edae880,0xbf5d2d533f00e7e4,0x3f676bd83edae880,0x3f5d2d533f00e7e4,0xbf4f7a1f3f15f6d9,0xbf4154e13f27ce61,0x3f4f7a1f3f15f6d9,0x3f4154e13f27ce61,0xbf3085bb3f396842,0xbf1ebc123f48d8b3,0x3f3085bb3f396842,0x3f1ebc123f48d8b3,0xbf0b9a6b3f5695e5,0xbeed30633f62df7b,0x3f0b9a6b3f5695e5,0x3eed30633f62df7b
.quad 0x3e94a031bf74fa0b,0x3e78cfccbf7853f8,0xbe94a031bf74fa0b,0xbe78cfccbf7853f8,0x3dee3876bf7e4323,0x3d83db0abf7f7808,0xbdee3876bf7e4323,0xbd83db0abf7f7808,0xbd7b2b74bf7f84ab,0xbdee3876bf7e4323,0x3d7b2b74bf7f84ab,0x3dee3876bf7e4323,0xbe72b651bf78b47b,0xbe9620d2bf74bf62,0x3e72b651bf78b47b,0x3e9620d2bf74bf62
.quad 0xbecf7bcabf6a09a7,0xbeebcbbbbf633c5a,0x3ecf7bcabf6a09a7,0x3eebcbbbbf633c5a,0xbf0f8784bf53fac3,0xbf1ce11fbf4a4c87,0x3f0f8784bf53fac3,0x3f1ce11fbf4a4c87,0xbf32c8c9bf373a23,0xbf3ebc1bbf2ac082,0x3f32c8c9bf373a23,0x3f3ebc1bbf2ac082,0xbf5064afbf14b039,0xbf5a5ba0bf05a02c,0x3f5064afbf14b039,0x3f5a5ba0bf05a02c
.quad 0xbf676bd8bedae880,0xbf6ed89ebeb8442a,0x3f676bd8bedae880,0x3f6ed89ebeb8442a,0xbf772417be8586ce,0xbf7b87b2be3e853e,0x3f772417be8586ce,0x3f7b87b2be3e853e,0xbf7f0e58bdafb680,0xbf7ffec4bbc90f88,0x3f7f0e58bdafb680,0x3f7ffec4bbc90f88,0xbf7eea9d3dbc3ac3,0xbf7c187a3e3228d4,0x3f7eea9d3dbc3ac3,0x3f7c187a3e3228d4
.quad 0xbf76ba073e888e93,0xbf6ff5733eb263ef,0x3f76ba073e888e93,0x3f6ff5733eb263ef,0xbf66becc3eddbe79,0xbf5bfb343f02ef9f,0x3f66becc3eddbe79,0x3f5bfb343f02ef9f,0xbf4f7a1f3f15f6d9,0xbf40d0da3f286605,0x3f4f7a1f3f15f6d9,0x3f40d0da3f286605,0xbf31a81d3f385216,0xbf1f599f3f485bca,0x3f31a81d3f385216,0x3f1f599f3f485bca
.quad 0x3dc8bd36bf7ec46d,0x3d48fb30bf7fb10f,0xbdc8bd36bf7ec46d,0xbd48fb30bf7fb10f,0xbdbc3ac3bf7eea9d,0xbe1324cabf7d57de,0x3dbc3ac3bf7eea9d,0x3e1324cabf7d57de,0xbe8e9a22bf75dec6,0xbea986c4bf718f57,0x3e8e9a22bf75dec6,0x3ea986c4bf718f57,0xbee900b7bf63f473,0xbf019573bf5cc7d1,0x3ee900b7bf63f473,0x3f019573bf5cc7d1
.quad 0xbf1d7fd1bf49d112,0xbf299415bf3fc767,0x3f1d7fd1bf49d112,0x3f299415bf3fc767,0xbf40d0dabf286605,0xbf4b41fabf1ba299,0x3f40d0dabf286605,0x3f4b41fabf1ba299,0xbf5d2d53bf00e7e4,0xbf655e0bbee363fa,0x3f5d2d53bf00e7e4,0x3f655e0bbee363fa,0xbf718f57bea986c4,0xbf76ef5bbe870ada,0x3f718f57bea986c4,0x3f76ef5bbe870ada
.quad 0xbf7d3aacbe164083,0xbf7f4e6dbd96a905,0x3f7d3aacbe164083,0x3f7f4e6dbd96a905,0xbf7fc38f3d2fe007,0xbf7e2b723df475c0,0x3f7fc38f3d2fe007,0x3f7e2b723df475c0,0xbf7912983e6c9a7f,0xbf73913f3e9d9e78,0x3f7912983e6c9a7f,0x3f73913f3e9d9e78,0xbf6965913ed25a09,0xbf5fe4e93ef840c8,0x3f6965913ed25a09,0x3f5fe4e93ef840c8
.quad 0xbf514d3d3f13682a,0xbf43e2003f24d225,0x3f514d3d3f13682a,0x3f43e2003f24d225,0xbf31a81d3f385216,0xbf2093933f476085,0x3f31a81d3f385216,0x3f2093933f476085,0xbf0b9a6b3f5695e5,0xbeee94793f628210,0x3f0b9a6b3f5695e5,0x3eee94793f628210,0xbec1071e3f6d1c1d,0xbe931f353f75341d,0x3ec1071e3f6d1c1d,0x3e931f353f75341d
.quad 0x35e38e39,0x35e38e39,0x35e38e39,0x31b2b8b035e38df3,0x35e38e39,0x3232b87935e38d20,0x35e38e39,0x32860a1635e38bc1,0x35e38e39,0x32b2b79c35e389d6,0x35e38e39,0x32df64b535e3875e,0x35e38e39,0x330608a235e3845a,0x35e38e39,0x331c5e9635e380ca
.quad 0x35e38e39,0x3332b42a35e37cad,0x35e38e39,0x3349095035e37804,0x35e38e39,0x335f5dfa35e372cf,0x35e38e39,0x3375b21a35e36d0d,0x35e38e39,0x338602d135e366c0,0x35e38e39,0x33912c4335e35fe5,0x35e38e39,0x339c555b35e3587f,0x35e38e39,0x33a77e1335e3508c
.quad 0x35e38e39,0x33b2a66335e3480d,0x35e38e39,0x33bdce4535e33f02,0x35e38e39,0x33c8f5b235e3356b,0x35e38e39,0x33d41ca335e32b48,0x35e38e39,0x33df431235e32098,0x35e38e39,0x33ea68f635e3155d,0x35e38e39,0x33f58e4a35e30995,0x35e38e39,0x3400598335e2fd41
.quad 0x35e38e39,0x3405eb9235e2f061,0x35e38e39,0x340b7d4f35e2e2f5,0x35e38e39,0x34110eb535e2d4fe,0x35e38e39,0x34169fc235e2c67a,0x35e38e39,0x341c307235e2b76b,0x35e38e39,0x3421c0c235e2a7cf,0x35e38e39,0x342750ae35e297a8,0x35e38e39,0x342ce03235e286f5
.quad 0x35e38e39,0x35e38e39,0x3232b87935e38d20,0x32860a1635e38bc1,0x32b2b79c35e389d6,0x330608a235e3845a,0x330608a235e3845a,0x3349095035e37804,0x3332b42a35e37cad,0x338602d135e366c0,0x335f5dfa35e372cf,0x33a77e1335e3508c,0x338602d135e366c0,0x33c8f5b235e3356b,0x339c555b35e3587f,0x33ea68f635e3155d
.quad 0x33b2a66335e3480d,0x3405eb9235e2f061,0x33c8f5b235e3356b,0x34169fc235e2c67a,0x33df431235e32098,0x342750ae35e297a8,0x33f58e4a35e30995,0x3437fdf835e263ec,0x3405eb9235e2f061,0x3448a74635e22b47,0x34110eb535e2d4fe,0x34594c3935e1edbb,0x341c307235e2b76b,0x3469ec7635e1ab48,0x342750ae35e297a8,0x347a87a035e163f0
.quad 0x34326f4c35e275b6,0x34858eae35e117b5,0x343d8c3335e25196,0x348dd6a635e0c699,0x3448a74635e22b47,0x34961b8b35e0709c,0x3453c06935e202ca,0x349e5d2e35e015c2,0x345ed78235e1d820,0x34a69b6335dfb60c,0x3469ec7635e1ab48,0x34aed5fa35df517b,0x3474ff2835e17c43,0x34b70cc735dee813,0x348007bf35e14b12,0x34bf3f9b35de79d6
.quad 0x34858eae35e117b5,0x34c76e4a35de06c5,0x348b145335e0e22d,0x34cf98a635dd8ee3,0x349098a135e0aa7a,0x34d7be8135dd1234,0x34961b8b35e0709c,0x34dfdfae35dc90b9,0x349b9d0235e03495,0x34e7fc0135dc0a76,0x34a11cf935dff665,0x34f0134b35db7f6e,0x34a69b6335dfb60c,0x34f8256135daefa2,0x34ac183135df738b,0x3500190b35da5b18
.quad 0x35e38e39,0x35e38e39,0x32b2b79c35e389d6,0x32df64b535e3875e,0x3332b42a35e37cad,0x335f5dfa35e372cf,0x338602d135e366c0,0x33a77e1335e3508c,0x33b2a66335e3480d,0x33df431235e32098,0x33df431235e32098,0x340b7d4f35e2e2f5,0x3405eb9235e2f061,0x342750ae35e297a8,0x341c307235e2b76b,0x344319f835e23eb4
.quad 0x34326f4c35e275b6,0x345ed78235e1d820,0x3448a74635e22b47,0x347a87a035e163f0,0x345ed78235e1d820,0x348b145335e0e22d,0x3474ff2835e17c43,0x3498dc7635e052de,0x34858eae35e117b5,0x34a69b6335dfb60c,0x349098a135e0aa7a,0x34b4504635df0bbf,0x349b9d0235e03495,0x34c1fa4e35de5404,0x34a69b6335dfb60c,0x34cf98a635dd8ee3
.quad 0x34b1935735df2ee2,0x34dd2a7c35dcbc6b,0x34bc847335de9f1e,0x34eaaf0035dbdca6,0x34c76e4a35de06c5,0x34f8256135daefa2,0x34d2507135dd65dc,0x3502c66835d9f56f,0x34dd2a7c35dcbc6b,0x3509723e35d8ee1a,0x34e7fc0135dc0a76,0x351015cd35d7d9b4,0x34f2c49435db5006,0x3516b0ae35d6b84e,0x34fd83cb35da8d22,0x351d427b35d589f8
.quad 0x35041c9e35d9c1d1,0x3523cad035d44ec5,0x3509723e35d8ee1a,0x352a494635d306c8,0x350ec29235d81207,0x3530bd7a35d1b215,0x35140d6535d72d9f,0x3537270935d050c1,0x3519528335d640eb,0x353d858f35cee2e0,0x351e91b835d54bf5,0x3543d8ab35cd6888,0x3523cad035d44ec5,0x354a1ffb35cbe1d1,0x3528fd9735d34966,0x35505b1e35ca4ed2
.quad 0x35e38e39,0x35e38e39,0x330608a235e3845a,0x331c5e9635e380ca,0x338602d135e366c0,0x339c555b35e3587f,0x33c8f5b235e3356b,0x33ea68f635e3155d,0x3405eb9235e2f061,0x341c307235e2b76b,0x342750ae35e297a8,0x344319f835e23eb4,0x3448a74635e22b47,0x3469ec7635e1ab48,0x3469ec7635e1ab48,0x348851aa35e0fd37
.quad 0x34858eae35e117b5,0x349b9d0235e03495,0x34961b8b35e0709c,0x34aed5fa35df517b,0x34a69b6335dfb60c,0x34c1fa4e35de5404,0x34b70cc735dee813,0x34d507bb35dd3c4c,0x34c76e4a35de06c5,0x34e7fc0135dc0a76,0x34d7be8135dd1234,0x34fad4e335dabea6,0x34e7fc0135dc0a76,0x3506c81435d95902,0x34f8256135daefa2,0x351015cd35d7d9b4
.quad 0x35041c9e35d9c1d1,0x3519528335d640eb,0x350c1b1535d8811b,0x35227d1f35d48ed6,0x35140d6535d72d9f,0x352b948c35d2c3a8,0x351bf2de35d5c777,0x353497b735d0df99,0x3523cad035d44ec5,0x353d858f35cee2e0,0x352b948c35d2c3a8,0x35465d0835cccdba,0x35334f6635d12643,0x354f1d1535caa066,0x353afab335cf76ba,0x3557c4ae35c85b26
.quad 0x354295c735cdb531,0x356052cd35c5fe3e,0x354a1ffb35cbe1d1,0x3568c67135c389f6,0x355198a635c9fcc1,0x35711e9935c0fe97,0x3558ff2335c8062c,0x35795a4935be5c70,0x356052cd35c5fe3e,0x3580bc4435bba3cf,0x3567930235c3e522,0x3584bc3135b8d507,0x356ebf2135c1bb09,0x3588ac7235b5f06c,0x3575d68a35bf8021,0x358c8c9035b2f656
.quad 0x35e38e39,0x35e38e39,0x3332b42a35e37cad,0x3349095035e37804,0x33b2a66335e3480d,0x33c8f5b235e3356b,0x3405eb9235e2f061,0x34169fc235e2c67a,0x34326f4c35e275b6,0x3448a74635e22b47,0x345ed78235e1d820,0x347a87a035e163f0,0x34858eae35e117b5,0x34961b8b35e0709c,0x349b9d0235e03495,0x34aed5fa35df517b
.quad 0x34b1935735df2ee2,0x34c76e4a35de06c5,0x34c76e4a35de06c5,0x34dfdfae35dc90b9,0x34dd2a7c35dcbc6b,0x34f8256135daefa2,0x34f2c49435db5006,0x35081d5335d923d1,0x35041c9e35d9c1d1,0x35140d6535d72d9f,0x350ec29235d81207,0x351fe09335d50d6e,0x3519528335d640eb,0x352b948c35d2c3a8,0x3523cad035d44ec5,0x3537270935d050c1
.quad 0x352e29da35d23be2,0x354295c735cdb531,0x35386e0935d00894,0x354dde8c35caf17d,0x354295c735cdb531,0x3558ff2335c8062c,0x354c9f8435cb4216,0x3563f56035c4f3d3,0x355689b335c8afa3,0x356ebf2135c1bb09,0x356052cd35c5fe3e,0x35795a4935be5c70,0x3569f95035c32e50,0x3581e26335bad8b0,0x35737bbe35c0404a,0x3586fe4935b73079
.quad 0x357cd8a035bd349e,0x358bffd635b36482,0x3583074235ba0bc4,0x3590e61135af7588,0x35878e0035b6c63b,0x3595b00435ab6450,0x358bffd635b36482,0x359a5cc135a731a4,0x35905c1635afe71f,0x359eeb5d35a2de58,0x3594a21335ac4e9d,0x35a35af6359e6b42,0x3598d12535a89b88,0x35a7aaad3599d941,0x359ce8a635a4ce73,0x35abd9ab3595293a
.quad 0x35e38e39,0x35e38e39,0x335f5dfa35e372cf,0x3375b21a35e36d0d,0x33df431235e32098,0x33f58e4a35e30995,0x342750ae35e297a8,0x3437fdf835e263ec,0x345ed78235e1d820,0x3474ff2835e17c43,0x348b145335e0e22d,0x3498dc7635e052de,0x34a69b6335dfb60c,0x34b70cc735dee813,0x34c1fa4e35de5404,0x34d507bb35dd3c4c
.quad 0x34dd2a7c35dcbc6b,0x34f2c49435db5006,0x34f8256135daefa2,0x35081d5335d923d1,0x3509723e35d8ee1a,0x3516b0ae35d6b84e,0x3516b0ae35d6b84e,0x3525181b35d40e31,0x3523cad035d44ec5,0x35334f6635d12643,0x3530bd7a35d1b215,0x3541526b35ce015c,0x353d858f35cee2e0,0x354f1d1535caa066,0x354a1ffb35cbe1d1,0x355cab5d35c7045d
.quad 0x355689b335c8afa3,0x3569f95035c32e50,0x3562bfbb35c54d1b,0x3577030d35bf1f5c,0x356ebf2135c1bb09,0x3581e26335bad8b0,0x357a850135bdfa4a,0x35881d6335b65b8c,0x3583074235ba0bc4,0x358e30b435b1a93d,0x3588ac7235b5f06c,0x35941a9135acc324,0x358e30b435b1a93d,0x3599d94135a7aaad,0x359392b435ad3741,0x359f6b1735a26155
.quad 0x3598d12535a89b88,0x35a4ce73359ce8a6,0x359deac535a3d730,0x35aa01c435974239,0x35a2de58359eeb5d,0x35af038435916fb3,0x35a7aaad3599d941,0x35b3d23f358b72c6,0x35ac4e9d3594a213,0x35b86c8e35854d33,0x35b0c909358f4716,0x35bcd118357e0186,0x35b518dc3589c993,0x35c0fe9735711e99,0x35b93d0e35842ade,0x35c4f3d33563f560
.quad 0x35e38e39,0x35e38e39,0x338602d135e366c0,0x33912c4335e35fe5,0x3405eb9235e2f061,0x34110eb535e2d4fe,0x3448a74635e22b47,0x34594c3935e1edbb,0x34858eae35e117b5,0x349098a135e0aa7a,0x34a69b6335dfb60c,0x34b4504635df0bbf,0x34c76e4a35de06c5,0x34d7be8135dd1234,0x34e7fc0135dc0a76,0x34fad4e335dabea6
.quad 0x35041c9e35d9c1d1,0x350ec29235d81207,0x35140d6535d72d9f,0x351fe09335d50d6e,0x3523cad035d44ec5,0x3530bd7a35d1b215,0x35334f6635d12643,0x3541526b35ce015c,0x354295c735cdb531,0x355198a635c9fcc1,0x355198a635c9fcc1,0x3561898a35c5a5e9,0x356052cd35c5fe3e,0x35711e9935c0fe97,0x356ebf2135c1bb09,0x358028bd35bc08b1
.quad 0x357cd8a035bd349e,0x35878e0035b6c63b,0x35854d3335b86c8e,0x358ebc1135b1395a,0x358bffd635b36482,0x3595b00435ab6450,0x359281e835ae1e39,0x359c670535a5497d,0x3598d12535a89b88,0x35a2de58359eeb5d,0x359eeb5d35a2de58,0x35a9135a35984c89,0x35a4ce73359ce8a6,0x35af038435916fb3,0x35aa785c3596bc84,0x35b4ac6d358a57a4
.quad 0x35afe71f35905c16,0x35ba0bc435830742,0x35b518dc3589c993,0x35bf1f5c3577030d,0x35ba0bc435830742,0x35c3e52235679302,0x35bebe2135782ef7,0x35c85b263557c4ae,0x35c32e503569f950,0x35cc7f9535479e7f,0x35c75ac8355b727b,0x35d050c135372709,0x35cb4216354c9f84,0x35d3cd1b35266500,0x35cee2e0353d858f,0x35d6f33835155f38
.quad 0x35e38e39,0x35e38e39,0x339c555b35e3587f,0x33a77e1335e3508c,0x341c307235e2b76b,0x342750ae35e297a8,0x3469ec7635e1ab48,0x347a87a035e163f0,0x349b9d0235e03495,0x34a69b6335dfb60c,0x34c1fa4e35de5404,0x34cf98a635dd8ee3,0x34e7fc0135dc0a76,0x34f8256135daefa2,0x3506c81435d95902,0x351015cd35d7d9b4
.quad 0x3519528335d640eb,0x3523cad035d44ec5,0x352b948c35d2c3a8,0x3537270935d050c1,0x353d858f35cee2e0,0x354a1ffb35cbe1d1,0x354f1d1535caa066,0x355cab5d35c7045d,0x356052cd35c5fe3e,0x356ebf2135c1bb09,0x35711e9935c0fe97,0x358028bd35bc08b1,0x3580bc4435bba3cf,0x3588ac7235b5f06c,0x3588ac7235b5f06c,0x3590e61135af7588
.quad 0x35905c1635afe71f,0x3598d12535a89b88,0x3597c79035a98ac3,0x35a0696335a16623,0x359eeb5d35a2de58,0x35a7aaad3599d941,0x35a5c420359be504,0x35ae91153591f8fa,0x35ac4e9d3594a213,0x35b518dc3589c993,0x35b287bc358d18f3,0x35bb3e7935814f7c,0x35b86c8e35854d33,0x35c0fe9735711e99,0x35bdfa4a357a8501,0x35c65618355f1b86
.quad 0x35c32e503569f950,0x35cb4216354c9f84,0x35c8062c3558ff23,0x35cfbfe73539b497,0x35cc7f9535479e7f,0x35d3cd1b35266500,0x35d0986d3535df98,0x35d767803512bb38,0x35d44ec53523cad0,0x35da8d2234fd83cb,0x35d7a0dd351168af,0x35dd3c4c34d507bb,0x35da8d2234fd83cb,0x35df738b34ac1831,0x35dd123434d7be81,0x35e131a93482cb5f
.quad 0x35e38e39,0x34326f4c35e275b6,0x35e38e39,0x3437fdf835e263ec,0x35e38e39,0x343d8c3335e25196,0x35e38e39,0x344319f835e23eb4,0x35e38e39,0x3448a74635e22b47,0x35e38e39,0x344e341735e2174e,0x35e38e39,0x3453c06935e202ca,0x35e38e39,0x34594c3935e1edbb
.quad 0x35e38e39,0x345ed78235e1d820,0x35e38e39,0x3464624335e1c1f9,0x35e38e39,0x3469ec7635e1ab48,0x35e38e39,0x346f761935e1940b,0x35e38e39,0x3474ff2835e17c43,0x35e38e39,0x347a87a035e163f0,0x35e38e39,0x348007bf35e14b12,0x35e38e39,0x3482cb5f35e131a9
.quad 0x35e38e39,0x34858eae35e117b5,0x35e38e39,0x348851aa35e0fd37,0x35e38e39,0x348b145335e0e22d,0x35e38e39,0x348dd6a635e0c699,0x35e38e39,0x349098a135e0aa7a,0x35e38e39,0x34935a4435e08dd0,0x35e38e39,0x34961b8b35e0709c,0x35e38e39,0x3498dc7635e052de
.quad 0x35e38e39,0x349b9d0235e03495,0x35e38e39,0x349e5d2e35e015c2,0x35e38e39,0x34a11cf935dff665,0x35e38e39,0x34a3dc6035dfd67d,0x35e38e39,0x34a69b6335dfb60c,0x35e38e39,0x34a959fe35df9510,0x35e38e39,0x34ac183135df738b,0x35e38e39,0x34aed5fa35df517b
.quad 0x34b1935735df2ee2,0x35041c9e35d9c1d1,0x34b70cc735dee813,0x35081d5335d923d1,0x34bc847335de9f1e,0x350c1b1535d8811b,0x34c1fa4e35de5404,0x351015cd35d7d9b4,0x34c76e4a35de06c5,0x35140d6535d72d9f,0x34cce05a35ddb762,0x351801c835d67cde,0x34d2507135dd65dc,0x351bf2de35d5c777,0x34d7be8135dd1234,0x351fe09335d50d6e
.quad 0x34dd2a7c35dcbc6b,0x3523cad035d44ec5,0x34e2945635dc6480,0x3527b17f35d38b82,0x34e7fc0135dc0a76,0x352b948c35d2c3a8,0x34ed616f35dbae4d,0x352f73e035d1f73d,0x34f2c49435db5006,0x35334f6635d12643,0x34f8256135daefa2,0x3537270935d050c1,0x34fd83cb35da8d22,0x353afab335cf76ba,0x35016fe135da2886,0x353eca4f35ce9833
.quad 0x35041c9e35d9c1d1,0x354295c735cdb531,0x3506c81435d95902,0x35465d0835cccdba,0x3509723e35d8ee1a,0x354a1ffb35cbe1d1,0x350c1b1535d8811b,0x354dde8c35caf17d,0x350ec29235d81207,0x355198a635c9fcc1,0x351168af35d7a0dd,0x35554e3535c903a5,0x35140d6535d72d9f,0x3558ff2335c8062c,0x3516b0ae35d6b84e,0x355cab5d35c7045d
.quad 0x3519528335d640eb,0x356052cd35c5fe3e,0x351bf2de35d5c777,0x3563f56035c4f3d3,0x351e91b835d54bf5,0x3567930235c3e522,0x35212f0b35d4ce63,0x356b2b9e35c2d232,0x3523cad035d44ec5,0x356ebf2135c1bb09,0x3526650035d3cd1b,0x35724d7635c09fac,0x3528fd9735d34966,0x3575d68a35bf8021,0x352b948c35d2c3a8,0x35795a4935be5c70
.quad 0x352e29da35d23be2,0x355689b335c8afa3,0x35334f6635d12643,0x355cab5d35c7045d,0x35386e0935d00894,0x3562bfbb35c54d1b,0x353d858f35cee2e0,0x3568c67135c389f6,0x354295c735cdb531,0x356ebf2135c1bb09,0x35479e7f35cc7f95,0x3574a96f35bfe071,0x354c9f8435cb4216,0x357a850135bdfa4a,0x355198a635c9fcc1,0x358028bd35bc08b1
.quad 0x355689b335c8afa3,0x3583074235ba0bc4,0x355b727b35c75ac8,0x3585dde235b803a3,0x356052cd35c5fe3e,0x3588ac7235b5f06c,0x35652a7935c49a11,0x358b72c635b3d23f,0x3569f95035c32e50,0x358e30b435b1a93d,0x356ebf2135c1bb09,0x3590e61135af7588,0x35737bbe35c0404a,0x359392b435ad3741,0x35782ef735bebe21,0x3596367335aaee8a
.quad 0x357cd8a035bd349e,0x3598d12535a89b88,0x3580bc4435bba3cf,0x359b62a335a63e5e,0x3583074235ba0bc4,0x359deac535a3d730,0x35854d3335b86c8e,0x35a0696335a16623,0x35878e0035b6c63b,0x35a2de58359eeb5d,0x3589c99335b518dc,0x35a5497d359c6705,0x358bffd635b36482,0x35a7aaad3599d941,0x358e30b435b1a93d,0x35aa01c435974239
.quad 0x35905c1635afe71f,0x35ac4e9d3594a213,0x359281e835ae1e39,0x35ae91153591f8fa,0x3594a21335ac4e9d,0x35b0c909358f4716,0x3596bc8435aa785c,0x35b2f656358c8c90,0x3598d12535a89b88,0x35b518dc3589c993,0x359adfe235a6b834,0x35b730793586fe49,0x359ce8a635a4ce73,0x35b93d0e35842ade,0x359eeb5d35a2de58,0x35bb3e7935814f7c
.quad 0x357cd8a035bd349e,0x35905c1635afe71f,0x3581e26335bad8b0,0x35941a9135acc324,0x35854d3335b86c8e,0x3597c79035a98ac3,0x3588ac7235b5f06c,0x359b62a335a63e5e,0x358bffd635b36482,0x359eeb5d35a2de58,0x358f471635b0c909,0x35a26155359f6b17,0x359281e835ae1e39,0x35a5c420359be504,0x3595b00435ab6450,0x35a9135a35984c89
.quad 0x3598d12535a89b88,0x35ac4e9d3594a213,0x359be50435a5c420,0x35af75883590e611,0x359eeb5d35a2de58,0x35b287bc358d18f3,0x35a1e3ee359fea6e,0x35b584dc35893b2d,0x35a4ce73359ce8a6,0x35b86c8e35854d33,0x35a7aaad3599d941,0x35bb3e7935814f7c,0x35aa785c3596bc84,0x35bdfa4a357a8501,0x35ad3741359392b4,0x35c09fac35724d76
.quad 0x35afe71f35905c16,0x35c32e503569f950,0x35b287bc358d18f3,0x35c5a5e93561898a,0x35b518dc3589c993,0x35c8062c3558ff23,0x35b79a4735866e3f,0x35ca4ed235505b1e,0x35ba0bc435830742,0x35cc7f9535479e7f,0x35bc6d1f357f29cf,0x35ce9833353eca4f,0x35bebe2135782ef7,0x35d0986d3535df98,0x35c0fe9735711e99,0x35d28006352cdf68
.quad 0x35c32e503569f950,0x35d44ec53523cad0,0x35c54d1b3562bfbb,0x35d60473351aa2e0,0x35c75ac8355b727b,0x35d7a0dd351168af,0x35c9572b35541232,0x35d923d135081d53,0x35cb4216354c9f84,0x35da8d2234fd83cb,0x35cd1b6035451b16,0x35dbdca634eaaf00,0x35cee2e0353d858f,0x35dd123434d7be81,0x35d0986d3535df98,0x35de2da934c4b489
.quad 0x35a0e7f535a0e7f5,0x35afe71f35905c16,0x35a4ce73359ce8a6,0x35b3d23f358b72c6,0x35a89b883598d125,0x35b79a4735866e3f,0x35ac4e9d3594a213,0x35bb3e7935814f7c,0x35afe71f35905c16,0x35bebe2135782ef7,0x35b36482358bffd6,0x35c2188e356d8e88,0x35b6c63b35878e00,0x35c54d1b3562bfbb,0x35ba0bc435830742,0x35c85b263557c4ae
.quad 0x35bd349e357cd8a0,0x35cb4216354c9f84,0x35c0404a35737bbe,0x35ce015c3541526b,0x35c32e503569f950,0x35d0986d3535df98,0x35c5fe3e356052cd,0x35d306c8352a4946,0x35c8afa3355689b3,0x35d54bf5351e91b8,0x35cb4216354c9f84,0x35d767803512bb38,0x35cdb531354295c7,0x35d959023506c814,0x35d0089435386e09,0x35db201834f57546
.quad 0x35d23be2352e29da,0x35dcbc6b34dd2a7c,0x35d44ec53523cad0,0x35de2da934c4b489,0x35d640eb35195283,0x35df738b34ac1831,0x35d81207350ec292,0x35e08dd034935a44,0x35d9c1d135041c9e,0x35e17c433474ff28,0x35db500634f2c494,0x35e23eb4344319f8,0x35dcbc6b34dd2a7c,0x35e2d4fe34110eb5,0x35de06c534c76e4a,0x35e33f0233bdce45
.quad 0x35df2ee234b19357,0x35e37cad3332b42a,0x35e03495349b9d02,0x35e38df3b1b2b8b0,0x35e117b534858eae,0x35e372cfb35f5dfa,0x35e1d820345ed782,0x35e32b48b3d41ca3,0x35e275b634326f4c,0x35e2b76bb41c3072,0x35e2f0613405eb92,0x35e2174eb44e3417,0x35e3480d33b2a663,0x35e14b12b48007bf,0x35e37cad3332b42a,0x35e052deb498dc76
.quad 0x35bd349e357cd8a0,0x35c8afa3355689b3,0x35c0fe9735711e99,0x35cc30f23548df7b,0x35c49a1135652a79,0x35cf76ba353afab3,0x35c8062c3558ff23,0x35d28006352cdf68,0x35cb4216354c9f84,0x35d54bf5351e91b8,0x35ce4d0735400e98,0x35d7d9b4351015cd,0x35d1264335334f66,0x35da288635016fe1,0x35d3cd1b35266500,0x35dc37bf34e54872
.quad 0x35d640eb35195283,0x35de06c534c76e4a,0x35d8811b350c1b15,0x35df951034a959fe,0x35da8d2234fd83cb,0x35e0e22d348b1453,0x35dc648034e29456,0x35e1edbb34594c39,0x35de06c534c76e4a,0x35e2b76b341c3072,0x35df738b34ac1831,0x35e33f0233bdce45,0x35e0aa7a349098a1,0x35e3845a330608a2,0x35e1ab483469ec76,0x35e3875eb2df64b5
.quad 0x35e275b634326f4c,0x35e3480db3b2a663,0x35e3099533f58e4a,0x35e2c67ab4169fc2,0x35e366c0338602d1,0x35e202cab453c069,0x35e38d203232b879,0x35e0fd37b48851aa,0x35e37cadb332b42a,0x35dfb60cb4a69b63,0x35e3356bb3c8f5b2,0x35de2da9b4c4b489,0x35e2b76bb41c3072,0x35dc6480b4e29456,0x35e202cab453c069,0x35da5b18b500190b
.quad 0x35e117b5b4858eae,0x35d81207b50ec292,0x35dff665b4a11cf9,0x35d589f8b51d427b,0x35de9f1eb4bc8473,0x35d2c3a8b52b948c,0x35dd1234b4d7be81,0x35cfbfe7b539b497,0x35db5006b4f2c494,0x35cc7f95b5479e7f,0x35d95902b506c814,0x35c903a5b5554e35,0x35d72d9fb5140d65,0x35c54d1bb562bfbb,0x35d4ce63b5212f0b,0x35c15d0cb56fef27
.quad 0x35d23be2352e29da,0x35d9c1d135041c9e,0x35d54bf5351e91b8,0x35dc37bf34e54872,0x35d81207350ec292,0x35de540434c1fa4e,0x35da8d2234fd83cb,0x35e015c2349e5d2e,0x35dcbc6b34dd2a7c,0x35e17c433474ff28,0x35de9f1e34bc8473,0x35e286f5342ce032,0x35e03495349b9d02,0x35e3356b33c8f5b2,0x35e17c433474ff28,0x35e3875e32df64b5
.quad 0x35e275b634326f4c,0x35e37cadb332b42a,0x35e3209833df4312,0x35e3155db3ea68f6,0x35e37cad3332b42a,0x35e25196b43d8c33,0x35e389d6b2b2b79c,0x35e131a9b482cb5f,0x35e3480db3b2a663,0x35dfb60cb4a69b63,0x35e2b76bb41c3072,0x35dddf58b4ca2791,0x35e1d820b45ed782,0x35dbae4db4ed616f,0x35e0aa7ab49098a1,0x35d923d1b5081d53
.quad 0x35df2ee2b4b19357,0x35d640ebb5195283,0x35dd65dcb4d25071,0x35d306c8b52a4946,0x35db5006b4f2c494,0x35cf76bab53afab3,0x35d8ee1ab509723e,0x35cb9232b54b5ffe,0x35d640ebb5195283,0x35c75ac8b55b727b,0x35d34966b528fd97,0x35c2d232b56b2b9e,0x35d00894b5386e09,0x35bdfa4ab57a8501,0x35cc7f95b5479e7f,0x35b8d507b584bc31
.quad 0x35c8afa3b55689b3,0x35b36482b58bffd6,0x35c49a11b5652a79,0x35adaaf3b5930a7b,0x35c0404ab5737bbe,0x35a7aaadb599d941,0x35bba3cfb580bc44,0x35a16623b5a06963,0x35b6c63bb5878e00,0x359adfe2b5a6b834,0x35b1a93db58e30b4,0x35941a91b5acc324,0x35ac4e9db594a213,0x358d18f3b5b287bc,0x35a6b834b59adfe2,0x3585dde2b5b803a3
.quad 0x35df2ee234b19357,0x35e275b634326f4c,0x35e0e22d348b1453,0x35e33f0233bdce45,0x35e22b473448a746,0x35e38d203232b879,0x35e3099533f58e4a,0x35e35fe5b3912c43,0x35e37cad3332b42a,0x35e2b76bb41c3072,0x35e3845ab30608a2,0x35e1940bb46f7619,0x35e32098b3df4312,0x35dff665b4a11cf9,0x35e25196b43d8c33,0x35dddf58b4ca2791
.quad 0x35e117b5b4858eae,0x35db5006b4f2c494,0x35df738bb4ac1831,0x35d849d4b50d6eff,0x35dd65dcb4d25071,0x35d4ce63b5212f0b,0x35daefa2b4f82561,0x35d0df99b53497b7,0x35d81207b50ec292,0x35cc7f95b5479e7f,0x35d4ce63b5212f0b,0x35c7b0b8b55a3912,0x35d12643b5334f66,0x35c2759cb56c5d5c,0x35cd1b60b5451b16,0x35bcd118b57e0186
.quad 0x35c8afa3b55689b3,0x35b6c63bb5878e00,0x35c3e522b5679302,0x35b0584ab58fd1c3,0x35bebe21b5782ef7,0x35a98ac3b597c790,0x35b93d0eb5842ade,0x35a26155b59f6b17,0x35b36482b58bffd6,0x359adfe2b5a6b834,0x35ad3741b59392b4,0x35930a7bb5adaaf3,0x35a6b834b59adfe2,0x358ae560b5b43f8d,0x359fea6eb5a1e3ee,0x358274fbb5ba7274
.quad 0x3598d125b5a89b88,0x35737bbeb5c0404a,0x35916fb3b5af0384,0x3561898ab5c5a5e9,0x3589c993b5b518dc,0x354f1d15b5caa066,0x3581e263b5bad8b0,0x353c405bb5cf2d0d,0x35737bbeb5c0404a,0x3528fd97b5d34966,0x3562bfbbb5c54d1b,0x35155f38b5d6f338,0x355198a6b5c9fcc1,0x35016fe1b5da2886,0x35400e98b5ce4d07,0x34da74c2b5dce793
.quad 0x35e38e39,0x35e38e39,0x33b2a66335e3480d,0x33bdce4535e33f02,0x34326f4c35e275b6,0x343d8c3335e25196,0x34858eae35e117b5,0x348dd6a635e0c699,0x34b1935735df2ee2,0x34bc847335de9f1e,0x34dd2a7c35dcbc6b,0x34eaaf0035dbdca6,0x35041c9e35d9c1d1,0x350c1b1535d8811b,0x3519528335d640eb,0x35227d1f35d48ed6
.quad 0x352e29da35d23be2,0x35386e0935d00894,0x354295c735cdb531,0x354dde8c35caf17d,0x355689b335c8afa3,0x3562bfbb35c54d1b,0x3569f95035c32e50,0x3577030d35bf1f5c,0x357cd8a035bd349e,0x35854d3335b86c8e,0x35878e0035b6c63b,0x358ebc1135b1395a,0x35905c1635afe71f,0x3597c79035a98ac3,0x3598d12535a89b88,0x35a0696335a16623
.quad 0x35a0e7f535a0e7f5,0x35a89b883598d125,0x35a89b883598d125,0x35b0584a358fd1c3,0x35afe71f35905c16,0x35b79a4735866e3f,0x35b6c63b35878e00,0x35be5c7035795a49,0x35bd349e357cd8a0,0x35c49a1135652a79,0x35c32e503569f950,0x35ca4ed235505b1e,0x35c8afa3355689b3,0x35cf76ba353afab3,0x35cdb531354295c7,0x35d40e313525181b
.quad 0x35d23be2352e29da,0x35d81207350ec292,0x35d640eb35195283,0x35db7f6e34f0134b,0x35d9c1d135041c9e,0x35de540434c1fa4e,0x35dcbc6b34dd2a7c,0x35e08dd034935a44,0x35df2ee234b19357,0x35e22b473448a746,0x35e117b534858eae,0x35e32b4833d41ca3,0x35e275b634326f4c,0x35e38d203232b879,0x35e3480d33b2a663,0x35e3508cb3a77e13
.quad 0x35e38e39,0x35e38e39,0x33c8f5b235e3356b,0x33d41ca335e32b48,0x3448a74635e22b47,0x3453c06935e202ca,0x34961b8b35e0709c,0x349e5d2e35e015c2,0x34c76e4a35de06c5,0x34d2507135dd65dc,0x34f8256135daefa2,0x3502c66835d9f56f,0x35140d6535d72d9f,0x351bf2de35d5c777,0x352b948c35d2c3a8,0x353497b735d0df99
.quad 0x354295c735cdb531,0x354c9f8435cb4216,0x3558ff2335c8062c,0x3563f56035c4f3d3,0x356ebf2135c1bb09,0x357a850135bdfa4a,0x3581e26335bad8b0,0x35881d6335b65b8c,0x358bffd635b36482,0x359281e835ae1e39,0x3595b00435ab6450,0x359c670535a5497d,0x359eeb5d35a2de58,0x35a5c420359be504,0x35a7aaad3599d941,0x35ae91153591f8fa
.quad 0x35afe71f35905c16,0x35b6c63b35878e00,0x35b79a4735866e3f,0x35be5c7035795a49,0x35bebe2135782ef7,0x35c54d1b3562bfbb,0x35c54d1b3562bfbb,0x35cb9232354b5ffe,0x35cb4216354c9f84,0x35d1264335334f66,0x35d0986d3535df98,0x35d60473351aa2e0,0x35d54bf5351e91b8,0x35da288635016fe1,0x35d959023506c814,0x35dd8ee334cf98a6
.quad 0x35dcbc6b34dd2a7c,0x35e03495349b9d02,0x35df738b34ac1831,0x35e2174e344e3417,0x35e17c433474ff28,0x35e3356b33c8f5b2,0x35e2d4fe34110eb5,0x35e38df3b1b2b8b0,0x35e37cad3332b42a,0x35e32098b3df4312,0x35e372cfb35f5dfa,0x35e1edbbb4594c39,0x35e2b76bb41c3072,0x35dff665b4a11cf9,0x35e14b12b48007bf,0x35dd3c4cb4d507bb
.quad 0x35e38e39,0x35e38e39,0x33df431235e32098,0x33ea68f635e3155d,0x345ed78235e1d820,0x3469ec7635e1ab48,0x34a69b6335dfb60c,0x34aed5fa35df517b,0x34dd2a7c35dcbc6b,0x34e7fc0135dc0a76,0x3509723e35d8ee1a,0x351015cd35d7d9b4,0x3523cad035d44ec5,0x352b948c35d2c3a8,0x353d858f35cee2e0,0x35465d0835cccdba
.quad 0x355689b335c8afa3,0x356052cd35c5fe3e,0x356ebf2135c1bb09,0x35795a4935be5c70,0x3583074235ba0bc4,0x3588ac7235b5f06c,0x358e30b435b1a93d,0x35941a9135acc324,0x3598d12535a89b88,0x359eeb5d35a2de58,0x35a2de58359eeb5d,0x35a9135a35984c89,0x35ac4e9d3594a213,0x35b287bc358d18f3,0x35b518dc3589c993,0x35bb3e7935814f7c
.quad 0x35bd349e357cd8a0,0x35c32e503569f950,0x35c49a1135652a79,0x35ca4ed235505b1e,0x35cb4216354c9f84,0x35d0986d3535df98,0x35d1264335334f66,0x35d60473351aa2e0,0x35d640eb35195283,0x35da8d2234fd83cb,0x35da8d2234fd83cb,0x35de2da934c4b489,0x35de06c534c76e4a,0x35e0e22d348b1453,0x35e0aa7a349098a1,0x35e2a7cf3421c0c2
.quad 0x35e275b634326f4c,0x35e37cad3332b42a,0x35e366c0338602d1,0x35e35fe5b3912c43,0x35e37cadb332b42a,0x35e25196b43d8c33,0x35e2b76bb41c3072,0x35e052deb498dc76,0x35e117b5b4858eae,0x35dd65dcb4d25071,0x35de9f1eb4bc8473,0x35d98dacb5057282,0x35db5006b4f2c494,0x35d4ce63b5212f0b,0x35d72d9fb5140d65,0x35cf2d0db53c405b
.quad 0x35e38e39,0x35e38e39,0x33f58e4a35e30995,0x3400598335e2fd41,0x3474ff2835e17c43,0x348007bf35e14b12,0x34b70cc735dee813,0x34bf3f9b35de79d6,0x34f2c49435db5006,0x34fd83cb35da8d22,0x3516b0ae35d6b84e,0x351d427b35d589f8,0x35334f6635d12643,0x353afab335cf76ba,0x354f1d1535caa066,0x3557c4ae35c85b26
.quad 0x3569f95035c32e50,0x35737bbe35c0404a,0x3581e26335bad8b0,0x3586fe4935b73079,0x358e30b435b1a93d,0x359392b435ad3741,0x3599d94135a7aaad,0x359f6b1735a26155,0x35a4ce73359ce8a6,0x35aa785c3596bc84,0x35af038435916fb3,0x35b4ac6d358a57a4,0x35b86c8e35854d33,0x35bdfa4a357a8501,0x35c0fe9735711e99,0x35c65618355f1b86
.quad 0x35c8afa3355689b3,0x35cdb531354295c7,0x35cf76ba353afab3,0x35d40e313525181b,0x35d54bf5351e91b8,0x35d959023506c814,0x35da288635016fe1,0x35dd8ee334cf98a6,0x35de06c534c76e4a,0x35e0aa7a349098a1,0x35e0e22d348b1453,0x35e2a7cf3421c0c2,0x35e2b76b341c3072,0x35e3845a330608a2,0x35e3845a330608a2,0x35e33f02b3bdce45
.quad 0x35e3480db3b2a663,0x35e1d820b45ed782,0x35e202cab453c069,0x35df517bb4aed5fa,0x35dfb60cb4a69b63,0x35dbae4db4ed616f,0x35dc6480b4e29456,0x35d6f338b5155f38,0x35d81207b50ec292,0x35d12643b5334f66,0x35d2c3a8b52b948c,0x35ca4ed2b5505b1e,0x35cc7f95b5479e7f,0x35c2759cb56c5d5c,0x35c54d1bb562bfbb,0x35b9a4a2b5839938
.quad 0x35e38e39,0x35e38e39,0x3405eb9235e2f061,0x340b7d4f35e2e2f5,0x34858eae35e117b5,0x348b145335e0e22d,0x34c76e4a35de06c5,0x34cf98a635dd8ee3,0x35041c9e35d9c1d1,0x3509723e35d8ee1a,0x3523cad035d44ec5,0x352a494635d306c8,0x354295c735cdb531,0x354a1ffb35cbe1d1,0x356052cd35c5fe3e,0x3568c67135c389f6
.quad 0x357cd8a035bd349e,0x3583074235ba0bc4,0x358bffd635b36482,0x3590e61135af7588,0x3598d12535a89b88,0x359deac535a3d730,0x35a4ce73359ce8a6,0x35aa01c435974239,0x35afe71f35905c16,0x35b518dc3589c993,0x35ba0bc435830742,0x35bf1f5c3577030d,0x35c32e503569f950,0x35c8062c3558ff23,0x35cb4216354c9f84,0x35cfbfe73539b497
.quad 0x35d23be2352e29da,0x35d640eb35195283,0x35d81207350ec292,0x35db7f6e34f0134b,0x35dcbc6b34dd2a7c,0x35df738b34ac1831,0x35e03495349b9d02,0x35e2174e344e3417,0x35e275b634326f4c,0x35e366c0338602d1,0x35e37cad3332b42a,0x35e35fe5b3912c43,0x35e3480db3b2a663,0x35e202cab453c069,0x35e1d820b45ed782,0x35df517bb4aed5fa
.quad 0x35df2ee2b4b19357,0x35db5006b4f2c494,0x35db5006b4f2c494,0x35d60473b51aa2e0,0x35d640ebb5195283,0x35cf76bab53afab3,0x35d00894b5386e09,0x35c7b0b8b55a3912,0x35c8afa3b55689b3,0x35bebe21b5782ef7,0x35c0404ab5737bbe,0x35b4ac6db58a57a4,0x35b6c63bb5878e00,0x35a98ac3b597c790,0x35ac4e9db594a213,0x359d69e6b5a45304
.quad 0x35e38e39,0x35e38e39,0x34110eb535e2d4fe,0x34169fc235e2c67a,0x349098a135e0aa7a,0x34961b8b35e0709c,0x34d7be8135dd1234,0x34dfdfae35dc90b9,0x350ec29235d81207,0x35140d6535d72d9f,0x3530bd7a35d1b215,0x3537270935d050c1,0x355198a635c9fcc1,0x3558ff2335c8062c,0x35711e9935c0fe97,0x35795a4935be5c70
.quad 0x35878e0035b6c63b,0x358bffd635b36482,0x3595b00435ab6450,0x359a5cc135a731a4,0x35a2de58359eeb5d,0x35a7aaad3599d941,0x35af038435916fb3,0x35b3d23f358b72c6,0x35ba0bc435830742,0x35bebe2135782ef7,0x35c3e52235679302,0x35c85b263557c4ae,0x35cc7f9535479e7f,0x35d0986d3535df98,0x35d3cd1b35266500,0x35d767803512bb38
.quad 0x35d9c1d135041c9e,0x35dcbc6b34dd2a7c,0x35de540434c1fa4e,0x35e08dd034935a44,0x35e17c433474ff28,0x35e2d4fe34110eb5,0x35e3356b33c8f5b2,0x35e38df3b1b2b8b0,0x35e37cadb332b42a,0x35e2b76bb41c3072,0x35e25196b43d8c33,0x35e052deb498dc76,0x35dfb60cb4a69b63,0x35dc6480b4e29456,0x35dbae4db4ed616f,0x35d6f338b5155f38
.quad 0x35d640ebb5195283,0x35d00894b5386e09,0x35cf76bab53afab3,0x35c7b0b8b55a3912,0x35c75ac8b55b727b,0x35bdfa4ab57a8501,0x35bdfa4ab57a8501,0x35b2f656b58c8c90,0x35b36482b58bffd6,0x35a6b834b59adfe2,0x35a7aaadb599d941,0x35995562b5a8234e,0x359adfe2b5a6b834,0x358ae560b5b43f8d,0x358d18f3b5b287bc,0x3577030db5bf1f5c
.quad 0x35e38e39,0x35e38e39,0x341c307235e2b76b,0x3421c0c235e2a7cf,0x349b9d0235e03495,0x34a11cf935dff665,0x34e7fc0135dc0a76,0x34f0134b35db7f6e,0x3519528335d640eb,0x351e91b835d54bf5,0x353d858f35cee2e0,0x3543d8ab35cd6888,0x356052cd35c5fe3e,0x3567930235c3e522,0x3580bc4435bba3cf,0x3584bc3135b8d507
.quad 0x35905c1635afe71f,0x3594a21335ac4e9d,0x359eeb5d35a2de58,0x35a35af6359e6b42,0x35ac4e9d3594a213,0x35b0c909358f4716,0x35b86c8e35854d33,0x35bcd118357e0186,0x35c32e503569f950,0x35c75ac8355b727b,0x35cc7f9535479e7f,0x35d050c135372709,0x35d44ec53523cad0,0x35d7a0dd351168af,0x35da8d2234fd83cb,0x35dd3c4c34d507bb
.quad 0x35df2ee234b19357,0x35e117b534858eae,0x35e22b473448a746,0x35e32b4833d41ca3,0x35e37cad3332b42a,0x35e372cfb35f5dfa,0x35e32098b3df4312,0x35e1edbbb4594c39,0x35e117b5b4858eae,0x35de9f1eb4bc8473,0x35dd65dcb4d25071,0x35d98dacb5057282,0x35d81207b50ec292,0x35d2c3a8b52b948c,0x35d12643b5334f66,0x35ca4ed2b5505b1e
.quad 0x35c8afa3b55689b3,0x35c0404ab5737bbe,0x35bebe21b5782ef7,0x35b4ac6db58a57a4,0x35b36482b58bffd6,0x35a7aaadb599d941,0x35a6b834b59adfe2,0x35995562b5a8234e,0x3598d125b5a89b88,0x3589c993b5b518dc,0x3589c993b5b518dc,0x35724d76b5c09fac,0x35737bbeb5c0404a,0x354f1d15b5caa066,0x355198a6b5c9fcc1,0x352a4946b5d306c8
.quad 0x35e38e39,0x35e38e39,0x342750ae35e297a8,0x342ce03235e286f5,0x34a69b6335dfb60c,0x34ac183135df738b,0x34f8256135daefa2,0x3500190b35da5b18,0x3523cad035d44ec5,0x3528fd9735d34966,0x354a1ffb35cbe1d1,0x35505b1e35ca4ed2,0x356ebf2135c1bb09,0x3575d68a35bf8021,0x3588ac7235b5f06c,0x358c8c9035b2f656
.quad 0x3598d12535a89b88,0x359ce8a635a4ce73,0x35a7aaad3599d941,0x35abd9ab3595293a,0x35b518dc3589c993,0x35b93d0e35842ade,0x35c0fe9735711e99,0x35c4f3d33563f560,0x35cb4216354c9f84,0x35cee2e0353d858f,0x35d3cd1b35266500,0x35d6f33835155f38,0x35da8d2234fd83cb,0x35dd123434d7be81,0x35df738b34ac1831,0x35e131a93482cb5f
.quad 0x35e275b634326f4c,0x35e3480d33b2a663,0x35e38d203232b879,0x35e3508cb3a77e13,0x35e2b76bb41c3072,0x35e14b12b48007bf,0x35dff665b4a11cf9,0x35dd3c4cb4d507bb,0x35db5006b4f2c494,0x35d72d9fb5140d65,0x35d4ce63b5212f0b,0x35cf2d0db53c405b,0x35cc7f95b5479e7f,0x35c54d1bb562bfbb,0x35c2759cb56c5d5c,0x35b9a4a2b5839938
.quad 0x35b6c63bb5878e00,0x35ac4e9db594a213,0x35a98ac3b597c790,0x359d69e6b5a45304,0x359adfe2b5a6b834,0x358d18f3b5b287bc,0x358ae560b5b43f8d,0x3577030db5bf1f5c,0x35737bbeb5c0404a,0x355198a6b5c9fcc1,0x354f1d15b5caa066,0x352a4946b5d306c8,0x3528fd97b5d34966,0x35016fe1b5da2886,0x35016fe1b5da2886,0x34aed5fab5df517b
.quad 0x35e38e391afb021f,0x35e275b6b4326f4c,0x35e3480db3b2a663,0x35e0fd37b48851aa,0x35e275b6b4326f4c,0x35dee813b4b70cc7,0x35e117b5b4858eae,0x35dc37bfb4e54872,0x35df2ee2b4b19357,0x35d8ee1ab509723e,0x35dcbc6bb4dd2a7c,0x35d50d6eb51fe093,0x35d9c1d1b5041c9e,0x35d0986db535df98,0x35d640ebb5195283,0x35cb9232b54b5ffe
.quad 0x35d23be2b52e29da,0x35c5fe3eb56052cd,0x35cdb531b54295c7,0x35bfe071b574a96f,0x35c8afa3b55689b3,0x35b93d0eb5842ade,0x35c32e50b569f950,0x35b218b4b58da4ff,0x35bd349eb57cd8a0,0x35aa785cb596bc84,0x35b6c63bb5878e00,0x35a26155b59f6b17,0x35afe71fb5905c16,0x3599d941b5a7aaad,0x35a89b88b598d125,0x3590e611b5af7588
.quad 0x35a0e7f5b5a0e7f5,0x35878e00b5b6c63b,0x3598d125b5a89b88,0x357baf1eb5bd97ae,0x35905c16b5afe71f,0x35679302b5c3e522,0x35878e00b5b6c63b,0x3552d5adb5c9aa34,0x357cd8a0b5bd349e,0x353d858fb5cee2e0,0x3569f950b5c32e50,0x3527b17fb5d38b82,0x355689b3b5c8afa3,0x351168afb5d7a0dd,0x354295c7b5cdb531,0x34f57546b5db2018
.quad 0x352e29dab5d23be2,0x34c76e4ab5de06c5,0x35195283b5d640eb,0x3498dc76b5e052de,0x35041c9eb5d9c1d1,0x3453c069b5e202ca,0x34dd2a7cb5dcbc6b,0x33ea68f6b5e3155d,0x34b19357b5df2ee2,0x32b2b79cb5e389d6,0x34858eaeb5e117b5,0xb3912c43b5e35fe5,0x34326f4cb5e275b6,0xb42750aeb5e297a8,0x33b2a663b5e3480d,0xb482cb5fb5e131a9
.quad 0x35df2ee2b4b19357,0x35d9c1d1b5041c9e,0x35dc6480b4e29456,0x35d589f8b51d427b,0x35d8ee1ab509723e,0x35d0986db535df98,0x35d4ce63b5212f0b,0x35caf17db54dde8c,0x35d00894b5386e09,0x35c49a11b5652a79,0x35caa066b54f1d15,0x35bd97aeb57baf1e,0x35c49a11b5652a79,0x35b5f06cb588ac72,0x35bdfa4ab57a8501,0x35adaaf3b5930a7b
.quad 0x35b6c63bb5878e00,0x35a4ce73b59ce8a6,0x35af0384b5916fb3,0x359b62a3b5a63e5e,0x35a6b834b59adfe2,0x35916fb3b5af0384,0x359deac5b5a3d730,0x3586fe49b5b73079,0x3594a213b5ac4e9d,0x35782ef7b5bebe21,0x358ae560b5b43f8d,0x3561898ab5c5a5e9,0x3580bc44b5bba3cf,0x354a1ffbb5cbe1d1,0x356c5d5cb5c2759c,0x353206a7b5d16c6d
.quad 0x355689b3b5c8afa3,0x35195283b5d640eb,0x35400e98b5ce4d07,0x3500190bb5da5b18,0x3528fd97b5d34966,0x34cce05ab5ddb762,0x351168afb5d7a0dd,0x3498dc76b5e052de,0x34f2c494b5db5006,0x3448a746b5e22b47,0x34c1fa4eb5de5404,0x33bdce45b5e33f02,0x349098a1b5e0aa7a,0xb232b879b5e38d20,0x343d8c33b5e25196,0xb3ea68f6b5e3155d
.quad 0x33b2a663b5e3480d,0xb45ed782b5e1d820,0xb232b879b5e38d20,0xb4a3dc60b5dfd67d,0xb3df4312b5e32098,0xb4d7be81b5dd1234,0xb453c069b5e202ca,0xb5057282b5d98dac,0xb49b9d02b5e03495,0xb51e91b8b5d54bf5,0xb4cce05ab5ddb762,0xb5372709b5d050c1,0xb4fd83cbb5da8d22,0xb54f1d15b5caa066,0xb516b0aeb5d6b84e,0xb5665f05b5c43fd6
.quad 0x35d23be2b52e29da,0x35c8afa3b55689b3,0x35cc7f95b5479e7f,0x35c15d0cb56fef27,0x35c5fe3eb56052cd,0x35b93d0eb5842ade,0x35bebe21b5782ef7,0x35b0584ab58fd1c3,0x35b6c63bb5878e00,0x35a6b834b59adfe2,0x35ae1e39b59281e8,0x359c6705b5a5497d,0x35a4ce73b59ce8a6,0x35916fb3b5af0384,0x359adfe2b5a6b834,0x3585dde2b5b803a3
.quad 0x35905c16b5afe71f,0x35737bbeb5c0404a,0x35854d33b5b86c8e,0x355a3912b5c7b0b8,0x35737bbeb5c0404a,0x35400e98b5ce4d07,0x355b727bb5c75ac8,0x3525181bb5d40e31,0x354295c7b5cdb531,0x3509723eb5d8ee1a,0x3528fd97b5d34966,0x34da74c2b5dce793,0x350ec292b5d81207,0x34a11cf9b5dff665,0x34e7fc01b5dc0a76,0x344e3417b5e2174e
.quad 0x34b19357b5df2ee2,0x33b2a663b5e3480d,0x3474ff28b5e17c43,0xb2df64b5b5e3875e,0x3405eb92b5e2f061,0xb4110eb5b5e2d4fe,0x32b2b79cb5e389d6,0xb482cb5fb5e131a9,0xb3b2a663b5e3480d,0xb4bc8473b5de9f1e,0xb448a746b5e22b47,0xb4f57546b5db2018,0xb49b9d02b5e03495,0xb516b0aeb5d6b84e,0xb4d25071b5dd65dc,0xb53206a7b5d16c6d
.quad 0xb5041c9eb5d9c1d1,0xb54c9f84b5cb4216,0xb51e91b8b5d54bf5,0xb5665f05b5c43fd6,0xb5386e09b5d00894,0xb57f29cfb5bc6d1f,0xb55198a6b5c9fcc1,0xb58b72c6b5b3d23f,0xb569f950b5c32e50,0xb596bc84b5aa785c,0xb580bc44b5bba3cf,0xb5a16623b5a06963,0xb58bffd6b5b36482,0xb5ab6450b595b004,0xb596bc84b5aa785c,0xb5b4ac6db58a57a4
.quad 0x35bd349eb57cd8a0,0x35afe71fb5905c16,0x35b43f8db58ae560,0x35a5497db59c6705,0x35aa785cb596bc84,0x3599d941b5a7aaad,0x359fea6eb5a1e3ee,0x358da4ffb5b218b4,0x3594a213b5ac4e9d,0x3580bc44b5bba3cf,0x3588ac72b5b5f06c,0x35665f05b5c43fd6,0x35782ef7b5bebe21,0x354a1ffbb5cbe1d1,0x355de3b6b5c6ad78,0x352cdf68b5d28006
.quad 0x354295c7b5cdb531,0x350ec292b5d81207,0x35266500b5d3cd1b,0x34dfdfaeb5dc90b9,0x3509723eb5d8ee1a,0x34a11cf9b5dff665,0x34d7be81b5dd1234,0x344319f8b5e23eb4,0x349b9d02b5e03495,0x338602d1b5e366c0,0x343d8c33b5e25196,0xb375b21ab5e36d0d,0x338602d1b5e366c0,0xb43d8c33b5e25196,0xb35f5dfab5e372cf,0xb49e5d2eb5e015c2
.quad 0xb4326f4cb5e275b6,0xb4dd2a7cb5dcbc6b,0xb4961b8bb5e0709c,0xb50d6effb5d849d4,0xb4d25071b5dd65dc,0xb52b948cb5d2c3a8,0xb506c814b5d95902,0xb548df7bb5cc30f2,0xb523cad0b5d44ec5,0xb5652a79b5c49a11,0xb5400e98b5ce4d07,0xb58028bdb5bc08b1,0xb55b727bb5c75ac8,0xb58d18f3b5b287bc,0xb575d68ab5bf8021,0xb5995562b5a8234e
.quad 0xb5878e00b5b6c63b,0xb5a4ce73b59ce8a6,0xb59392b4b5ad3741,0xb5af7588b590e611,0xb59eeb5db5a2de58,0xb5b93d0eb5842ade,0xb5a98ac3b597c790,0xb5c2188eb56d8e88,0xb5b36482b58bffd6,0xb5c9fcc1b55198a6,0xb5bc6d1fb57f29cf,0xb5d0df99b53497b7,0xb5c49a11b5652a79,0xb5d6b84eb516b0ae,0xb5cbe1d1b54a1ffb,0xb5db7f6eb4f0134b
.quad 0x35a0e7f5b5a0e7f5,0x35905c16b5afe71f,0x3594a213b5ac4e9d,0x358274fbb5ba7274,0x35878e00b5b6c63b,0x35679302b5c3e522,0x35737bbeb5c0404a,0x3548df7bb5cc30f2,0x355689b3b5c8afa3,0x3528fd97b5d34966,0x35386e09b5d00894,0x35081d53b5d923d1,0x35195283b5d640eb,0x34cce05ab5ddb762,0x34f2c494b5db5006,0x348851aab5e0fd37
.quad 0x34b19357b5df2ee2,0x3405eb92b5e2f061,0x345ed782b5e1d820,0xb1b2b8b0b5e38df3,0x33b2a663b5e3480d,0xb4110eb5b5e2d4fe,0xb332b42ab5e37cad,0xb48dd6a6b5e0c699,0xb4326f4cb5e275b6,0xb4d25071b5dd65dc,0xb49b9d02b5e03495,0xb50ac6d5b5d8b7de,0xb4dd2a7cb5dcbc6b,0xb52b948cb5d2c3a8,0xb50ec292b5d81207,0xb54b5ffeb5cb9232
.quad 0xb52e29dab5d23be2,0xb569f950b5c32e50,0xb54c9f84b5cb4216,0xb5839938b5b9a4a2,0xb569f950b5c32e50,0xb5916fb3b5af0384,0xb5830742b5ba0bc4,0xb59e6b42b5a35af6,0xb5905c16b5afe71f,0xb5aa785cb596bc84,0xb59ce8a6b5a4ce73,0xb5b584dcb5893b2d,0xb5a89b88b598d125,0xb5bf8021b575d68a,0xb5b36482b58bffd6,0xb5c85b26b557c4ae
.quad 0xb5bd349eb57cd8a0,0xb5d00894b5386e09,0xb5c5fe3eb56052cd,0xb5d67cdeb51801c8,0xb5cdb531b54295c7,0xb5dbae4db4ed616f,0xb5d44ec5b523cad0,0xb5df9510b4a959fe,0xb5d9c1d1b5041c9e,0xb5e22b47b448a746,0xb5de06c5b4c76e4a,0xb5e36d0db375b21a,0xb5e117b5b4858eae,0xb5e3587f339c555b,0xb5e2f061b405eb92,0xb5e1edbb34594c39
.quad 0x357cd8a0b5bd349e,0x355689b3b5c8afa3,0x355de3b6b5c6ad78,0x353497b7b5d0df99,0x353d858fb5cee2e0,0x351168afb5d7a0dd,0x351bf2deb5d5c777,0x34da74c2b5dce793,0x34f2c494b5db5006,0x349098a1b5e0aa7a,0x34ac1831b5df738b,0x340b7d4fb5e2e2f5,0x3448a746b5e22b47,0xb232b879b5e38d20,0x335f5dfab5e372cf,0xb421c0c2b5e2a7cf
.quad 0xb3b2a663b5e3480d,0xb49b9d02b5e03495,0xb469ec76b5e1ab48,0xb4e54872b5dc37bf,0xb4bc8473b5de9f1e,0xb516b0aeb5d6b84e,0xb5016fe1b5da2886,0xb539b497b5cfbfe7,0xb523cad0b5d44ec5,0xb55b727bb5c75ac8,0xb5451b16b5cd1b60,0xb57baf1eb5bd97ae,0xb5652a79b5c49a11,0xb58d18f3b5b287bc,0xb581e263b5bad8b0,0xb59b62a3b5a63e5e
.quad 0xb5905c16b5afe71f,0xb5a89b88b598d125,0xb59deac5b5a3d730,0xb5b4ac6db58a57a4,0xb5aa785cb596bc84,0xb5bf8021b575d68a,0xb5b5f06cb588ac72,0xb5c903a5b5554e35,0xb5c0404ab5737bbe,0xb5d12643b5334f66,0xb5c9572bb5541232,0xb5d7d9b4b51015cd,0xb5d12643b5334f66,0xb5dd1234b4d7be81,0xb5d7a0ddb51168af,0xb5e0c699b48dd6a6
.quad 0xb5dcbc6bb4dd2a7c,0xb5e2f061b405eb92,0xb5e0709cb4961b8b,0xb5e38bc132860a16,0xb5e2b76bb41c3072,0xb5e297a8342750ae,0xb5e38d20b232b879,0xb5e015c2349e5d2e,0xb5e2f0613405eb92,0xb5dc0a7634e7fc01,0xb5e0e22d348b1453,0xb5d67cde351801c8,0xb5dd65dc34d25071,0xb5cf76ba353afab3,0xb5d8811b350c1b15,0xb5c7045d355cab5d
.quad 0x352e29dab5d23be2,0x35041c9eb5d9c1d1,0x3509723eb5d8ee1a,0x34b9c8d6b5dec3dd,0x34c76e4ab5de06c5,0x3453c069b5e202ca,0x3474ff28b5e17c43,0x33490950b5e37804,0x33b2a663b5e3480d,0xb3df4312b5e32098,0xb38602d1b5e366c0,0xb48851aab5e0fd37,0xb45ed782b5e1d820,0xb4d7be81b5dd1234,0xb4bc8473b5de9f1e,0xb512bb38b5d76780
.quad 0xb5041c9eb5d9c1d1,0xb5386e09b5d00894,0xb528fd97b5d34966,0xb55cab5db5c7045d,0xb54c9f84b5cb4216,0xb57f29cfb5bc6d1f,0xb56ebf21b5c1bb09,0xb58fd1c3b5b0584a,0xb5878e00b5b6c63b,0xb59eeb5db5a2de58,0xb596bc84b5aa785c,0xb5acc324b5941a91,0xb5a4ce73b59ce8a6,0xb5b93d0eb5842ade,0xb5b1a93db58e30b4,0xb5c43fd6b5665f05
.quad 0xb5bd349eb57cd8a0,0xb5cdb531b54295c7,0xb5c75ac8b55b727b,0xb5d589f8b51d427b,0xb5d00894b5386e09,0xb5dbae4db4ed616f,0xb5d72d9fb5140d65,0xb5e015c2b49e5d2e,0xb5dcbc6bb4dd2a7c,0xb5e2b76bb41c3072,0xb5e0aa7ab49098a1,0xb5e38df331b2b8b0,0xb5e2f061b405eb92,0xb5e297a8342750ae,0xb5e389d632b2b79c,0xb5dfd67d34a3dc60
.quad 0xb5e275b634326f4c,0xb5db500634f2c494,0xb5dfb60c34a69b63,0xb5d50d6e351fe093,0xb5db500634f2c494,0xb5cd1b6035451b16,0xb5d54bf5351e91b8,0xb5c389f63568c671,0xb5cdb531354295c7,0xb5b86c8e35854d33,0xb5c49a1135652a79,0xb5abd9ab3595293a,0xb5ba0bc435830742,0xb59deac535a3d730,0xb5ae1e39359281e8,0xb58ebc1135b1395a
.quad 0x34b19357b5df2ee2,0x34326f4cb5e275b6,0x343d8c33b5e25196,0x31b2b8b0b5e38df3,0x32b2b79cb5e389d6,0xb42750aeb5e297a8,0xb4110eb5b5e2d4fe,0xb4a959feb5df9510,0xb49b9d02b5e03495,0xb4fd83cbb5da8d22,0xb4ed616fb5dbae4d,0xb527b17fb5d38b82,0xb51e91b8b5d54bf5,0xb54f1d15b5caa066,0xb5451b16b5cd1b60,0xb574a96fb5bfe071
.quad 0xb569f950b5c32e50,0xb58bffd6b5b36482,0xb5866e3fb5b79a47,0xb59c6705b5a5497d,0xb596bc84b5aa785c,0xb5ab6450b595b004,0xb5a5c420b59be504,0xb5b8d507b584bc31,0xb5b36482b58bffd6,0xb5c49a11b5652a79,0xb5bf8021b575d68a,0xb5ce9833b53eca4f,0xb5c9fcc1b55198a6,0xb5d6b84eb516b0ae,0xb5d2c3a8b52b948c,0xb5dce793b4da74c2
.quad 0xb5d9c1d1b5041c9e,0xb5e117b5b4858eae,0xb5dee813b4b70cc7,0xb5e33f02b3bdce45,0xb5e22b47b448a746,0xb5e3587f339c555b,0xb5e3845ab30608a2,0xb5e163f0347a87a0,0xb5e2f0613405eb92,0xb5dd65dc34d25071,0xb5e0709c34961b8b,0xb5d767803512bb38,0xb5dc0a7634e7fc01,0xb5cf76ba353afab3,0xb5d5c777351bf2de,0xb5c5a5e93561898a
.quad 0xb5cdb531354295c7,0xb5ba0bc435830742,0xb5c3e52235679302,0xb5acc32435941a91,0xb5b86c8e35854d33,0xb59deac535a3d730,0xb5ab64503595b004,0xb58da4ff35b218b4,0xb59ce8a635a4ce73,0xb5782ef735bebe21,0xb58d18f335b287bc,0xb552d5ad35c9aa34,0xb5782ef735bebe21,0xb52b948c35d2c3a8,0xb554123235c9572b,0xb502c66835d9f56f
.quad 0x80003f8080003f80,0x80003f8080003f80,0x3f8000003f800000,0x3f8000003f800000,0xbe483f7b80003f80,0xbf553f0ebf353f35,0x3f7b3e483f800000,0x3f0e3f553f353f35,0xbec43f6d80003f80,0xbf6dbec4bf80248d,0x3f6d3ec43f800000,0xbec43f6d248d3f80,0xbf0e3f5580003f80,0xbe48bf7bbf35bf35,0x3f553f0e3f800000,0xbf7b3e48bf353f35
.quad 0xbf353f3580003f80,0x3f35bf35a50dbf80,0x3f353f353f800000,0xbf35bf35bf80250d,0xbf553f0e80003f80,0x3f7b3e483f35bf35,0x3f0e3f553f800000,0x3e48bf7bbf35bf35,0xbf6d3ec480003f80,0x3ec43f6d3f80a554,0x3ec43f6d3f800000,0x3f6dbec4a554bf80,0xbf7b3e4880003f80,0xbf0e3f553f353f35,0x3e483f7b3f800000,0x3f553f0e3f35bf35
.quad 0xbf80248d80003f80,0xbf8025b0258d3f80,0x248d3f803f800000,0x25b03f803f80a58d,0xbf7bbe4880003f80,0xbf0ebf55bf353f35,0xbe483f7b3f800000,0xbf553f0e3f353f35,0xbf6dbec480003f80,0x3ec4bf6dbf8025b0,0xbec43f6d3f800000,0xbf6dbec425b03f80,0xbf55bf0e80003f80,0x3f7bbe48bf35bf35,0xbf0e3f553f800000,0xbe48bf7bbf353f35
.quad 0xbf35bf3580003f80,0x3f353f35a5d4bf80,0xbf353f353f800000,0x3f35bf35bf8025d4,0xbf0ebf5580003f80,0xbe483f7b3f35bf35,0xbf553f0e3f800000,0x3f7b3e48bf35bf35,0xbec4bf6d80003f80,0xbf6d3ec43f80a5f7,0xbf6d3ec43f800000,0x3ec43f6da5f7bf80,0xbe48bf7b80003f80,0xbf55bf0e3f353f35,0xbf7b3e483f800000,0xbf0e3f553f35bf35
.quad 0x80003f8080003f80,0x80003f8080003f80,0x3f8000003f800000,0x3f8000003f800000,0xbf0e3f55bec43f6d,0xbf7b3e48bf6d3ec4,0x3f553f0e3f6d3ec4,0x3e483f7b3ec43f6d,0xbf6d3ec4bf353f35,0xbec4bf6dbf35bf35,0x3ec43f6d3f353f35,0xbf6d3ec4bf353f35,0xbf7bbe48bf6d3ec4,0x3f55bf0e3ec4bf6d,0xbe483f7b3ec43f6d,0xbf0ebf55bf6dbec4
.quad 0xbf35bf35bf80248d,0x3f353f353f80a554,0xbf353f35248d3f80,0x3f35bf35a554bf80,0xbe48bf7bbf6dbec4,0xbf0e3f553ec43f6d,0xbf7b3e48bec43f6d,0x3f553f0e3f6dbec4,0x3ec4bf6dbf35bf35,0xbf6dbec4bf353f35,0xbf6dbec4bf353f35,0xbec43f6d3f353f35,0x3f55bf0ebec4bf6d,0x3e48bf7bbf6dbec4,0xbf0ebf55bf6d3ec4,0xbf7bbe48bec43f6d
.quad 0x3f80a554a50dbf80,0x3f80a5f7a5d4bf80,0xa554bf80bf80250d,0xa5f7bf80bf8025d4,0x3f553f0e3ec4bf6d,0x3e483f7b3f6dbec4,0x3f0ebf55bf6dbec4,0x3f7bbe48bec4bf6d,0x3ec43f6d3f35bf35,0xbf6d3ec43f353f35,0x3f6dbec4bf35bf35,0x3ec43f6d3f35bf35,0xbe483f7b3f6dbec4,0xbf0ebf55bec43f6d,0x3f7b3e48bec4bf6d,0xbf553f0e3f6d3ec4
.quad 0xbf353f353f80a554,0x3f35bf35bf80261f,0x3f353f35a554bf80,0xbf35bf35261f3f80,0xbf7b3e483f6d3ec4,0x3f553f0ebec4bf6d,0x3e483f7b3ec4bf6d,0x3f0ebf55bf6d3ec4,0xbf6dbec43f353f35,0xbec43f6d3f35bf35,0xbec43f6d3f35bf35,0x3f6d3ec4bf35bf35,0xbf0ebf553ec43f6d,0xbf7bbe483f6d3ec4,0xbf553f0e3f6dbec4,0xbe483f7b3ec4bf6d
.quad 0x80003f8080003f80,0x80003f8080003f80,0x3f8000003f800000,0x3f8000003f800000,0xbf7bbe48bf80248d,0xbf0ebf55bf35bf35,0xbe483f7b248d3f80,0xbf553f0ebf353f35,0x3ec4bf6da50dbf80,0x3f6d3ec43f80a554,0xbf6dbec4bf80250d,0x3ec4bf6da554bf80,0x3f553f0e3f80a554,0xbf7b3e48bf353f35,0x3f0ebf55a554bf80,0x3e483f7b3f353f35
.quad 0xbf353f35258d3f80,0x3f35bf35a5d4bf80,0x3f353f353f80a58d,0xbf35bf35bf8025d4,0xbf0ebf55bf8025b0,0xbe483f7b3f353f35,0xbf553f0e25b03f80,0x3f7b3e483f35bf35,0x3f6dbec4a5d4bf80,0xbec4bf6dbf80261f,0xbec4bf6dbf8025d4,0xbf6d3ec4261f3f80,0x3e483f7b3f80a5f7,0x3f553f0e3f35bf35,0x3f7bbe48a5f7bf80,0x3f0ebf55bf35bf35
.quad 0xbf80261f260d3f80,0xbf80a68d26543f80,0x261f3f803f80a60d,0xa68d3f803f80a654,0x3e48bf7bbf80261f,0x3f55bf0ebf35bf35,0xbf7bbe48261f3f80,0xbf0ebf55bf353f35,0x3f6d3ec4a630bf80,0xbec43f6d3f80a742,0x3ec4bf6dbf802630,0x3f6d3ec4a742bf80,0xbf0e3f553f80a731,0xbe48bf7bbf353f35,0x3f553f0ea731bf80,0xbf7b3e483f353f35
.quad 0xbf35bf3526543f80,0x3f353f35a69fbf80,0xbf353f353f80a654,0x3f35bf35bf80269f,0x3f55bf0ebf80a68d,0xbf7bbe483f353f35,0xbf0ebf55a68d3f80,0xbe483f7b3f35bf35,0x3ec43f6da677bf80,0x3f6dbec4bf80a60d,0x3f6dbec4bf802677,0xbec4bf6da60d3f80,0xbf7b3e483f80a742,0xbf0e3f553f35bf35,0x3e483f7ba742bf80,0x3f553f0ebf35bf35
.quad 0x80003f8080003f80,0x80003f8080003f80,0x3f8000003f800000,0x3f8000003f800000,0xbf55bf0ebf6dbec4,0xbe48bf7bbec4bf6d,0xbf0e3f55bec43f6d,0xbf7b3e48bf6d3ec4,0x3f6dbec43f35bf35,0x3ec43f6d3f353f35,0xbec4bf6dbf35bf35,0x3f6dbec43f35bf35,0xbe483f7b3ec43f6d,0xbf0ebf55bf6dbec4,0x3f7b3e483f6dbec4,0xbf553f0ebec43f6d
.quad 0xbf35bf35bf8025b0,0x3f353f353f80a5f7,0xbf353f3525b03f80,0x3f35bf35a5f7bf80,0x3f7bbe483ec4bf6d,0xbf55bf0ebf6d3ec4,0xbe48bf7bbf6dbec4,0xbf0e3f553ec43f6d,0xbec43f6d3f353f35,0x3f6d3ec43f35bf35,0x3f6d3ec43f35bf35,0x3ec4bf6dbf35bf35,0xbf0ebf55bf6d3ec4,0xbf7bbe48bec43f6d,0xbf553f0e3ec43f6d,0xbe483f7b3f6d3ec4
.quad 0x3f80a731a630bf80,0x3f80a742a677bf80,0xa731bf80bf802630,0xa742bf80bf802677,0xbf0e3f553f6d3ec4,0xbf7b3e483ec43f6d,0x3f553f0e3ec4bf6d,0x3e483f7b3f6dbec4,0xbec4bf6dbf353f35,0x3f6dbec4bf35bf35,0xbf6d3ec43f353f35,0xbec4bf6dbf353f35,0x3f7b3e48bec4bf6d,0xbf553f0e3f6d3ec4,0x3e48bf7bbf6d3ec4,0x3f0e3f553ec4bf6d
.quad 0xbf353f353f80a742,0x3f35bf35bf80a60d,0x3f353f35a742bf80,0xbf35bf35a60d3f80,0xbe48bf7bbec43f6d,0xbf0e3f553f6dbec4,0xbf7b3e483f6d3ec4,0x3f553f0ebec4bf6d,0x3f6d3ec4bf35bf35,0x3ec4bf6dbf353f35,0x3ec4bf6dbf353f35,0xbf6dbec43f353f35,0xbf553f0e3f6dbec4,0xbe483f7b3ec4bf6d,0x3f0e3f55bec4bf6d,0x3f7b3e48bf6dbec4
.quad 0x80003f8080003f80,0x80003f8080003f80,0x3f8000003f800000,0x3f8000003f800000,0x3e48bf7ba50dbf80,0x3f55bf0e3f35bf35,0xbf7bbe48bf80250d,0xbf0ebf55bf35bf35,0xbec43f6d258d3f80,0xbf6dbec4bf8025b0,0x3f6d3ec43f80a58d,0xbec43f6d25b03f80,0x3f0ebf55a5d4bf80,0x3e483f7b3f353f35,0xbf55bf0ebf8025d4,0x3f7bbe483f35bf35
.quad 0xbf353f35260d3f80,0x3f35bf35a630bf80,0x3f353f353f80a60d,0xbf35bf35bf802630,0x3f55bf0ea630bf80,0xbf7bbe48bf353f35,0xbf0ebf55bf802630,0xbe483f7b3f353f35,0xbf6d3ec426543f80,0x3ec43f6d3f80a742,0x3ec43f6d3f80a654,0x3f6dbec4a742bf80,0x3f7bbe48a677bf80,0x3f0ebf55bf35bf35,0xbe48bf7bbf802677,0xbf55bf0ebf353f35
.quad 0xbf80a654268d3f80,0xbf80a60d26b03f80,0xa6543f803f80a68d,0xa60d3f803f80a6b0,0x3f7b3e48a69fbf80,0x3f0e3f553f35bf35,0x3e48bf7bbf80269f,0x3f55bf0ebf35bf35,0xbf6dbec426b03f80,0x3ec4bf6dbf80a58e,0xbec43f6d3f80a6b0,0xbf6dbec4a58e3f80,0x3f553f0ea7b1bf80,0xbf7b3e483f353f35,0x3f0ebf55bf8027b1,0x3e483f7b3f35bf35
.quad 0xbf35bf3526d43f80,0x3f353f35a7c2bf80,0xbf353f353f80a6d4,0x3f35bf35bf8027c2,0x3f0e3f55270dbf80,0x3e48bf7bbf353f35,0x3f55bf0ebf80a70d,0xbf7bbe483f353f35,0xbec4bf6d26f73f80,0xbf6d3ec43f80a78d,0xbf6d3ec43f80a6f7,0x3ec43f6da78dbf80,0x3e483f7ba7c2bf80,0x3f553f0ebf35bf35,0x3f7bbe48bf8027c2,0x3f0ebf55bf353f35
.quad 0x80003f8080003f80,0x80003f8080003f80,0x3f8000003f800000,0x3f8000003f800000,0x3f0ebf553ec4bf6d,0x3f7bbe483f6dbec4,0xbf55bf0ebf6dbec4,0xbe48bf7bbec4bf6d,0xbf6d3ec4bf353f35,0xbec4bf6dbf35bf35,0x3ec43f6d3f353f35,0xbf6d3ec4bf353f35,0x3f7b3e483f6dbec4,0xbf553f0ebec43f6d,0x3e48bf7bbec4bf6d,0x3f0e3f553f6d3ec4
.quad 0xbf35bf35bf80261f,0x3f353f353f80a731,0xbf353f35261f3f80,0x3f35bf35a731bf80,0x3e483f7b3f6d3ec4,0x3f0ebf55bec4bf6d,0x3f7bbe483ec4bf6d,0xbf55bf0ebf6d3ec4,0x3ec4bf6dbf35bf35,0xbf6dbec4bf353f35,0xbf6dbec4bf353f35,0xbec43f6d3f353f35,0xbf553f0e3ec43f6d,0xbe483f7b3f6d3ec4,0x3f0e3f553f6dbec4,0x3f7b3e483ec4bf6d
.quad 0x3f80a754a69fbf80,0x3f80a765a7b1bf80,0xa754bf80bf80269f,0xa765bf80bf8027b1,0xbf55bf0ebec43f6d,0xbe48bf7bbf6d3ec4,0xbf0e3f553f6d3ec4,0xbf7b3e483ec43f6d,0x3ec43f6d3f35bf35,0xbf6d3ec43f353f35,0x3f6dbec4bf35bf35,0x3ec43f6d3f35bf35,0x3e48bf7bbf6d3ec4,0x3f0e3f553ec4bf6d,0xbf7bbe483ec43f6d,0x3f55bf0ebf6dbec4
.quad 0xbf353f353f80a777,0x3f35bf35bf80258d,0x3f353f35a777bf80,0xbf35bf35258d3f80,0x3f7bbe48bf6dbec4,0xbf55bf0e3ec43f6d,0xbe48bf7bbec43f6d,0xbf0e3f553f6dbec4,0xbf6dbec43f353f35,0xbec43f6d3f35bf35,0xbec43f6d3f35bf35,0x3f6d3ec4bf35bf35,0x3f0e3f55bec4bf6d,0x3f7b3e48bf6dbec4,0x3f55bf0ebf6d3ec4,0x3e48bf7bbec43f6d
.quad 0x80003f8080003f80,0x80003f8080003f80,0x3f8000003f800000,0x3f8000003f800000,0x3f7b3e483f80a554,0x3f0e3f553f353f35,0x3e48bf7ba554bf80,0x3f55bf0e3f35bf35,0x3ec4bf6da5d4bf80,0x3f6d3ec43f80a5f7,0xbf6dbec4bf8025d4,0x3ec4bf6da5f7bf80,0xbf55bf0ebf80261f,0x3f7bbe483f35bf35,0xbf0e3f55261f3f80,0xbe48bf7bbf35bf35
.quad 0xbf353f3526543f80,0x3f35bf35a677bf80,0x3f353f353f80a654,0xbf35bf35bf802677,0x3f0e3f553f80a742,0x3e48bf7bbf35bf35,0x3f55bf0ea742bf80,0xbf7bbe48bf353f35,0x3f6dbec4a69fbf80,0xbec4bf6dbf80a60d,0xbec4bf6dbf80269f,0xbf6d3ec4a60d3f80,0xbe48bf7bbf80a60d,0xbf55bf0ebf353f35,0xbf7b3e48a60d3f80,0xbf0e3f553f353f35
.quad 0xbf80a58e26d43f80,0xbf80a13726f73f80,0xa58e3f803f80a6d4,0xa1373f803f80a6f7,0xbe483f7b3f80a777,0xbf553f0e3f353f35,0x3f7b3e48a777bf80,0x3f0e3f553f35bf35,0x3f6d3ec4a7c2bf80,0xbec43f6d3f80a78d,0x3ec4bf6dbf8027c2,0x3f6d3ec4a78dbf80,0x3f0ebf55bf802804,0x3e483f7b3f35bf35,0xbf55bf0e28043f80,0x3f7bbe48bf35bf35
.quad 0xbf35bf35271f3f80,0x3f353f35268dbf80,0xbf353f353f80a71f,0x3f35bf35bf80a68d,0xbf553f0e3f802754,0x3f7b3e48bf35bf35,0x3f0e3f552754bf80,0x3e48bf7bbf353f35,0x3ec43f6d268dbf80,0x3f6dbec4bf802816,0x3f6dbec4bf80a68d,0xbec4bf6d28163f80,0x3f7bbe48bf802889,0x3f0ebf55bf353f35,0xbe48bf7b28893f80,0xbf55bf0e3f353f35
.quad 0x80003f8080003f80,0x80003f8080003f80,0x3f8000003f800000,0x3f8000003f800000,0x3f553f0e3f6d3ec4,0x3e483f7b3ec43f6d,0x3f0ebf553ec4bf6d,0x3f7bbe483f6dbec4,0x3f6dbec43f35bf35,0x3ec43f6d3f353f35,0xbec4bf6dbf35bf35,0x3f6dbec43f35bf35,0x3e48bf7bbec4bf6d,0x3f0e3f553f6d3ec4,0xbf7bbe48bf6d3ec4,0x3f55bf0e3ec4bf6d
.quad 0xbf35bf35bf80a68d,0x3f353f353f80a742,0xbf353f35a68d3f80,0x3f35bf35a742bf80,0xbf7b3e48bec43f6d,0x3f553f0e3f6dbec4,0x3e483f7b3f6d3ec4,0x3f0ebf55bec4bf6d,0xbec43f6d3f353f35,0x3f6d3ec43f35bf35,0x3f6d3ec43f35bf35,0x3ec4bf6dbf35bf35,0x3f0e3f553f6dbec4,0x3f7b3e483ec4bf6d,0x3f55bf0ebec4bf6d,0x3e48bf7bbf6dbec4
.quad 0x3f80a777270dbf80,0x3f80a784a7c2bf80,0xa777bf80bf80a70d,0xa784bf80bf8027c2,0x3f0ebf55bf6dbec4,0x3f7bbe48bec4bf6d,0xbf55bf0ebec43f6d,0xbe48bf7bbf6d3ec4,0xbec4bf6dbf353f35,0x3f6dbec4bf35bf35,0xbf6d3ec43f353f35,0xbec4bf6dbf353f35,0xbf7bbe483ec43f6d,0x3f55bf0ebf6dbec4,0xbe483f7b3f6dbec4,0xbf0ebf55bec43f6d
.quad 0xbf353f353f80a796,0x3f35bf35bf80268d,0x3f353f35a796bf80,0xbf35bf35268d3f80,0x3e483f7b3ec4bf6d,0x3f0ebf55bf6d3ec4,0x3f7bbe48bf6dbec4,0xbf55bf0e3ec43f6d,0x3f6d3ec4bf35bf35,0x3ec4bf6dbf353f35,0x3ec4bf6dbf353f35,0xbf6dbec43f353f35,0x3f55bf0ebf6d3ec4,0x3e48bf7bbec43f6d,0xbf0ebf553ec43f6d,0xbf7bbe483f6d3ec4
.quad 0xa50dbf8080003f80,0xa630bf80260d3f80,0xbf80250d3f800000,0xbf8026303f80a60d,0x3e48bf7b80003f80,0x3f55bf0ebf353f35,0xbf7bbe483f800000,0xbf0ebf553f353f35,0x3ec4bf6d80003f80,0x3f6d3ec4bf80261f,0xbf6dbec43f800000,0x3ec4bf6d261f3f80,0x3f0ebf5580003f80,0x3e483f7bbf35bf35,0xbf55bf0e3f800000,0x3f7bbe48bf353f35
.quad 0x3f35bf3580003f80,0xbf353f35a630bf80,0xbf35bf353f800000,0x3f353f35bf802630,0x3f55bf0e80003f80,0xbf7bbe483f35bf35,0xbf0ebf553f800000,0xbe483f7bbf35bf35,0x3f6dbec480003f80,0xbec4bf6d3f80a731,0xbec4bf6d3f800000,0xbf6d3ec4a731bf80,0x3f7bbe4880003f80,0x3f0ebf553f353f35,0xbe48bf7b3f800000,0xbf55bf0e3f35bf35
.quad 0x3f80a55480003f80,0x3f80a74226543f80,0xa554bf803f800000,0xa742bf803f80a654,0x3f7b3e4880003f80,0x3f0e3f55bf353f35,0x3e48bf7b3f800000,0x3f55bf0e3f353f35,0x3f6d3ec480003f80,0xbec43f6dbf80a68d,0x3ec4bf6d3f800000,0x3f6d3ec4a68d3f80,0x3f553f0e80003f80,0xbf7b3e48bf35bf35,0x3f0ebf553f800000,0x3e483f7bbf353f35
.quad 0x3f353f3580003f80,0xbf35bf35a677bf80,0x3f35bf353f800000,0xbf353f35bf802677,0x3f0e3f5580003f80,0x3e48bf7b3f35bf35,0x3f55bf0e3f800000,0xbf7bbe48bf35bf35,0x3ec43f6d80003f80,0x3f6dbec43f80a742,0x3f6dbec43f800000,0xbec4bf6da742bf80,0x3e483f7b80003f80,0x3f553f0e3f353f35,0x3f7bbe483f800000,0x3f0ebf553f35bf35
.quad 0xa5d4bf80258d3f80,0xa677bf8026543f80,0xbf8025d43f80a58d,0xbf8026773f80a654,0x3f0ebf55bec43f6d,0x3f7bbe48bf6d3ec4,0xbf55bf0e3f6d3ec4,0xbe48bf7b3ec43f6d,0x3f6dbec4bf353f35,0x3ec43f6dbf35bf35,0xbec4bf6d3f353f35,0x3f6dbec4bf353f35,0x3f7b3e48bf6d3ec4,0xbf553f0e3ec4bf6d,0x3e48bf7b3ec43f6d,0x3f0e3f55bf6dbec4
.quad 0x3f353f35bf8025b0,0xbf35bf353f80a742,0x3f35bf3525b03f80,0xbf353f35a742bf80,0x3e483f7bbf6dbec4,0x3f0ebf553ec43f6d,0x3f7bbe48bec43f6d,0xbf55bf0e3f6dbec4,0xbec43f6dbf35bf35,0x3f6d3ec4bf353f35,0x3f6d3ec4bf353f35,0x3ec4bf6d3f353f35,0xbf553f0ebec4bf6d,0xbe483f7bbf6dbec4,0x3f0e3f55bf6d3ec4,0x3f7b3e48bec43f6d
.quad 0xbf80261fa5d4bf80,0xbf80a60da69fbf80,0x261f3f80bf8025d4,0xa60d3f80bf80269f,0xbf55bf0e3ec4bf6d,0xbe48bf7b3f6dbec4,0xbf0e3f55bf6dbec4,0xbf7b3e48bec4bf6d,0xbec4bf6d3f35bf35,0x3f6dbec43f353f35,0xbf6d3ec4bf35bf35,0xbec4bf6d3f35bf35,0x3e48bf7b3f6dbec4,0x3f0e3f55bec43f6d,0xbf7bbe48bec4bf6d,0x3f55bf0e3f6d3ec4
.quad 0x3f35bf353f80a5f7,0xbf353f35bf80a60d,0xbf35bf35a5f7bf80,0x3f353f35a60d3f80,0x3f7bbe483f6d3ec4,0xbf55bf0ebec4bf6d,0xbe48bf7b3ec4bf6d,0xbf0e3f55bf6d3ec4,0x3f6d3ec43f353f35,0x3ec4bf6d3f35bf35,0x3ec4bf6d3f35bf35,0xbf6dbec4bf35bf35,0x3f0e3f553ec43f6d,0x3f7b3e483f6d3ec4,0x3f55bf0e3f6dbec4,0x3e48bf7b3ec4bf6d
.quad 0xa69fbf80268d3f80,0x270dbf8026d43f80,0xbf80269f3f80a68d,0xbf80a70d3f80a6d4,0x3f7b3e48bf80a654,0x3f0e3f55bf35bf35,0x3e48bf7ba6543f80,0x3f55bf0ebf353f35,0xbec43f6da69fbf80,0xbf6dbec43f80a777,0x3f6d3ec4bf80269f,0xbec43f6da777bf80,0xbf55bf0e3f80a754,0x3f7bbe48bf353f35,0xbf0e3f55a754bf80,0xbe48bf7b3f353f35
.quad 0x3f35bf3526b03f80,0xbf353f35a7c2bf80,0xbf35bf353f80a6b0,0x3f353f35bf8027c2,0x3f0e3f55bf80a60d,0x3e48bf7b3f353f35,0x3f55bf0ea60d3f80,0xbf7bbe483f35bf35,0xbf6d3ec4a7b1bf80,0x3ec43f6dbf802804,0x3ec43f6dbf8027b1,0x3f6dbec428043f80,0xbe48bf7b3f80a765,0xbf55bf0e3f35bf35,0xbf7b3e48a765bf80,0xbf0e3f55bf35bf35
.quad 0x3f80a77726d43f80,0x3f80a796271f3f80,0xa777bf803f80a6d4,0xa796bf803f80a71f,0xbe483f7bbf80a58e,0xbf553f0ebf35bf35,0x3f7b3e48a58e3f80,0x3f0e3f55bf353f35,0xbf6dbec4270dbf80,0x3ec4bf6d3f802754,0xbec43f6dbf80a70d,0xbf6dbec42754bf80,0x3f0ebf553f80a777,0x3e483f7bbf353f35,0xbf55bf0ea777bf80,0x3f7bbe483f353f35
.quad 0x3f353f3526f73f80,0xbf35bf35268dbf80,0x3f35bf353f80a6f7,0xbf353f35bf80a68d,0xbf553f0ebf80a137,0x3f7b3e483f353f35,0x3f0e3f55a1373f80,0x3e48bf7b3f35bf35,0xbec4bf6da7c2bf80,0xbf6d3ec4bf802889,0xbf6d3ec4bf8027c2,0x3ec43f6d28893f80,0x3f7bbe483f80a784,0x3f0ebf553f35bf35,0xbe48bf7ba784bf80,0xbf55bf0ebf35bf35
.quad 0xa7b1bf8026b03f80,0xa7c2bf8026f73f80,0xbf8027b13f80a6b0,0xbf8027c23f80a6f7,0x3f553f0ebf6dbec4,0x3e483f7bbec4bf6d,0x3f0ebf55bec43f6d,0x3f7bbe48bf6d3ec4,0xbf6d3ec43f35bf35,0xbec4bf6d3f353f35,0x3ec43f6dbf35bf35,0xbf6d3ec43f35bf35,0x3e48bf7b3ec43f6d,0x3f0e3f55bf6dbec4,0xbf7bbe483f6dbec4,0x3f55bf0ebec43f6d
.quad 0x3f353f35bf80a58e,0xbf35bf353f80a78d,0x3f35bf35a58e3f80,0xbf353f35a78dbf80,0xbf7b3e483ec4bf6d,0x3f553f0ebf6d3ec4,0x3e483f7bbf6dbec4,0x3f0ebf553ec43f6d,0x3ec4bf6d3f353f35,0xbf6dbec43f35bf35,0xbf6dbec43f35bf35,0xbec43f6dbf35bf35,0x3f0e3f55bf6d3ec4,0x3f7b3e48bec43f6d,0x3f55bf0e3ec43f6d,0x3e48bf7b3f6d3ec4
.quad 0xbf80258da7c2bf80,0xbf80268d268dbf80,0x258d3f80bf8027c2,0x268d3f80bf80a68d,0x3f0ebf553f6d3ec4,0x3f7bbe483ec43f6d,0xbf55bf0e3ec4bf6d,0xbe48bf7b3f6dbec4,0x3ec43f6dbf353f35,0xbf6d3ec4bf35bf35,0x3f6dbec43f353f35,0x3ec43f6dbf353f35,0xbf7bbe48bec4bf6d,0x3f55bf0e3f6d3ec4,0xbe483f7bbf6d3ec4,0xbf0ebf553ec4bf6d
.quad 0x3f35bf353f80a78d,0xbf353f35bf802816,0xbf35bf35a78dbf80,0x3f353f3528163f80,0x3e483f7bbec43f6d,0x3f0ebf553f6dbec4,0x3f7bbe483f6d3ec4,0xbf55bf0ebec4bf6d,0xbf6dbec4bf35bf35,0xbec43f6dbf353f35,0xbec43f6dbf353f35,0x3f6d3ec43f353f35,0x3f55bf0e3f6dbec4,0x3e48bf7b3ec4bf6d,0xbf0ebf55bec4bf6d,0xbf7bbe48bf6dbec4
.quad 0x26d4bf80270d3f80,0x268dbf8027303f80,0xbf80a6d43f80a70d,0xbf80a68d3f80a730,0xbe483f7b26d4bf80,0xbf553f0e3f35bf35,0x3f7b3e48bf80a6d4,0x3f0e3f55bf35bf35,0x3ec4bf6d271f3f80,0x3f6d3ec4bf80268d,0xbf6dbec43f80a71f,0x3ec4bf6d268d3f80,0xbf0e3f55a7d4bf80,0xbe48bf7b3f353f35,0x3f553f0ebf8027d4,0xbf7b3e483f35bf35
.quad 0x3f35bf3527303f80,0xbf353f35260ebf80,0xbf35bf353f80a730,0x3f353f35bf80a60e,0xbf553f0e268dbf80,0x3f7b3e48bf353f35,0x3f0e3f55bf80a68d,0x3e48bf7b3f353f35,0x3f6dbec428313f80,0xbec4bf6d3f80a85d,0xbec4bf6d3f80a831,0xbf6d3ec4a85dbf80,0xbf7b3e48a7e5bf80,0xbf0e3f55bf35bf35,0x3e483f7bbf8027e5,0x3f553f0ebf353f35
.quad 0x3f80a7b127543f80,0x3f8026d428423f80,0xa7b1bf803f80a754,0x26d4bf803f80a842,0xbf7bbe48260ebf80,0xbf0ebf553f35bf35,0xbe483f7bbf80a60e,0xbf553f0ebf35bf35,0x3f6d3ec4a78d3f80,0xbec43f6dbf80a7b1,0x3ec4bf6d3f80278d,0x3f6d3ec4a7b13f80,0xbf55bf0ea7f7bf80,0x3f7bbe483f353f35,0xbf0e3f55bf8027f7,0xbe48bf7b3f35bf35
.quad 0x3f353f3527773f80,0xbf35bf35a80dbf80,0x3f35bf353f80a777,0xbf353f35bf80280d,0xbf0ebf5521b7bf80,0xbe483f7bbf353f35,0xbf553f0ebf80a1b7,0x3f7b3e483f353f35,0x3ec43f6d28423f80,0x3f6dbec43f80a7e5,0x3f6dbec43f80a842,0xbec4bf6da7e5bf80,0xbe48bf7ba804bf80,0xbf55bf0ebf35bf35,0xbf7b3e48bf802804,0xbf0e3f55bf353f35
.quad 0xa7d4bf80271f3f80,0xa7e5bf8028313f80,0xbf8027d43f80a71f,0xbf8027e53f80a831,0xbf0e3f553ec4bf6d,0xbf7b3e483f6dbec4,0x3f553f0ebf6dbec4,0x3e483f7bbec4bf6d,0x3f6dbec4bf353f35,0x3ec43f6dbf35bf35,0xbec4bf6d3f353f35,0x3f6dbec4bf353f35,0xbf7bbe483f6dbec4,0x3f55bf0ebec43f6d,0xbe483f7bbec4bf6d,0xbf0ebf553f6d3ec4
.quad 0x3f353f35bf80268d,0xbf35bf353f80270d,0x3f35bf35268d3f80,0xbf353f35270dbf80,0xbe48bf7b3f6d3ec4,0xbf0e3f55bec4bf6d,0xbf7b3e483ec4bf6d,0x3f553f0ebf6d3ec4,0xbec43f6dbf35bf35,0x3f6d3ec4bf353f35,0x3f6d3ec4bf353f35,0x3ec4bf6d3f353f35,0x3f55bf0e3ec43f6d,0x3e48bf7b3f6d3ec4,0xbf0ebf553f6dbec4,0xbf7bbe483ec4bf6d
.quad 0xbf80281fa7f7bf80,0xbf802730a60dbf80,0x281f3f80bf8027f7,0x27303f80bf80260d,0x3f553f0ebec43f6d,0x3e483f7bbf6d3ec4,0x3f0ebf553f6d3ec4,0x3f7bbe483ec43f6d,0xbec4bf6d3f35bf35,0x3f6dbec43f353f35,0xbf6d3ec4bf35bf35,0xbec4bf6d3f35bf35,0xbe483f7bbf6d3ec4,0xbf0ebf553ec4bf6d,0x3f7b3e483ec43f6d,0xbf553f0ebf6dbec4
.quad 0x3f35bf353f8026d4,0xbf353f35bf802754,0xbf35bf3526d4bf80,0x3f353f3527543f80,0xbf7b3e48bf6dbec4,0x3f553f0e3ec43f6d,0x3e483f7bbec43f6d,0x3f0ebf553f6dbec4,0x3f6d3ec43f353f35,0x3ec4bf6d3f35bf35,0x3ec4bf6d3f35bf35,0xbf6dbec4bf35bf35,0xbf0ebf55bec4bf6d,0xbf7bbe48bf6dbec4,0xbf553f0ebf6d3ec4,0xbe483f7bbec43f6d
.quad 0x260ebf8027543f80,0x21b7bf8027773f80,0xbf80a60e3f80a754,0xbf80a1b73f80a777,0xbf7bbe483f802828,0xbf0ebf553f353f35,0xbe483f7b2828bf80,0xbf553f0e3f35bf35,0xbec43f6da7f7bf80,0xbf6dbec43f8026d4,0x3f6d3ec4bf8027f7,0xbec43f6d26d4bf80,0x3f553f0ebf80281f,0xbf7b3e483f35bf35,0x3f0ebf55281f3f80,0x3e483f7bbf35bf35
.quad 0x3f35bf3528423f80,0xbf353f35a80dbf80,0xbf35bf353f80a842,0x3f353f35bf80280d,0xbf0ebf553f8026d4,0xbe483f7bbf35bf35,0xbf553f0e26d4bf80,0x3f7b3e48bf353f35,0xbf6d3ec4a884bf80,0x3ec43f6dbf80289a,0x3ec43f6dbf802884,0x3f6dbec4289a3f80,0x3e483f7bbf802730,0x3f553f0ebf353f35,0x3f7bbe4827303f80,0x3f0ebf553f353f35
.quad 0x3f80a7e5279f3f80,0x3f80a880a70d3f80,0xa7e5bf803f80a79f,0xa880bf803f80270d,0x3e48bf7b3f80a7e5,0x3f55bf0e3f353f35,0xbf7bbe48a7e5bf80,0xbf0ebf553f35bf35,0xbf6dbec427d4bf80,0x3ec4bf6d3f8028be,0xbec43f6dbf80a7d4,0xbf6dbec428bebf80,0xbf0e3f55bf802839,0xbe48bf7b3f35bf35,0x3f553f0e28393f80,0xbf7b3e48bf35bf35
.quad 0x3f353f35a70d3f80,0xbf35bf35a896bf80,0x3f35bf353f80270d,0xbf353f35bf802896,0x3f55bf0e3f80a880,0xbf7bbe48bf35bf35,0xbf0ebf55a880bf80,0xbe483f7bbf353f35,0xbec4bf6da909bf80,0xbf6d3ec4bf8028ea,0xbf6d3ec4bf802909,0x3ec43f6d28ea3f80,0xbf7b3e48bf8028a3,0xbf0e3f55bf353f35,0x3e483f7b28a33f80,0x3f553f0e3f353f35
.quad 0xa7f7bf80a78d3f80,0xa804bf8028423f80,0xbf8027f73f80278d,0xbf8028043f80a842,0xbf55bf0e3f6d3ec4,0xbe48bf7b3ec43f6d,0xbf0e3f553ec4bf6d,0xbf7b3e483f6dbec4,0xbf6d3ec43f35bf35,0xbec4bf6d3f353f35,0x3ec43f6dbf35bf35,0xbf6d3ec43f35bf35,0xbe483f7bbec4bf6d,0xbf0ebf553f6d3ec4,0x3f7b3e48bf6d3ec4,0xbf553f0e3ec4bf6d
.quad 0x3f353f35bf802828,0xbf35bf353f80a7e5,0x3f35bf3528283f80,0xbf353f35a7e5bf80,0x3f7bbe48bec43f6d,0xbf55bf0e3f6dbec4,0xbe48bf7b3f6d3ec4,0xbf0e3f55bec4bf6d,0x3ec4bf6d3f353f35,0xbf6dbec43f35bf35,0xbf6dbec43f35bf35,0xbec43f6dbf35bf35,0xbf0ebf553f6dbec4,0xbf7bbe483ec4bf6d,0xbf553f0ebec4bf6d,0xbe483f7bbf6dbec4
.quad 0xbf802839a816bf80,0xbf8028a3a70dbf80,0x28393f80bf802816,0x28a33f80bf80270d,0xbf0e3f55bf6dbec4,0xbf7b3e48bec4bf6d,0x3f553f0ebec43f6d,0x3e483f7bbf6d3ec4,0x3ec43f6dbf353f35,0xbf6d3ec4bf35bf35,0x3f6dbec43f353f35,0x3ec43f6dbf353f35,0x3f7b3e483ec43f6d,0xbf553f0ebf6dbec4,0x3e48bf7b3f6dbec4,0x3f0e3f55bec43f6d
.quad 0x3f35bf353f80a804,0xbf353f35bf80a731,0xbf35bf35a804bf80,0x3f353f35a7313f80,0xbe48bf7b3ec4bf6d,0xbf0e3f55bf6d3ec4,0xbf7b3e48bf6dbec4,0x3f553f0e3ec43f6d,0xbf6dbec4bf35bf35,0xbec43f6dbf353f35,0xbec43f6dbf353f35,0x3f6d3ec43f353f35,0xbf553f0ebf6d3ec4,0xbe483f7bbec43f6d,0x3f0e3f553ec43f6d,0x3f7b3e483f6d3ec4
.altmacro
.set tc0,16256
.set tc1,16256
.set tc2,16256
.set tc3,16256
.set tc4,16256
.set tc5,16256
.set tc6,16255
.set tc7,16255
.set tc8,16255
.set tc9,16255
.set tc10,16254
.set tc11,16254
.set tc12,16254
.set tc13,16253
.set tc14,16253
.set tc15,16253
.set tc16,16252
.set tc17,16252
.set tc18,16251
.set tc19,16251
.set tc20,16250
.set tc21,16249
.set tc22,16249
.set tc23,16248
.set tc24,16247
.set tc25,16247
.set tc26,16246
.set tc27,16245
.set tc28,16244
.set tc29,16243
.set tc30,16242
.set tc31,16242
.set tc32,16241
.set tc33,16240
.set tc34,16239
.set tc35,16238
.set tc36,16237
.set tc37,16235
.set tc38,16234
.set tc39,16233
.set tc40,16232
.set tc41,16231
.set tc42,16230
.set tc43,16228
.set tc44,16227
.set tc45,16226
.set tc46,16224
.set tc47,16223
.set tc48,16222
.set tc49,16220
.set tc50,16219
.set tc51,16217
.set tc52,16216
.set tc53,16214
.set tc54,16213
.set tc55,16211
.set tc56,16210
.set tc57,16208
.set tc58,16206
.set tc59,16205
.set tc60,16203
.set tc61,16201
.set tc62,16200
.set tc63,16198
.set tc64,16196
.set tc65,16194
.set tc66,16192
.set tc67,16191
.set tc68,16189
.set tc69,16187
.set tc70,16185
.set tc71,16183
.set tc72,16181
.set tc73,16179
.set tc74,16177
.set tc75,16175
.set tc76,16173
.set tc77,16171
.set tc78,16169
.set tc79,16167
.set tc80,16165
.set tc81,16162
.set tc82,16160
.set tc83,16158
.set tc84,16156
.set tc85,16154
.set tc86,16151
.set tc87,16149
.set tc88,16147
.set tc89,16145
.set tc90,16142
.set tc91,16140
.set tc92,16138
.set tc93,16135
.set tc94,16133
.set tc95,16130
.set tc96,16128
.set tc97,16123
.set tc98,16118
.set tc99,16113
.set tc100,16108
.set tc101,16103
.set tc102,16098
.set tc103,16093
.set tc104,16088
.set tc105,16083
.set tc106,16078
.set tc107,16073
.set tc108,16068
.set tc109,16063
.set tc110,16058
.set tc111,16052
.set tc112,16047
.set tc113,16042
.set tc114,16037
.set tc115,16031
.set tc116,16026
.set tc117,16021
.set tc118,16015
.set tc119,16010
.set tc120,16005
.set tc121,15998
.set tc122,15987
.set tc123,15977
.set tc124,15966
.set tc125,15955
.set tc126,15944
.set tc127,15933
.set tc128,15922
.set tc129,15911
.set tc130,15900
.set tc131,15889
.set tc132,15878
.set tc133,15861
.set tc134,15839
.set tc135,15817
.set tc136,15794
.set tc137,15772
.set tc138,15750
.set tc139,15711
.set tc140,15667
.set tc141,15622
.set tc142,15539
.set tc143,15411
.set tc144,9357
.set tc145,48179
.set tc146,48307
.set tc147,48390
.set tc148,48435
.set tc149,48479
.set tc150,48518
.set tc151,48540
.set tc152,48562
.set tc153,48585
.set tc154,48607
.set tc155,48629
.set tc156,48646
.set tc157,48657
.set tc158,48668
.set tc159,48679
.set tc160,48690
.set tc161,48701
.set tc162,48712
.set tc163,48723
.set tc164,48734
.set tc165,48745
.set tc166,48755
.set tc167,48766
.set tc168,48773
.set tc169,48778
.set tc170,48783
.set tc171,48789
.set tc172,48794
.set tc173,48799
.set tc174,48805
.set tc175,48810
.set tc176,48815
.set tc177,48820
.set tc178,48826
.set tc179,48831
.set tc180,48836
.set tc181,48841
.set tc182,48846
.set tc183,48851
.set tc184,48856
.set tc185,48861
.set tc186,48866
.set tc187,48871
.set tc188,48876
.set tc189,48881
.set tc190,48886
.set tc191,48891
.set tc192,48896
.set tc193,48898
.set tc194,48901
.set tc195,48903
.set tc196,48906
.set tc197,48908
.set tc198,48910
.set tc199,48913
.set tc200,48915
.set tc201,48917
.set tc202,48919
.set tc203,48922
.set tc204,48924
.set tc205,48926
.set tc206,48928
.set tc207,48930
.set tc208,48933
.set tc209,48935
.set tc210,48937
.set tc211,48939
.set tc212,48941
.set tc213,48943
.set tc214,48945
.set tc215,48947
.set tc216,48949
.set tc217,48951
.set tc218,48953
.set tc219,48955
.set tc220,48957
.set tc221,48959
.set tc222,48960
.set tc223,48962
.set tc224,48964
.set tc225,48966
.set tc226,48968
.set tc227,48969
.set tc228,48971
.set tc229,48973
.set tc230,48974
.set tc231,48976
.set tc232,48978
.set tc233,48979
.set tc234,48981
.set tc235,48982
.set tc236,48984
.set tc237,48985
.set tc238,48987
.set tc239,48988
.set tc240,48990
.set tc241,48991
.set tc242,48992
.set tc243,48994
.set tc244,48995
.set tc245,48996
.set tc246,48998
.set tc247,48999
.set tc248,49000
.set tc249,49001
.set tc250,49002
.set tc251,49003
.set tc252,49005
.set tc253,49006
.set tc254,49007
.set tc255,49008
.set tc256,49009
.set tc257,49010
.set tc258,49010
.set tc259,49011
.set tc260,49012
.set tc261,49013
.set tc262,49014
.set tc263,49015
.set tc264,49015
.set tc265,49016
.set tc266,49017
.set tc267,49017
.set tc268,49018
.set tc269,49019
.set tc270,49019
.set tc271,49020
.set tc272,49020
.set tc273,49021
.set tc274,49021
.set tc275,49021
.set tc276,49022
.set tc277,49022
.set tc278,49022
.set tc279,49023
.set tc280,49023
.set tc281,49023
.set tc282,49023
.set tc283,49024
.set tc284,49024
.set tc285,49024
.set tc286,49024
.set tc287,49024
.set tc288,49024
.set tc289,49024
.set tc290,49024
.set tc291,49024
.set tc292,49024
.set tc293,49024
.set tc294,49023
.set tc295,49023
.set tc296,49023
.set tc297,49023
.set tc298,49022
.set tc299,49022
.set tc300,49022
.set tc301,49021
.set tc302,49021
.set tc303,49021
.set tc304,49020
.set tc305,49020
.set tc306,49019
.set tc307,49019
.set tc308,49018
.set tc309,49017
.set tc310,49017
.set tc311,49016
.set tc312,49015
.set tc313,49015
.set tc314,49014
.set tc315,49013
.set tc316,49012
.set tc317,49011
.set tc318,49010
.set tc319,49010
.set tc320,49009
.set tc321,49008
.set tc322,49007
.set tc323,49006
.set tc324,49005
.set tc325,49003
.set tc326,49002
.set tc327,49001
.set tc328,49000
.set tc329,48999
.set tc330,48998
.set tc331,48996
.set tc332,48995
.set tc333,48994
.set tc334,48992
.set tc335,48991
.set tc336,48990
.set tc337,48988
.set tc338,48987
.set tc339,48985
.set tc340,48984
.set tc341,48982
.set tc342,48981
.set tc343,48979
.set tc344,48978
.set tc345,48976
.set tc346,48974
.set tc347,48973
.set tc348,48971
.set tc349,48969
.set tc350,48968
.set tc351,48966
.set tc352,48964
.set tc353,48962
.set tc354,48960
.set tc355,48959
.set tc356,48957
.set tc357,48955
.set tc358,48953
.set tc359,48951
.set tc360,48949
.set tc361,48947
.set tc362,48945
.set tc363,48943
.set tc364,48941
.set tc365,48939
.set tc366,48937
.set tc367,48935
.set tc368,48933
.set tc369,48930
.set tc370,48928
.set tc371,48926
.set tc372,48924
.set tc373,48922
.set tc374,48919
.set tc375,48917
.set tc376,48915
.set tc377,48913
.set tc378,48910
.set tc379,48908
.set tc380,48906
.set tc381,48903
.set tc382,48901
.set tc383,48898
.set tc384,48896
.set tc385,48891
.set tc386,48886
.set tc387,48881
.set tc388,48876
.set tc389,48871
.set tc390,48866
.set tc391,48861
.set tc392,48856
.set tc393,48851
.set tc394,48846
.set tc395,48841
.set tc396,48836
.set tc397,48831
.set tc398,48826
.set tc399,48820
.set tc400,48815
.set tc401,48810
.set tc402,48805
.set tc403,48799
.set tc404,48794
.set tc405,48789
.set tc406,48783
.set tc407,48778
.set tc408,48773
.set tc409,48766
.set tc410,48755
.set tc411,48745
.set tc412,48734
.set tc413,48723
.set tc414,48712
.set tc415,48701
.set tc416,48690
.set tc417,48679
.set tc418,48668
.set tc419,48657
.set tc420,48646
.set tc421,48629
.set tc422,48607
.set tc423,48585
.set tc424,48562
.set tc425,48540
.set tc426,48518
.set tc427,48479
.set tc428,48435
.set tc429,48390
.set tc430,48307
.set tc431,48179
.set tc432,42324
.set tc433,15411
.set tc434,15539
.set tc435,15622
.set tc436,15667
.set tc437,15711
.set tc438,15750
.set tc439,15772
.set tc440,15794
.set tc441,15817
.set tc442,15839
.set tc443,15861
.set tc444,15878
.set tc445,15889
.set tc446,15900
.set tc447,15911
.set tc448,15922
.set tc449,15933
.set tc450,15944
.set tc451,15955
.set tc452,15966
.set tc453,15977
.set tc454,15987
.set tc455,15998
.set tc456,16005
.set tc457,16010
.set tc458,16015
.set tc459,16021
.set tc460,16026
.set tc461,16031
.set tc462,16037
.set tc463,16042
.set tc464,16047
.set tc465,16052
.set tc466,16058
.set tc467,16063
.set tc468,16068
.set tc469,16073
.set tc470,16078
.set tc471,16083
.set tc472,16088
.set tc473,16093
.set tc474,16098
.set tc475,16103
.set tc476,16108
.set tc477,16113
.set tc478,16118
.set tc479,16123
.set tc480,16128
.set tc481,16130
.set tc482,16133
.set tc483,16135
.set tc484,16138
.set tc485,16140
.set tc486,16142
.set tc487,16145
.set tc488,16147
.set tc489,16149
.set tc490,16151
.set tc491,16154
.set tc492,16156
.set tc493,16158
.set tc494,16160
.set tc495,16162
.set tc496,16165
.set tc497,16167
.set tc498,16169
.set tc499,16171
.set tc500,16173
.set tc501,16175
.set tc502,16177
.set tc503,16179
.set tc504,16181
.set tc505,16183
.set tc506,16185
.set tc507,16187
.set tc508,16189
.set tc509,16191
.set tc510,16192
.set tc511,16194
.set tc512,16196
.set tc513,16198
.set tc514,16200
.set tc515,16201
.set tc516,16203
.set tc517,16205
.set tc518,16206
.set tc519,16208
.set tc520,16210
.set tc521,16211
.set tc522,16213
.set tc523,16214
.set tc524,16216
.set tc525,16217
.set tc526,16219
.set tc527,16220
.set tc528,16222
.set tc529,16223
.set tc530,16224
.set tc531,16226
.set tc532,16227
.set tc533,16228
.set tc534,16230
.set tc535,16231
.set tc536,16232
.set tc537,16233
.set tc538,16234
.set tc539,16235
.set tc540,16237
.set tc541,16238
.set tc542,16239
.set tc543,16240
.set tc544,16241
.set tc545,16242
.set tc546,16242
.set tc547,16243
.set tc548,16244
.set tc549,16245
.set tc550,16246
.set tc551,16247
.set tc552,16247
.set tc553,16248
.set tc554,16249
.set tc555,16249
.set tc556,16250
.set tc557,16251
.set tc558,16251
.set tc559,16252
.set tc560,16252
.set tc561,16253
.set tc562,16253
.set tc563,16253
.set tc564,16254
.set tc565,16254
.set tc566,16254
.set tc567,16255
.set tc568,16255
.set tc569,16255
.set tc570,16255
.set tc571,16256
.set tc572,16256
.set tc573,16256
.set tc574,16256
.set tc575,16256
.macro tab_e i
.short tc\i
.endm
.macro tab_row p, o
.set tn,0
.rept 576
tab_e %((tn*p+o)%576)
.set tn,tn+1
.endr
.endm
.p2align 8
.type TTAB,@object
TTAB:
tab_row 0, 0
tab_row 288, 0
.set tp,1
.rept 287
tab_row %tp, 0
tab_row %tp, 144
.set tp,tp+1
.endr
.noaltmacro
.section .rodata,"a"
.p2align 6
.amdhsa_kernel k1_kernel
  .amdhsa_next_free_vgpr 168
  .amdhsa_next_free_sgpr 102
  .amdhsa_accum_offset 168
  .amdhsa_group_segment_fixed_size 0
  .amdhsa_kernarg_size 88
  .amdhsa_user_sgpr_count 2
  .amdhsa_user_sgpr_kernarg_segment_ptr 1
  .amdhsa_system_sgpr_workgroup_id_x 1
.end_amdhsa_kernel
.text
.section .rodata,"a"
.p2align 6
.amdhsa_kernel k2_kernel
  .amdhsa_next_free_vgpr 168
  .amdhsa_next_free_sgpr 102
  .amdhsa_accum_offset 168
  .amdhsa_group_segment_fixed_size 0
  .amdhsa_kernarg_size 88
  .amdhsa_user_sgpr_count 2
  .amdhsa_user_sgpr_kernarg_segment_ptr 1
  .amdhsa_system_sgpr_workgroup_id_x 1
.end_amdhsa_kernel
.text
.section .rodata,"a"
.p2align 6
.amdhsa_kernel k3_kernel
  .amdhsa_next_free_vgpr 168
  .amdhsa_next_free_sgpr 102
  .amdhsa_accum_offset 168
  .amdhsa_group_segment_fixed_size 0
  .amdhsa_kernarg_size 88
  .amdhsa_user_sgpr_count 2
  .amdhsa_user_sgpr_kernarg_segment_ptr 1
  .amdhsa_system_sgpr_workgroup_id_x 1
.end_amdhsa_kernel
.text
```
